```python
import torch

def _softmax(x, axis=-1):
    return torch.softmax(x, dim=axis)
def _gelu(x):
    return torch.nn.functional.gelu(x, approximate="tanh")
def _silu(x):
    return torch.nn.functional.silu(x)
def _sigmoid(x):
    return torch.sigmoid(x)
def _layernorm(x, axis=-1, eps=1e-5):
    m = x.mean(dim=axis, keepdim=True)
    v = x.var(dim=axis, keepdim=True, unbiased=False)
    return (x - m) / torch.sqrt(v + eps)
def _scatter_add(tgt, idx, src, axis=0):
    return tgt.clone().index_add_(axis, idx, src)
def _segment_sum(src, seg, n):
    out = torch.zeros((n,) + src.shape[1:], dtype=src.dtype)
    return out.index_add_(0, seg, src)
def _pad(x, pw):
    flat = tuple(v for pair in reversed(pw) for v in pair)
    return torch.nn.functional.pad(x, flat)

kernel_name = 'recurrent_scan__ssm_conv_s5__dense_activation_gelu__prompt'

def setup_inputs():

    _w = (lambda a: (lambda t: t.to(torch.bfloat16) if t.is_floating_point() else t)(torch.as_tensor(a)))
    def _A_setup():
        B, S, D = 1, 2048, 576
        P = D
        Lambda_re = -0.5 * (lambda _x: torch.exp(torch.as_tensor(_x)))((lambda *s: torch.randn(*s, dtype=torch.bfloat16) * 0.4)(P))
        Lambda_im = (lambda *s: torch.randn(*s, dtype=torch.bfloat16) * 0.8)(P) * 1.0
        B_re = (lambda *s: torch.randn(*s, dtype=torch.bfloat16) * 0.8)(P, D) * (D ** -0.5)
        B_im = (lambda *s: torch.randn(*s, dtype=torch.bfloat16) * 0.8)(P, D) * (D ** -0.5)
        C_re = (lambda *s: torch.randn(*s, dtype=torch.bfloat16) * 0.8)(D, P) * (P ** -0.5)
        C_im = (lambda *s: torch.randn(*s, dtype=torch.bfloat16) * 0.8)(D, P) * (P ** -0.5)
        log_dt = (lambda *s: torch.randn(*s, dtype=torch.bfloat16) * 0.4)(P) * 0.3 - 2.0
        Dskip = (lambda *s: torch.randn(*s, dtype=torch.bfloat16) * 0.2)(D)
        return {
            "x": _w((lambda *s: torch.randn(*s, dtype=torch.bfloat16) * 0.05)(B, S, D)),
            "Lambda_re": _w(Lambda_re),
            "Lambda_im": _w(Lambda_im),
            "B_re": _w(B_re),
            "B_im": _w(B_im),
            "C_re": _w(C_re),
            "C_im": _w(C_im),
            "log_dt": _w(log_dt),
            "Dskip": _w(Dskip),
        }
    _A_in = _A_setup()

    def _B_setup():
        B, S, D, F = 1, 2048, 576, 4608
        return {
            "x": _w((lambda *s: torch.randn(*s, dtype=torch.bfloat16) * 0.05)(B, S, D)),
            "w1": _w((lambda *s: torch.randn(*s, dtype=torch.bfloat16) * 0.8)(D, F) * (D ** -0.5)),
            "b1": _w((lambda *s: torch.randn(*s, dtype=torch.bfloat16) * 12.8)(F) * 0.01),
            "w2": _w((lambda *s: torch.randn(*s, dtype=torch.bfloat16) * 0.8)(F, D) * (F ** -0.5)),
            "b2": _w((lambda *s: torch.randn(*s, dtype=torch.bfloat16) * 6.4)(D) * 0.01),
        }
    _B_in = _B_setup()

    return {
        "A_x": _A_in["x"],
        "A_Lambda_re": _A_in["Lambda_re"],
        "A_Lambda_im": _A_in["Lambda_im"],
        "A_B_re": _A_in["B_re"],
        "A_B_im": _A_in["B_im"],
        "A_C_re": _A_in["C_re"],
        "A_C_im": _A_in["C_im"],
        "A_log_dt": _A_in["log_dt"],
        "A_Dskip": _A_in["Dskip"],
        "B_x": _B_in["x"],
        "B_w1": _B_in["w1"],
        "B_b1": _B_in["b1"],
        "B_w2": _B_in["w2"],
        "B_b2": _B_in["b2"],
    }

def reference(A_x, A_Lambda_re, A_Lambda_im, A_B_re, A_B_im, A_C_re, A_C_im, A_log_dt, A_Dskip, B_x, B_w1, B_b1, B_w2, B_b2):
    def _A_ref(x, Lambda_re, Lambda_im, B_re, B_im, C_re, C_im, log_dt, Dskip):
        Bsz, L, H = x.shape
        Lam = Lambda_re + 1j * Lambda_im
        Bmat = B_re + 1j * B_im
        Cmat = C_re + 1j * C_im
        dt = torch.exp(log_dt)
        Lam_bar = torch.exp(dt * Lam)
        B_bar = ((Lam_bar - 1.0) / Lam)[:, None] * Bmat
        Bu = torch.einsum("bld,pd->blp", x + 0j, B_bar)
        h = torch.zeros_like(Bu[:, 0, :])
        hs = []
        for t in range(L):
            h = Lam_bar[None, :] * h + Bu[:, t, :]
            hs.append(h)
        hseq = torch.stack(hs, 1)
        y = 2.0 * torch.einsum("blp,dp->bld", hseq, Cmat).real + x * Dskip[None, None, :]
        return y

    def _B_ref(x, w1, b1, w2, b2):
        h = torch.einsum("bsd,df->bsf", x, w1) + b1
        h = _gelu(h)
        return torch.einsum("bsf,fd->bsd", h, w2) + b2

    x = A_x
    xn = _layernorm(x, axis=-1)
    s = _A_ref(xn, A_Lambda_re, A_Lambda_im, A_B_re, A_B_im, A_C_re, A_C_im, A_log_dt, A_Dskip)
    g = _silu(_B_ref(xn, B_w1, B_b1, B_w2, B_b2))
    return x + s * g
```

```asm
; @launch grid=(256,1,1) block=(512,1,1) lds=163840
.amdgcn_target "amdgcn-amd-amdhsa--gfx950"
.text
.p2align 8
CODE_BEGIN:
.globl recurrent_scan__ssm_conv_s5__dense_activation_gelu__prompt_kernel
.p2align 8
.type recurrent_scan__ssm_conv_s5__dense_activation_gelu__prompt_kernel,@function
recurrent_scan__ssm_conv_s5__dense_activation_gelu__prompt_kernel:
  s_cmp_ge_u32 s2, 256
  s_cbranch_scc1 K1_END
  s_load_dwordx16 s[48:63], s[0:1], 0
  s_load_dwordx16 s[64:79], s[0:1], 64
  s_load_dwordx2 s[80:81], s[0:1], 128
  v_lshrrev_b32 v1, 6, v0
  v_and_b32 v0, 63, v0
  v_readfirstlane_b32 s3, v1
  s_cmp_lt_u32 s2, 16
  s_cbranch_scc0 CT_SKIP
  s_getpc_b64 s[88:89]
CT_0:
  s_sub_u32 s88, s88, CT_0-CODE_BEGIN
  s_subb_u32 s89, s89, 0
  s_mov_b32 s90, CODE_END-CODE_BEGIN
  s_mov_b32 s91, 0x00020000
  s_and_b32 s40, s2, 8
  s_add_u32 s40, s40, s3
  s_lshr_b32 s40, s40, 1
  s_mul_i32 s40, s40, 3840
  s_bitcmp1_b32 s3, 0
  s_cselect_b32 s41, K1_SSM-CODE_BEGIN, 0
  s_add_u32 s40, s40, s41
  v_lshlrev_b32 v92, 7, v0
  s_mov_b64 exec, 0x3fffffff
  buffer_load_dword v92, v92, s[88:91], s40 offen
  s_mov_b64 exec, -1
CT_SKIP:
  s_and_b32 s40, s2, 3
  s_lshl_b32 s40, s40, 2
  s_bfe_u32 s41, s2, 0x20003
  s_add_u32 s6, s40, s41
  s_bfe_u32 s40, s2, 0x10002
  s_bfe_u32 s41, s2, 0x10005
  s_lshl1_add_u32 s40, s40, s41
  s_lshr_b32 s41, s2, 6
  s_lshl2_add_u32 s7, s41, s40
  s_and_b32 s4, s3, 3
  s_lshr_b32 s5, s3, 2
  s_lshl_b32 s36, s3, 10
  s_lshl_b32 s39, s3, 11
  s_lshl_b32 s40, s5, 1
  s_xor_b32 s38, s4, s40
  s_mov_b32 s37, 0x3f803f80
  s_lshl_b32 s40, s3, 4
  v_lshrrev_b32 v101, 3, v0
  v_add_u32 v101, s40, v101
  v_mul_u32_u24 v101, 0x480, v101
  v_and_b32 v102, 7, v0
  v_lshrrev_b32 v103, 4, v0
  v_xor_b32 v102, v102, v103
  v_lshl_add_u32 v4, v102, 4, v101
  v_xor_b32 v5, 64, v4
  v_add_u32 v5, 0x2400, v5
  s_and_b32 s42, s6, 7
  s_mul_i32 s42, s42, 1
  s_lshr_b32 s43, s7, 2
  s_mul_i32 s43, s43, 2
  s_add_u32 s42, s42, s43
  s_and_b32 s42, s42, 7
  s_lshl_b32 s42, s42, 2
  s_mov_b32 s44, 0x76543210
  s_mov_b32 s45, 0x65432108
  s_waitcnt lgkmcnt(0)
  s_lshr_b64 s[0:1], s[44:45], s42
  s_mul_i32 s40, s6, 147456
  s_add_u32 s8, s48, s40
  s_addc_u32 s9, s49, 0
  s_mov_b32 s10, 147456
  s_mov_b32 s11, 0x00020000
  s_cmp_ge_u32 s7, 12
  s_cbranch_scc1 K1_SSM
  s_and_b32 s40, s7, 3
  s_lshl2_add_u32 s40, s40, 0x40000
  s_bfe_u32 s40, 8192, s40
  s_add_u32 s40, s40, s7
  s_lshl1_add_u32 s40, s7, s40
  s_lshl_b32 s40, s40, 8
  s_mov_b32 s12, s68
  s_mov_b32 s13, s69
  s_mov_b32 s14, 5308416
  s_mov_b32 s15, 0x00020000
  s_lshl_b32 s42, s3, 3
  v_lshrrev_b32 v101, 3, v0
  v_add_u32 v101, s42, v101
  v_and_b32 v102, 7, v0
  v_bfe_u32 v103, v0, 4, 1
  v_lshlrev_b32 v103, 2, v103
  v_xor_b32 v102, v102, v103
  v_lshlrev_b32 v102, 4, v102
  v_mul_u32_u24 v6, 0x2400, v101
  v_add3_u32 v6, v6, v102, s40
  s_bfe_u32 s40, s0, 0x40000
  s_add_u32 m0, s39, 106496
  s_lshl_b32 s40, s40, 7
  buffer_load_dwordx4 v4, s[8:11], s40 offen lds
  s_bfe_u32 s41, s0, 0x40000
  s_add_u32 m0, s39, 107520
  s_lshl_b32 s41, s41, 7
  buffer_load_dwordx4 v5, s[8:11], s41 offen lds
  s_bfe_u32 s42, s0, 0x40000
  s_add_u32 m0, s36, 122880
  s_mul_i32 s86, s42, 589824
  buffer_load_dwordx4 v6, s[12:15], s86 offen offset:0 lds
  s_bfe_u32 s43, s0, 0x40004
  s_add_u32 m0, s39, 131072
  s_lshl_b32 s43, s43, 7
  buffer_load_dwordx4 v4, s[8:11], s43 offen lds
  s_bfe_u32 s44, s0, 0x40004
  s_add_u32 m0, s39, 132096
  s_lshl_b32 s44, s44, 7
  buffer_load_dwordx4 v5, s[8:11], s44 offen lds
  s_bfe_u32 s45, s0, 0x40004
  s_add_u32 m0, s36, 147456
  s_mul_i32 s88, s45, 589824
  buffer_load_dwordx4 v6, s[12:15], s88 offen offset:0 lds
  s_mov_b32 s20, s70
  s_mov_b32 s21, s71
  s_mov_b32 s22, 9216
  s_mov_b32 s23, 0x00020000
  v_bfe_u32 v101, v0, 1, 3
  v_lshrrev_b32 v103, 5, v0
  v_xor_b32 v103, v101, v103
  s_lshl_b32 s40, s38, 1
  v_xor_b32 v103, s40, v103
  v_lshlrev_b32 v103, 4, v103
  v_and_b32 v104, 31, v0
  s_lshl_b32 s40, s5, 4
  v_xor_b32 v104, s40, v104
  s_lshl_b32 s40, s4, 5
  v_add_u32 v102, s40, v104
  v_lshl_add_u32 v8, v102, 7, v103
  v_xor_b32 v9, 32, v8
  v_xor_b32 v10, 64, v8
  v_xor_b32 v11, 96, v8
  v_bfe_u32 v101, v0, 2, 2
  v_lshrrev_b32 v102, 1, v101
  v_xor_b32 v102, s5, v102
  v_lshlrev_b32 v102, 6, v102
  v_lshl_add_u32 v101, v101, 7, v102
  v_bfe_u32 v102, v0, 4, 1
  v_lshl_add_u32 v101, v102, 5, v101
  v_and_b32 v102, 3, v0
  v_lshl_add_u32 v101, v102, 3, v101
  v_lshrrev_b32 v102, 5, v0
  v_lshl_add_u32 v103, v102, 10, v101
  s_lshl_b32 s40, s38, 11
  v_add_u32 v12, s40, v103
  v_xor_b32 v13, 2048, v12
  v_xor_b32 v14, 4096, v12
  v_xor_b32 v15, 6144, v12
  v_add_u32 v96, 90112, v12
  v_add_u32 v97, 90112, v13
  v_add_u32 v98, 90112, v14
  v_add_u32 v99, 90112, v15
  v_and_b32 v101, 31, v0
  s_lshl_b32 s40, s5, 6
  v_lshl_add_u32 v103, v101, 1, s40
  v_lshl_add_u32 v31, v102, 16, v103
  s_lshl_b32 s40, s5, 9
  s_add_u32 s40, s40, 155648
  v_lshl_add_u32 v103, v101, 4, s40
  v_lshl_add_u32 v28, v102, 3, v103
  s_lshl_b32 s41, s4, 2
  v_add_u32 v30, s41, v103
  v_lshrrev_b32 v252, 2, v0
  v_xor_b32 v252, v252, v0
  v_bfe_u32 v252, v252, 2, 1
  v_add_u32 v252, -1, v252
  v_and_b32 v252, s37, v252
  v_mov_b32 v253, v252
  v_mov_b32 v254, v252
  v_mov_b32 v255, v252
  s_lshl_b32 s40, s4, 10
  s_add_u32 s40, s40, 157696
  v_lshl_add_u32 v50, v104, 5, s40
  s_lshl_b32 s41, s5, 4
  v_lshl_add_u32 v51, v102, 3, v50
  v_add_u32 v51, s41, v51
  v_mov_b32 v48, 0
  v_mov_b32 v49, 0
  s_bfe_u32 s46, s0, 0x40008
  s_add_u32 m0, s39, 81920
  s_lshl_b32 s46, s46, 7
  buffer_load_dwordx4 v4, s[8:11], s46 offen lds
  s_bfe_u32 s47, s0, 0x40008
  s_add_u32 m0, s39, 82944
  s_lshl_b32 s47, s47, 7
  buffer_load_dwordx4 v5, s[8:11], s47 offen lds
  s_bfe_u32 s40, s0, 0x40008
  s_add_u32 m0, s36, 98304
  s_mul_i32 s91, s40, 589824
  buffer_load_dwordx4 v6, s[12:15], s91 offen offset:0 lds
  s_lshr_b32 s42, s7, 2
  s_and_b32 s43, s7, 3
  s_mul_i32 s40, s42, 384
  s_sub_u32 s41, 5308416, s40
  s_add_u32 s16, s72, s40
  s_addc_u32 s17, s73, 0
  s_mov_b32 s18, s41
  s_mov_b32 s19, 0x00020000
  s_lshl_b32 s41, s43, 6
  s_add_u32 s44, s40, s41
  s_lshl_b32 s62, 1, s42
  s_xor_b32 s62, s62, 7
  s_mul_i32 s40, s6, 3
  s_add_u32 s40, s40, s42
  s_mul_i32 s40, s40, 786432
  s_add_u32 s24, s80, s40
  s_addc_u32 s25, s81, 0
  s_mov_b32 s26, 786432
  s_mov_b32 s27, 0x00020000
  s_mul_i32 s40, s6, 1179648
  s_add_u32 s40, s40, 41943040
  s_add_u32 s52, s80, s40
  s_addc_u32 s53, s81, 0
  s_mov_b32 s54, 1179648
  s_mov_b32 s55, 0x00020000
  s_lshl4_add_u32 s40, s6, s7
  s_lshl_b32 s40, s40, 7
  s_add_u32 s40, s40, 37945344
  s_cmp_eq_u32 s3, 0
  s_cselect_b32 s41, 4, 0
  s_add_u32 s28, s80, s40
  s_addc_u32 s29, s81, 0
  s_mov_b32 s30, s41
  s_mov_b32 s31, 0x00020000
  s_lshl_b32 s40, s6, 11
  s_add_u32 s40, s40, 37945344
  s_add_u32 s32, s80, s40
  s_addc_u32 s33, s81, 0
  s_mov_b32 s34, 2048
  s_mov_b32 s35, 0x00020000
  s_mov_b32 s89, 0
  s_lshl_b32 s87, s6, 3
  s_add_u32 s87, s87, 128
  s_mov_b32 s96, s78
  s_mov_b32 s97, s79
  s_mov_b32 s98, 256
  s_mov_b32 s99, 0x00020000
  s_mov_b32 s92, s64
  s_mov_b32 s93, s65
  s_mov_b32 s94, 1152
  s_mov_b32 s95, 0x00020000
  s_mov_b32 s40, s7
  s_and_b32 s56, s40, 3
  s_lshl2_add_u32 s56, s56, 0x40000
  s_bfe_u32 s56, 8192, s56
  s_add_u32 s56, s56, s40
  s_lshl1_add_u32 s56, s40, s56
  s_mul_i32 s56, s56, 147456
  s_mul_i32 s59, s40, 98304
  s_add_u32 s40, s40, 4
  s_sub_u32 s41, s40, 12
  s_cselect_b32 s40, s40, s41
  s_and_b32 s57, s40, 3
  s_lshl2_add_u32 s57, s57, 0x40000
  s_bfe_u32 s57, 8192, s57
  s_add_u32 s57, s57, s40
  s_lshl1_add_u32 s57, s40, s57
  s_mul_i32 s57, s57, 147456
  s_mul_i32 s60, s40, 98304
  s_add_u32 s40, s40, 4
  s_sub_u32 s41, s40, 12
  s_cselect_b32 s40, s40, s41
  s_and_b32 s58, s40, 3
  s_lshl2_add_u32 s58, s58, 0x40000
  s_bfe_u32 s58, 8192, s58
  s_add_u32 s58, s58, s40
  s_lshl1_add_u32 s58, s40, s58
  s_mul_i32 s58, s58, 147456
  s_mul_i32 s61, s40, 98304
  s_and_b32 s40, s43, 2
  s_lshl_b32 s40, s40, 6
  s_xor_b32 s41, s40, 128
  s_add_u32 s48, s56, s40
  s_add_u32 s63, s56, s41
  s_add_u32 s49, s57, s40
  s_add_u32 s64, s57, s41
  s_add_u32 s50, s58, s40
  s_add_u32 s65, s58, s41
  s_xor_b32 s40, s43, 0
  s_mul_i32 s66, s40, 98304
  s_xor_b32 s40, s43, 1
  s_mul_i32 s67, s40, 98304
  s_add_u32 s67, s67, 2048
  s_xor_b32 s40, s43, 2
  s_mul_i32 s68, s40, 98304
  s_add_u32 s68, s68, 2560
  s_xor_b32 s40, s43, 3
  s_mul_i32 s69, s40, 98304
  s_add_u32 s69, s69, 3072
  s_lshl_b32 s51, 16, s43
  s_xor_b32 s51, s51, 0xf0
  s_mov_b32 s70, s44
  s_lshl_b32 s40, s43, 5
  s_sub_u32 s71, 256, s40
  s_mov_b32 s90, 0xffff0000
  v_lshrrev_b32 v101, 3, v0
  s_lshl_b32 s100, s3, 3
  v_add_u32 v101, s100, v101
  v_mul_u32_u24 v101, 0x480, v101
  v_lshrrev_b32 v102, 3, v0
  v_and_b32 v102, 6, v102
  v_xor_b32 v102, v102, v0
  v_and_b32 v102, 7, v102
  v_lshl_add_u32 v101, v102, 4, v101
  s_and_b32 s100, s3, 2
  s_and_b32 s101, s7, 3
  s_xor_b32 s101, s101, s100
  s_lshl_b32 s101, s101, 5
  v_xor_b32 v7, s101, v101
  v_add_u32 v7, 0x100, v7
  s_lshl_b32 s101, s7, 1
  s_xor_b32 s101, s101, s3
  s_and_b32 s101, s101, 2
  s_lshl_b32 s101, s101, 5
  v_xor_b32 v1, s101, v101
  v_and_b32 v101, 16, v0
  v_lshrrev_b32 v102, 5, v0
  v_lshl_add_u32 v101, v102, 2, v101
  v_bfe_u32 v103, v0, 2, 2
  v_add_u32 v101, v101, v103
  s_lshl_b32 s100, s5, 5
  v_add_u32 v101, s100, v101
  v_bfe_u32 v104, v0, 4, 1
  v_xor_b32 v102, v102, v104
  v_and_b32 v104, 3, v0
  v_lshlrev_b32 v104, 3, v104
  v_lshrrev_b32 v103, 1, v103
  v_lshl_add_u32 v103, v102, 1, v103
  v_lshl_add_u32 v104, v103, 5, v104
  v_lshl_add_u32 v16, v101, 7, v104
  s_lshr_b32 s100, s7, 2
  s_mul_i32 s100, s100, 3
  s_and_b32 s101, s0, 15
  s_sub_u32 s100, s100, s101
  s_bfe_u32 s101, s7, 0x10001
  s_add_u32 s82, s100, s101
  s_add_u32 s83, s100, 2
  s_add_u32 s101, s82, 9
  s_min_u32 s82, s82, s101
  s_lshl_b32 s82, s82, 4
  s_add_u32 s101, s83, 9
  s_min_u32 s83, s83, s101
  s_lshl_b32 s83, s83, 4
  s_lshl_b32 s100, s7, 1
  s_xor_b32 s100, s100, s38
  s_and_b32 s100, s100, 3
  s_lshl2_add_u32 s82, s100, s82
  s_xor_b32 s100, s7, s38
  s_and_b32 s100, s100, 3
  s_lshl2_add_u32 s83, s100, s83
  s_and_b32 s100, s7, 3
  v_lshl_add_u32 v2, v0, 2, s100
  v_add_u32 v101, 4, v0
  s_andn2_b32 s100, s7, 3
  s_sub_u32 s100, s100, 4
  v_add_u32 v102, s100, v0
  s_mov_b64 vcc, 0xf0
  v_cndmask_b32 v2, v2, v102
  s_mov_b64 vcc, 0xf00
  v_cndmask_b32 v2, v2, v101
  v_lshlrev_b32 v2, 7, v2
  s_mov_b32 s44, s74
  s_mov_b32 s45, s75
  s_mov_b32 s46, 1152
  s_mov_b32 s47, 0x00020000
  s_sub_u32 s40, s71, 64
  v_mov_b32 v102, s40
  v_cmp_lt_u32 vcc, 15, v0
  v_lshl_add_u32 v101, v0, 2, s70
  s_nop 0
  v_cndmask_b32 v102, 0, v102
  v_add_u32 v101, v101, v102
  s_mov_b32 m0, 162816
  s_nop 0
  buffer_load_dword v101, s[44:47], 0 offen lds
  s_mov_b32 m0, 163072
  s_nop 0
  buffer_load_dword v101, s[92:95], 0 offen lds
  s_and_b32 s92, s7, 3
  s_lshl2_add_u32 s92, s92, 0x40000
  s_bfe_u32 s92, 8192, s92
  s_add_u32 s92, s92, s7
  s_lshl1_add_u32 s92, s7, s92
  s_lshl_b32 s92, s92, 8
  s_xor_b32 s40, s7, 0
  s_and_b32 s40, s40, 3
  s_lshl2_add_u32 s40, s40, 0x40000
  s_bfe_i32 s41, 61714, s40
  s_bfe_i32 s40, 57889, s40
  s_mul_i32 s94, s40, 147456
  s_sub_u32 s40, s40, s41
  s_lshl_b32 s93, s40, 8
  s_lshl_b32 s74, s41, 8
  s_mul_i32 s75, s41, 147456
  v_min_u32 v17, 8, v0
  v_lshlrev_b32 v17, 7, v17
  s_lshl3_add_u32 s40, s6, s3
  s_mul_i32 s40, s40, 3456
  s_mul_i32 s41, s7, 442368
  s_add_u32 s40, s40, s41
  v_add_u32 v17, s40, v17
  s_waitcnt vmcnt(8)
  s_barrier
  v_add_u32 v8, 0x14000, v8
  v_add_u32 v9, 0x14000, v9
  v_add_u32 v10, 0x14000, v10
  v_add_u32 v11, 0x14000, v11
  ds_read_b128 v[108:111], v8 offset:24576
  ds_read_b64_tr_b16 v[32:33], v96 offset:32768
  ds_read_b64_tr_b16 v[34:35], v96 offset:33280
  s_bfe_u32 s40, s0, 0x4000c
  s_add_u32 m0, s39, 16384
  s_lshl_b32 s40, s40, 7
  buffer_load_dwordx4 v4, s[8:11], s40 offen lds
  ds_read_b128 v[112:115], v9 offset:24576
  ds_read_b64_tr_b16 v[36:37], v97 offset:32768
  ds_read_b64_tr_b16 v[38:39], v97 offset:33280
  s_bfe_u32 s41, s0, 0x4000c
  s_add_u32 m0, s39, 17408
  s_lshl_b32 s41, s41, 7
  buffer_load_dwordx4 v5, s[8:11], s41 offen lds
  ds_read_b128 v[116:119], v10 offset:24576
  ds_read_b64_tr_b16 v[40:41], v98 offset:32768
  ds_read_b64_tr_b16 v[42:43], v98 offset:33280
  s_bfe_u32 s42, s0, 0x4000c
  s_add_u32 m0, s36, 8192
  s_mul_i32 s2, s42, 589824
  buffer_load_dwordx4 v6, s[12:15], s2 offen offset:0 lds
  s_waitcnt lgkmcnt(6)
  v_mfma_f32_16x16x32_bf16 v[24:27], v[252:255], v[32:35], 0
  v_mfma_f32_32x32x16_bf16 v[52:67], v[32:35], v[108:111], 0
  ds_read_b128 v[120:123], v11 offset:24576
  ds_read_b64_tr_b16 v[44:45], v99 offset:32768
  ds_read_b64_tr_b16 v[46:47], v99 offset:33280
  s_waitcnt vmcnt(8)
  s_barrier
  s_waitcnt lgkmcnt(6)
  v_mfma_f32_32x32x16_bf16 v[52:67], v[36:39], v[112:115], v[52:67]
  ds_read_b128 v[124:127], v8 offset:49152
  ds_read_b64_tr_b16 v[32:33], v96 offset:57344
  ds_read_b64_tr_b16 v[34:35], v96 offset:57856
  s_bfe_u32 s43, s0, 0x40010
  s_add_u32 m0, s39, 40960
  s_lshl_b32 s43, s43, 7
  buffer_load_dwordx4 v4, s[8:11], s43 offen lds
  s_waitcnt lgkmcnt(6)
  v_mfma_f32_32x32x16_bf16 v[52:67], v[40:43], v[116:119], v[52:67]
  ds_read_b128 v[128:131], v9 offset:49152
  ds_read_b64_tr_b16 v[36:37], v97 offset:57344
  ds_read_b64_tr_b16 v[38:39], v97 offset:57856
  s_bfe_u32 s40, s0, 0x40010
  s_add_u32 m0, s39, 41984
  s_lshl_b32 s40, s40, 7
  buffer_load_dwordx4 v5, s[8:11], s40 offen lds
  v_dot2c_f32_bf16 v48, s37, v108
  v_dot2c_f32_bf16 v49, v108, v108
  v_dot2c_f32_bf16 v48, s37, v109
  v_dot2c_f32_bf16 v49, v109, v109
  v_dot2c_f32_bf16 v48, s37, v110
  v_dot2c_f32_bf16 v49, v110, v110
  v_dot2c_f32_bf16 v48, s37, v111
  v_dot2c_f32_bf16 v49, v111, v111
  v_dot2c_f32_bf16 v48, s37, v112
  v_dot2c_f32_bf16 v49, v112, v112
  v_dot2c_f32_bf16 v48, s37, v113
  v_dot2c_f32_bf16 v49, v113, v113
  v_dot2c_f32_bf16 v48, s37, v114
  v_dot2c_f32_bf16 v49, v114, v114
  v_dot2c_f32_bf16 v48, s37, v115
  v_dot2c_f32_bf16 v49, v115, v115
  s_waitcnt lgkmcnt(6)
  v_mfma_f32_32x32x16_bf16 v[52:67], v[44:47], v[120:123], v[52:67]
  ds_read_b128 v[132:135], v10 offset:49152
  ds_read_b64_tr_b16 v[40:41], v98 offset:57344
  ds_read_b64_tr_b16 v[42:43], v98 offset:57856
  s_bfe_u32 s41, s0, 0x40010
  s_add_u32 m0, s36, 32768
  s_mul_i32 s78, s41, 589824
  buffer_load_dwordx4 v6, s[12:15], s78 offen offset:0 lds
  s_waitcnt lgkmcnt(6)
  v_mfma_f32_16x16x32_bf16 v[24:27], v[252:255], v[32:35], v[24:27]
  v_mfma_f32_32x32x16_bf16 v[52:67], v[32:35], v[124:127], v[52:67]
  ds_read_b128 v[136:139], v11 offset:49152
  ds_read_b64_tr_b16 v[44:45], v99 offset:57344
  ds_read_b64_tr_b16 v[46:47], v99 offset:57856
  s_waitcnt vmcnt(8)
  s_barrier
  s_waitcnt lgkmcnt(6)
  v_mfma_f32_32x32x16_bf16 v[52:67], v[36:39], v[128:131], v[52:67]
  ds_read_b128 v[140:143], v8 offset:0
  ds_read_b64_tr_b16 v[32:33], v96 offset:8192
  ds_read_b64_tr_b16 v[34:35], v96 offset:8704
  s_bfe_u32 s42, s0, 0x40014
  s_add_u32 m0, s39, 65536
  s_lshl_b32 s42, s42, 7
  buffer_load_dwordx4 v4, s[8:11], s42 offen lds
  s_waitcnt lgkmcnt(6)
  v_mfma_f32_32x32x16_bf16 v[52:67], v[40:43], v[132:135], v[52:67]
  ds_read_b128 v[144:147], v9 offset:0
  ds_read_b64_tr_b16 v[36:37], v97 offset:8192
  ds_read_b64_tr_b16 v[38:39], v97 offset:8704
  s_bfe_u32 s43, s0, 0x40014
  s_add_u32 m0, s39, 66560
  s_lshl_b32 s43, s43, 7
  buffer_load_dwordx4 v5, s[8:11], s43 offen lds
  v_dot2c_f32_bf16 v48, s37, v124
  v_dot2c_f32_bf16 v49, v124, v124
  v_dot2c_f32_bf16 v48, s37, v125
  v_dot2c_f32_bf16 v49, v125, v125
  v_dot2c_f32_bf16 v48, s37, v126
  v_dot2c_f32_bf16 v49, v126, v126
  v_dot2c_f32_bf16 v48, s37, v127
  v_dot2c_f32_bf16 v49, v127, v127
  v_dot2c_f32_bf16 v48, s37, v128
  v_dot2c_f32_bf16 v49, v128, v128
  v_dot2c_f32_bf16 v48, s37, v129
  v_dot2c_f32_bf16 v49, v129, v129
  v_dot2c_f32_bf16 v48, s37, v130
  v_dot2c_f32_bf16 v49, v130, v130
  v_dot2c_f32_bf16 v48, s37, v131
  v_dot2c_f32_bf16 v49, v131, v131
  s_waitcnt lgkmcnt(6)
  v_mfma_f32_32x32x16_bf16 v[52:67], v[44:47], v[136:139], v[52:67]
  ds_read_b128 v[148:151], v10 offset:0
  ds_read_b64_tr_b16 v[40:41], v98 offset:8192
  ds_read_b64_tr_b16 v[42:43], v98 offset:8704
  s_bfe_u32 s40, s0, 0x40014
  s_add_u32 m0, s36, 57344
  s_mul_i32 s79, s40, 589824
  buffer_load_dwordx4 v6, s[12:15], s79 offen offset:0 lds
  s_waitcnt lgkmcnt(6)
  v_mfma_f32_16x16x32_bf16 v[24:27], v[252:255], v[32:35], v[24:27]
  v_mfma_f32_32x32x16_bf16 v[52:67], v[32:35], v[140:143], v[52:67]
  ds_read_b128 v[152:155], v11 offset:0
  ds_read_b64_tr_b16 v[44:45], v99 offset:8192
  ds_read_b64_tr_b16 v[46:47], v99 offset:8704
  s_waitcnt vmcnt(6)
  s_barrier
  s_waitcnt lgkmcnt(6)
  v_mfma_f32_32x32x16_bf16 v[52:67], v[36:39], v[144:147], v[52:67]
  v_add_u32 v8, 0xffff0000, v8
  v_add_u32 v9, 0xffff0000, v9
  v_add_u32 v10, 0xffff0000, v10
  v_add_u32 v11, 0xffff0000, v11
  ds_read_b128 v[156:159], v8 offset:0
  ds_read_b64_tr_b16 v[32:33], v12 offset:8192
  ds_read_b64_tr_b16 v[34:35], v12 offset:8704
  s_bfe_u32 s41, s0, 0x40018
  s_add_u32 m0, s39, 106496
  s_lshl_b32 s41, s41, 7
  buffer_load_dwordx4 v4, s[8:11], s41 offen lds
  s_waitcnt lgkmcnt(6)
  v_mfma_f32_32x32x16_bf16 v[52:67], v[40:43], v[148:151], v[52:67]
  ds_read_b128 v[160:163], v9 offset:0
  ds_read_b64_tr_b16 v[36:37], v13 offset:8192
  ds_read_b64_tr_b16 v[38:39], v13 offset:8704
  s_bfe_u32 s42, s0, 0x40018
  s_add_u32 m0, s39, 107520
  s_lshl_b32 s42, s42, 7
  buffer_load_dwordx4 v5, s[8:11], s42 offen lds
  v_dot2c_f32_bf16 v48, s37, v140
  v_dot2c_f32_bf16 v49, v140, v140
  v_dot2c_f32_bf16 v48, s37, v141
  v_dot2c_f32_bf16 v49, v141, v141
  v_dot2c_f32_bf16 v48, s37, v142
  v_dot2c_f32_bf16 v49, v142, v142
  v_dot2c_f32_bf16 v48, s37, v143
  v_dot2c_f32_bf16 v49, v143, v143
  v_dot2c_f32_bf16 v48, s37, v144
  v_dot2c_f32_bf16 v49, v144, v144
  v_dot2c_f32_bf16 v48, s37, v145
  v_dot2c_f32_bf16 v49, v145, v145
  v_dot2c_f32_bf16 v48, s37, v146
  v_dot2c_f32_bf16 v49, v146, v146
  v_dot2c_f32_bf16 v48, s37, v147
  v_dot2c_f32_bf16 v49, v147, v147
  s_waitcnt lgkmcnt(6)
  v_mfma_f32_32x32x16_bf16 v[52:67], v[44:47], v[152:155], v[52:67]
  ds_read_b128 v[164:167], v10 offset:0
  ds_read_b64_tr_b16 v[40:41], v14 offset:8192
  ds_read_b64_tr_b16 v[42:43], v14 offset:8704
  s_bfe_u32 s43, s0, 0x40018
  s_add_u32 m0, s36, 122880
  s_mul_i32 s72, s43, 589824
  buffer_load_dwordx4 v6, s[12:15], s72 offen offset:0 lds
  s_waitcnt lgkmcnt(6)
  v_mfma_f32_16x16x32_bf16 v[24:27], v[252:255], v[32:35], v[24:27]
  v_mfma_f32_32x32x16_bf16 v[52:67], v[32:35], v[156:159], v[52:67]
  ds_read_b128 v[168:171], v11 offset:0
  ds_read_b64_tr_b16 v[44:45], v15 offset:8192
  ds_read_b64_tr_b16 v[46:47], v15 offset:8704
  s_waitcnt vmcnt(6)
  s_barrier
  s_waitcnt lgkmcnt(6)
  v_mfma_f32_32x32x16_bf16 v[52:67], v[36:39], v[160:163], v[52:67]
  ds_read_b128 v[172:175], v8 offset:24576
  ds_read_b64_tr_b16 v[32:33], v12 offset:32768
  ds_read_b64_tr_b16 v[34:35], v12 offset:33280
  s_bfe_u32 s40, s0, 0x4001c
  s_add_u32 m0, s39, 131072
  s_lshl_b32 s40, s40, 7
  buffer_load_dwordx4 v4, s[8:11], s40 offen lds
  s_bfe_u32 s41, s0, 0x4001c
  s_add_u32 m0, s39, 132096
  s_lshl_b32 s41, s41, 7
  buffer_load_dwordx4 v5, s[8:11], s41 offen lds
  v_mov_b32 v29, 0
  s_mov_b64 exec, 1
  buffer_store_dword v29, off, s[28:31], 0 sc1
  s_mov_b64 exec, -1
  s_waitcnt lgkmcnt(6)
  v_mfma_f32_32x32x16_bf16 v[52:67], v[40:43], v[164:167], v[52:67]
  ds_read_b128 v[176:179], v9 offset:24576
  ds_read_b64_tr_b16 v[36:37], v13 offset:32768
  ds_read_b64_tr_b16 v[38:39], v13 offset:33280
  s_bfe_u32 s42, s0, 0x4001c
  s_add_u32 m0, s36, 147456
  s_mul_i32 s73, s42, 589824
  buffer_load_dwordx4 v6, s[12:15], s73 offen offset:0 lds
  v_dot2c_f32_bf16 v48, s37, v156
  v_dot2c_f32_bf16 v49, v156, v156
  v_dot2c_f32_bf16 v48, s37, v157
  v_dot2c_f32_bf16 v49, v157, v157
  v_dot2c_f32_bf16 v48, s37, v158
  v_dot2c_f32_bf16 v49, v158, v158
  v_dot2c_f32_bf16 v48, s37, v159
  v_dot2c_f32_bf16 v49, v159, v159
  v_dot2c_f32_bf16 v48, s37, v160
  v_dot2c_f32_bf16 v49, v160, v160
  v_dot2c_f32_bf16 v48, s37, v161
  v_dot2c_f32_bf16 v49, v161, v161
  v_dot2c_f32_bf16 v48, s37, v162
  v_dot2c_f32_bf16 v49, v162, v162
  v_dot2c_f32_bf16 v48, s37, v163
  v_dot2c_f32_bf16 v49, v163, v163
  s_waitcnt lgkmcnt(6)
  v_mfma_f32_32x32x16_bf16 v[52:67], v[44:47], v[168:171], v[52:67]
  ds_read_b128 v[180:183], v10 offset:24576
  ds_read_b64_tr_b16 v[40:41], v14 offset:32768
  ds_read_b64_tr_b16 v[42:43], v14 offset:33280
  s_waitcnt lgkmcnt(6)
  v_mfma_f32_16x16x32_bf16 v[24:27], v[252:255], v[32:35], v[24:27]
  v_mfma_f32_32x32x16_bf16 v[52:67], v[32:35], v[172:175], v[52:67]
  ds_read_b128 v[184:187], v11 offset:24576
  ds_read_b64_tr_b16 v[44:45], v15 offset:32768
  ds_read_b64_tr_b16 v[46:47], v15 offset:33280
  s_waitcnt vmcnt(7)
  s_barrier
  s_waitcnt lgkmcnt(6)
  v_mfma_f32_32x32x16_bf16 v[52:67], v[36:39], v[176:179], v[52:67]
  ds_read_b128 v[188:191], v8 offset:49152
  ds_read_b64_tr_b16 v[32:33], v12 offset:57344
  ds_read_b64_tr_b16 v[34:35], v12 offset:57856
  s_and_b32 s43, s1, 15
  s_add_u32 m0, s39, 81920
  s_lshl_b32 s43, s43, 7
  buffer_load_dwordx4 v4, s[8:11], s43 offen lds
  s_and_b32 s40, s1, 15
  s_add_u32 m0, s39, 82944
  s_lshl_b32 s40, s40, 7
  buffer_load_dwordx4 v5, s[8:11], s40 offen lds
  s_waitcnt lgkmcnt(6)
  v_mfma_f32_32x32x16_bf16 v[52:67], v[40:43], v[180:183], v[52:67]
  ds_read_b128 v[192:195], v9 offset:49152
  ds_read_b64_tr_b16 v[36:37], v13 offset:57344
  ds_read_b64_tr_b16 v[38:39], v13 offset:57856
  s_and_b32 s41, s1, 15
  s_add_u32 m0, s36, 98304
  s_mul_i32 s39, s41, 589824
  buffer_load_dwordx4 v6, s[12:15], s39 offen offset:0 lds
  s_add_u32 m0, s36, 0
  s_add_u32 s42, s86, 128
  buffer_load_dwordx4 v6, s[12:15], s42 offen offset:0 lds
  v_dot2c_f32_bf16 v48, s37, v172
  v_dot2c_f32_bf16 v49, v172, v172
  v_dot2c_f32_bf16 v48, s37, v173
  v_dot2c_f32_bf16 v49, v173, v173
  v_dot2c_f32_bf16 v48, s37, v174
  v_dot2c_f32_bf16 v49, v174, v174
  v_dot2c_f32_bf16 v48, s37, v175
  v_dot2c_f32_bf16 v49, v175, v175
  v_dot2c_f32_bf16 v48, s37, v176
  v_dot2c_f32_bf16 v49, v176, v176
  v_dot2c_f32_bf16 v48, s37, v177
  v_dot2c_f32_bf16 v49, v177, v177
  v_dot2c_f32_bf16 v48, s37, v178
  v_dot2c_f32_bf16 v49, v178, v178
  v_dot2c_f32_bf16 v48, s37, v179
  v_dot2c_f32_bf16 v49, v179, v179
  s_waitcnt lgkmcnt(6)
  v_mfma_f32_32x32x16_bf16 v[52:67], v[44:47], v[184:187], v[52:67]
  ds_read_b128 v[196:199], v10 offset:49152
  ds_read_b64_tr_b16 v[40:41], v14 offset:57344
  ds_read_b64_tr_b16 v[42:43], v14 offset:57856
  s_add_u32 m0, s36, 8064
  s_nop 0
  buffer_load_dwordx4 v6, s[12:15], s88 offen offset:128 lds
  s_add_u32 m0, s36, 16256
  s_nop 0
  buffer_load_dwordx4 v6, s[12:15], s91 offen offset:128 lds
  s_waitcnt lgkmcnt(6)
  v_mfma_f32_16x16x32_bf16 v[24:27], v[252:255], v[32:35], v[24:27]
  v_mfma_f32_32x32x16_bf16 v[52:67], v[32:35], v[188:191], v[52:67]
  ds_read_b128 v[200:203], v11 offset:49152
  ds_read_b64_tr_b16 v[44:45], v15 offset:57344
  ds_read_b64_tr_b16 v[46:47], v15 offset:57856
  s_waitcnt vmcnt(10)
  s_barrier
  s_waitcnt lgkmcnt(6)
  v_mfma_f32_32x32x16_bf16 v[52:67], v[36:39], v[192:195], v[52:67]
  v_add_u32 v8, 0x10000, v8
  v_add_u32 v9, 0x10000, v9
  v_add_u32 v10, 0x10000, v10
  v_add_u32 v11, 0x10000, v11
  ds_read_b128 v[204:207], v8 offset:24576
  ds_read_b64_tr_b16 v[32:33], v96 offset:32768
  ds_read_b64_tr_b16 v[34:35], v96 offset:33280
  s_add_u32 m0, s36, 24448
  s_nop 0
  buffer_load_dwordx4 v6, s[12:15], s2 offen offset:128 lds
  s_add_u32 m0, s36, 32640
  s_nop 0
  buffer_load_dwordx4 v6, s[12:15], s78 offen offset:128 lds
  s_waitcnt lgkmcnt(6)
  v_mfma_f32_32x32x16_bf16 v[52:67], v[40:43], v[196:199], v[52:67]
  ds_read_b128 v[208:211], v9 offset:24576
  ds_read_b64_tr_b16 v[36:37], v97 offset:32768
  ds_read_b64_tr_b16 v[38:39], v97 offset:33280
  s_add_u32 m0, s36, 40832
  s_nop 0
  buffer_load_dwordx4 v6, s[12:15], s79 offen offset:128 lds
  v_dot2c_f32_bf16 v48, s37, v188
  v_dot2c_f32_bf16 v49, v188, v188
  v_dot2c_f32_bf16 v48, s37, v189
  v_dot2c_f32_bf16 v49, v189, v189
  v_dot2c_f32_bf16 v48, s37, v190
  v_dot2c_f32_bf16 v49, v190, v190
  v_dot2c_f32_bf16 v48, s37, v191
  v_dot2c_f32_bf16 v49, v191, v191
  v_dot2c_f32_bf16 v48, s37, v192
  v_dot2c_f32_bf16 v49, v192, v192
  v_dot2c_f32_bf16 v48, s37, v193
  v_dot2c_f32_bf16 v49, v193, v193
  v_dot2c_f32_bf16 v48, s37, v194
  v_dot2c_f32_bf16 v49, v194, v194
  v_dot2c_f32_bf16 v48, s37, v195
  v_dot2c_f32_bf16 v49, v195, v195
  s_waitcnt lgkmcnt(6)
  v_mfma_f32_32x32x16_bf16 v[52:67], v[44:47], v[200:203], v[52:67]
  ds_read_b128 v[212:215], v10 offset:24576
  ds_read_b64_tr_b16 v[40:41], v98 offset:32768
  ds_read_b64_tr_b16 v[42:43], v98 offset:33280
  s_add_u32 m0, s36, 49024
  s_nop 0
  buffer_load_dwordx4 v6, s[12:15], s72 offen offset:128 lds
  s_waitcnt lgkmcnt(6)
  v_mfma_f32_16x16x32_bf16 v[24:27], v[252:255], v[32:35], v[24:27]
  v_mfma_f32_32x32x16_bf16 v[52:67], v[32:35], v[204:207], v[52:67]
  ds_read_b128 v[216:219], v11 offset:24576
  ds_read_b64_tr_b16 v[44:45], v99 offset:32768
  ds_read_b64_tr_b16 v[46:47], v99 offset:33280
  s_waitcnt vmcnt(10)
  s_barrier
  s_waitcnt lgkmcnt(6)
  v_mfma_f32_32x32x16_bf16 v[52:67], v[36:39], v[208:211], v[52:67]
  ds_read_b128 v[220:223], v8 offset:49152
  ds_read_b64_tr_b16 v[32:33], v96 offset:57344
  ds_read_b64_tr_b16 v[34:35], v96 offset:57856
  s_add_u32 m0, s36, 57216
  s_nop 0
  buffer_load_dwordx4 v6, s[12:15], s73 offen offset:128 lds
  s_waitcnt lgkmcnt(6)
  v_mfma_f32_32x32x16_bf16 v[52:67], v[40:43], v[212:215], v[52:67]
  ds_read_b128 v[224:227], v9 offset:49152
  ds_read_b64_tr_b16 v[36:37], v97 offset:57344
  ds_read_b64_tr_b16 v[38:39], v97 offset:57856
  v_dot2c_f32_bf16 v48, s37, v204
  v_dot2c_f32_bf16 v49, v204, v204
  v_dot2c_f32_bf16 v48, s37, v205
  v_dot2c_f32_bf16 v49, v205, v205
  v_dot2c_f32_bf16 v48, s37, v206
  v_dot2c_f32_bf16 v49, v206, v206
  v_dot2c_f32_bf16 v48, s37, v207
  v_dot2c_f32_bf16 v49, v207, v207
  v_dot2c_f32_bf16 v48, s37, v208
  v_dot2c_f32_bf16 v49, v208, v208
  v_dot2c_f32_bf16 v48, s37, v209
  v_dot2c_f32_bf16 v49, v209, v209
  v_dot2c_f32_bf16 v48, s37, v210
  v_dot2c_f32_bf16 v49, v210, v210
  v_dot2c_f32_bf16 v48, s37, v211
  v_dot2c_f32_bf16 v49, v211, v211
  s_waitcnt lgkmcnt(6)
  v_mfma_f32_32x32x16_bf16 v[52:67], v[44:47], v[216:219], v[52:67]
  ds_read_b128 v[228:231], v10 offset:49152
  ds_read_b64_tr_b16 v[40:41], v98 offset:57344
  ds_read_b64_tr_b16 v[42:43], v98 offset:57856
  buffer_load_ushort v23, v31, s[20:23], s92 offen
  s_waitcnt lgkmcnt(6)
  v_mfma_f32_16x16x32_bf16 v[24:27], v[252:255], v[32:35], v[24:27]
  v_mfma_f32_32x32x16_bf16 v[52:67], v[32:35], v[220:223], v[52:67]
  ds_read_b128 v[232:235], v11 offset:49152
  ds_read_b64_tr_b16 v[44:45], v99 offset:57344
  ds_read_b64_tr_b16 v[46:47], v99 offset:57856
  s_waitcnt vmcnt(9)
  s_barrier
  s_cmp_eq_u32 s3, 0
  s_cselect_b32 s40, s87, 0x1000
  s_lshl_b32 s41, 1, s7
  v_mov_b32 v29, s41
  s_mov_b64 exec, 1
  buffer_atomic_or v29, off, s[96:99], s40 sc1
  s_mov_b64 exec, -1
  s_waitcnt lgkmcnt(6)
  v_mfma_f32_32x32x16_bf16 v[52:67], v[36:39], v[224:227], v[52:67]
  ds_read_b128 v[236:239], v8 offset:0
  ds_read_b64_tr_b16 v[32:33], v96 offset:8192
  ds_read_b64_tr_b16 v[34:35], v96 offset:8704
  s_add_u32 m0, s36, 106368
  s_nop 0
  buffer_load_dwordx4 v6, s[12:15], s39 offen offset:128 lds
  s_waitcnt lgkmcnt(6)
  v_mfma_f32_32x32x16_bf16 v[52:67], v[40:43], v[228:231], v[52:67]
  ds_read_b128 v[240:243], v9 offset:0
  ds_read_b64_tr_b16 v[36:37], v97 offset:8192
  ds_read_b64_tr_b16 v[38:39], v97 offset:8704
  s_add_u32 m0, s36, 114688
  v_add_u32 v6, s74, v6
  buffer_load_dwordx4 v6, s[12:15], s86 offen offset:0 lds
  v_dot2c_f32_bf16 v48, s37, v220
  v_dot2c_f32_bf16 v49, v220, v220
  v_dot2c_f32_bf16 v48, s37, v221
  v_dot2c_f32_bf16 v49, v221, v221
  v_dot2c_f32_bf16 v48, s37, v222
  v_dot2c_f32_bf16 v49, v222, v222
  v_dot2c_f32_bf16 v48, s37, v223
  v_dot2c_f32_bf16 v49, v223, v223
  v_dot2c_f32_bf16 v48, s37, v224
  v_dot2c_f32_bf16 v49, v224, v224
  v_dot2c_f32_bf16 v48, s37, v225
  v_dot2c_f32_bf16 v49, v225, v225
  v_dot2c_f32_bf16 v48, s37, v226
  v_dot2c_f32_bf16 v49, v226, v226
  v_dot2c_f32_bf16 v48, s37, v227
  v_dot2c_f32_bf16 v49, v227, v227
  s_waitcnt lgkmcnt(6)
  v_mfma_f32_32x32x16_bf16 v[52:67], v[44:47], v[232:235], v[52:67]
  ds_read_b128 v[244:247], v10 offset:0
  ds_read_b64_tr_b16 v[40:41], v98 offset:8192
  ds_read_b64_tr_b16 v[42:43], v98 offset:8704
  s_add_u32 m0, s36, 122880
  s_nop 0
  buffer_load_dwordx4 v6, s[12:15], s88 offen offset:0 lds
  s_waitcnt lgkmcnt(6)
  v_mfma_f32_16x16x32_bf16 v[24:27], v[252:255], v[32:35], v[24:27]
  v_mfma_f32_32x32x16_bf16 v[52:67], v[32:35], v[236:239], v[52:67]
  ds_read_b128 v[248:251], v11 offset:0
  ds_read_b64_tr_b16 v[44:45], v99 offset:8192
  ds_read_b64_tr_b16 v[46:47], v99 offset:8704
  s_waitcnt vmcnt(12)
  s_barrier
  s_waitcnt lgkmcnt(6)
  v_mfma_f32_32x32x16_bf16 v[52:67], v[36:39], v[240:243], v[52:67]
  ds_read_b64_tr_b16 v[32:33], v12 offset:0
  ds_read_b64_tr_b16 v[34:35], v12 offset:512
  v_dot2c_f32_bf16 v48, s37, v236
  v_dot2c_f32_bf16 v49, v236, v236
  v_dot2c_f32_bf16 v48, s37, v237
  v_dot2c_f32_bf16 v49, v237, v237
  v_dot2c_f32_bf16 v48, s37, v238
  v_dot2c_f32_bf16 v49, v238, v238
  v_dot2c_f32_bf16 v48, s37, v239
  v_dot2c_f32_bf16 v49, v239, v239
  v_dot2c_f32_bf16 v48, s37, v240
  v_dot2c_f32_bf16 v49, v240, v240
  v_dot2c_f32_bf16 v48, s37, v241
  v_dot2c_f32_bf16 v49, v241, v241
  v_dot2c_f32_bf16 v48, s37, v242
  v_dot2c_f32_bf16 v49, v242, v242
  v_dot2c_f32_bf16 v48, s37, v243
  v_dot2c_f32_bf16 v49, v243, v243
  ds_write_b32 v30, v24
  s_nop 1
  ds_write_b64 v51, v[48:49]
  s_waitcnt lgkmcnt(7)
  v_mfma_f32_32x32x16_bf16 v[52:67], v[40:43], v[244:247], v[52:67]
  ds_read_b64_tr_b16 v[36:37], v13 offset:0
  ds_read_b64_tr_b16 v[38:39], v13 offset:512
  s_waitcnt lgkmcnt(2)
  s_barrier
  ds_read_b64 v[10:11], v28
  ds_read_b128 v[100:103], v50
  ds_read_b128 v[104:107], v50 offset:16
  s_add_u32 m0, s36, 131072
  v_mfma_f32_32x32x16_bf16 v[52:67], v[44:47], v[248:251], v[52:67]
  ds_read_b64_tr_b16 v[40:41], v14 offset:0
  ds_read_b64_tr_b16 v[42:43], v14 offset:512
  buffer_load_dwordx4 v6, s[12:15], s91 offen offset:0 lds
  v_mfma_f32_16x16x32_bf16 v[24:27], v[252:255], v[32:35], 0
  v_mfma_f32_32x32x16_bf16 v[68:83], v[32:35], v[108:111], 0
  ds_read_b64_tr_b16 v[44:45], v15 offset:0
  ds_read_b64_tr_b16 v[46:47], v15 offset:512
  s_waitcnt lgkmcnt(6)
  v_add_f32 v10, v10, v11
  v_cvt_pk_bf16_f32 v11, v10, v10
  v_lshlrev_b32 v11, 16, v11
  v_sub_f32 v10, v10, v11
  v_cvt_pk_bf16_f32 v22, v11, v10
  s_waitcnt lgkmcnt(5)
  v_add_f32 v100, v100, v102
  s_waitcnt vmcnt(10)
  s_barrier
  v_mfma_f32_32x32x16_bf16 v[68:83], v[36:39], v[112:115], v[68:83]
  ds_read_b64_tr_b16 v[32:33], v12 offset:8192
  ds_read_b64_tr_b16 v[34:35], v12 offset:8704
  v_add_f32 v101, v101, v103
  s_waitcnt lgkmcnt(6)
  v_add_f32 v104, v104, v106
  v_add_f32 v105, v105, v107
  v_add_f32 v100, v100, v104
  v_add_f32 v101, v101, v105
  s_waitcnt lgkmcnt(4)
  v_mfma_f32_32x32x16_bf16 v[68:83], v[40:43], v[116:119], v[68:83]
  ds_read_b64_tr_b16 v[36:37], v13 offset:8192
  ds_read_b64_tr_b16 v[38:39], v13 offset:8704
  v_mul_f32 v100, 0x3ae38e39, v100
  v_mul_f32 v101, 0x3ae38e39, v101
  v_cvt_pk_bf16_f32 v20, -v100, -v100
  v_fma_f32 v101, -v100, v100, v101
  v_max_f32 v101, 0, v101
  s_waitcnt lgkmcnt(4)
  v_mfma_f32_32x32x16_bf16 v[68:83], v[44:47], v[120:123], v[68:83]
  ds_read_b64_tr_b16 v[40:41], v14 offset:8192
  ds_read_b64_tr_b16 v[42:43], v14 offset:8704
  v_cvt_pk_bf16_f32 v102, v101, v101
  v_lshlrev_b32 v102, 16, v102
  v_add_f32 v102, 0x3727c5ac, v102
  v_cvt_pk_bf16_f32 v102, v102, v102
  v_lshlrev_b32 v102, 16, v102
  s_waitcnt lgkmcnt(4)
  v_mfma_f32_16x16x32_bf16 v[24:27], v[252:255], v[32:35], v[24:27]
  v_mfma_f32_32x32x16_bf16 v[68:83], v[32:35], v[124:127], v[68:83]
  ds_read_b64_tr_b16 v[44:45], v15 offset:8192
  ds_read_b64_tr_b16 v[46:47], v15 offset:8704
  v_sqrt_f32 v102, v102
  v_and_b32 v104, 0xffff, v20
  v_cvt_pk_bf16_f32 v21, v102, 0
  v_lshlrev_b32 v102, 16, v21
  v_or_b32 v104, v104, v102
  s_waitcnt lgkmcnt(4)
  v_mfma_f32_32x32x16_bf16 v[68:83], v[36:39], v[128:131], v[68:83]
  ds_read_b64_tr_b16 v[32:33], v12 offset:16384
  ds_read_b64_tr_b16 v[34:35], v12 offset:16896
  v_rcp_f32 v105, v102
  s_waitcnt lgkmcnt(4)
  v_mfma_f32_32x32x16_bf16 v[68:83], v[40:43], v[132:135], v[68:83]
  ds_read_b64_tr_b16 v[36:37], v13 offset:16384
  ds_read_b64_tr_b16 v[38:39], v13 offset:16896
  v_mul_f32 v18, 0xc0135761, v105
  v_mul_f32 v102, v105, v105
  v_mul_f32 v19, 0x3d372713, v18
  v_mul_f32 v19, v19, v102
  s_waitcnt vmcnt(5)
  v_mfma_f32_32x32x8_bf16 v[52:67], v[22:23], v[20:21], v[52:67]
  s_add_u32 m0, s36, 139264
  s_waitcnt lgkmcnt(4)
  v_mfma_f32_32x32x16_bf16 v[68:83], v[44:47], v[136:139], v[68:83]
  ds_read_b64_tr_b16 v[40:41], v14 offset:16384
  ds_read_b64_tr_b16 v[42:43], v14 offset:16896
  v_lshrrev_b32 v50, 2, v50
  v_add_u32 v50, 122368, v50
  ds_write_b64 v50, v[104:105]
  buffer_load_ushort v23, v31, s[20:23], s92 offen offset:128
  buffer_load_dwordx4 v6, s[12:15], s2 offen offset:0 lds
  s_waitcnt lgkmcnt(5)
  v_mfma_f32_16x16x32_bf16 v[24:27], v[252:255], v[32:35], v[24:27]
  v_mfma_f32_32x32x16_bf16 v[68:83], v[32:35], v[140:143], v[68:83]
  ds_read_b64_tr_b16 v[44:45], v15 offset:16384
  ds_read_b64_tr_b16 v[46:47], v15 offset:16896
  s_waitcnt lgkmcnt(5)
  v_mfma_f32_32x32x16_bf16 v[68:83], v[36:39], v[144:147], v[68:83]
  ds_read_b64_tr_b16 v[32:33], v12 offset:24576
  ds_read_b64_tr_b16 v[34:35], v12 offset:25088
  v_mul_f32 v92, v52, v52
  v_fma_f32 v92, v92, v19, v18
  v_mul_f32 v92, v92, v52
  v_exp_f32 v92, v92
  s_waitcnt lgkmcnt(5)
  v_mfma_f32_32x32x16_bf16 v[68:83], v[40:43], v[148:151], v[68:83]
  ds_read_b64_tr_b16 v[36:37], v13 offset:24576
  ds_read_b64_tr_b16 v[38:39], v13 offset:25088
  v_add_f32 v92, 1.0, v92
  v_rcp_f32 v92, v92
  s_add_u32 m0, s36, 147456
  v_mul_f32 v92, v92, v52
  s_waitcnt lgkmcnt(4)
  v_mfma_f32_32x32x16_bf16 v[68:83], v[44:47], v[152:155], v[68:83]
  ds_read_b64_tr_b16 v[40:41], v14 offset:24576
  ds_read_b64_tr_b16 v[42:43], v14 offset:25088
  v_mul_f32 v93, v53, v53
  v_fma_f32 v93, v93, v19, v18
  v_mul_f32 v93, v93, v53
  v_exp_f32 v93, v93
  buffer_load_dwordx4 v6, s[12:15], s78 offen offset:0 lds
  s_waitcnt lgkmcnt(4)
  v_mfma_f32_16x16x32_bf16 v[24:27], v[252:255], v[32:35], v[24:27]
  v_mfma_f32_32x32x16_bf16 v[68:83], v[32:35], v[156:159], v[68:83]
  ds_read_b64_tr_b16 v[44:45], v15 offset:24576
  ds_read_b64_tr_b16 v[46:47], v15 offset:25088
  v_add_f32 v93, 1.0, v93
  v_rcp_f32 v93, v93
  s_nop 0
  v_mul_f32 v93, v93, v53
  s_barrier
  s_waitcnt lgkmcnt(4)
  v_mfma_f32_32x32x16_bf16 v[68:83], v[36:39], v[160:163], v[68:83]
  ds_read_b64_tr_b16 v[32:33], v12 offset:32768
  ds_read_b64_tr_b16 v[34:35], v12 offset:33280
  v_mul_f32 v94, v54, v54
  v_fma_f32 v94, v94, v19, v18
  v_mul_f32 v94, v94, v54
  v_exp_f32 v94, v94
  s_waitcnt lgkmcnt(4)
  v_mfma_f32_32x32x16_bf16 v[68:83], v[40:43], v[164:167], v[68:83]
  ds_read_b64_tr_b16 v[36:37], v13 offset:32768
  ds_read_b64_tr_b16 v[38:39], v13 offset:33280
  v_add_f32 v94, 1.0, v94
  v_rcp_f32 v94, v94
  s_add_u32 m0, s36, 98304
  v_mul_f32 v94, v94, v54
  s_waitcnt lgkmcnt(4)
  v_mfma_f32_32x32x16_bf16 v[68:83], v[44:47], v[168:171], v[68:83]
  ds_read_b64_tr_b16 v[40:41], v14 offset:32768
  ds_read_b64_tr_b16 v[42:43], v14 offset:33280
  v_mul_f32 v95, v55, v55
  v_fma_f32 v95, v95, v19, v18
  v_mul_f32 v95, v95, v55
  v_exp_f32 v95, v95
  buffer_load_dwordx4 v6, s[12:15], s79 offen offset:0 lds
  s_waitcnt lgkmcnt(4)
  v_mfma_f32_16x16x32_bf16 v[24:27], v[252:255], v[32:35], v[24:27]
  v_mfma_f32_32x32x16_bf16 v[68:83], v[32:35], v[172:175], v[68:83]
  ds_read_b64_tr_b16 v[44:45], v15 offset:32768
  ds_read_b64_tr_b16 v[46:47], v15 offset:33280
  v_add_f32 v95, 1.0, v95
  v_rcp_f32 v95, v95
  v_cvt_pk_bf16_f32 v100, v92, v93
  v_mul_f32 v95, v95, v55
  buffer_load_dword v9, v17, s[16:19], 0 offen offset:0
  s_waitcnt lgkmcnt(4)
  v_mfma_f32_32x32x16_bf16 v[68:83], v[36:39], v[176:179], v[68:83]
  ds_read_b64_tr_b16 v[32:33], v12 offset:40960
  ds_read_b64_tr_b16 v[34:35], v12 offset:41472
  v_mul_f32 v92, v56, v56
  v_fma_f32 v92, v92, v19, v18
  v_mul_f32 v92, v92, v56
  v_exp_f32 v92, v92
  s_waitcnt lgkmcnt(4)
  v_mfma_f32_32x32x16_bf16 v[68:83], v[40:43], v[180:183], v[68:83]
  ds_read_b64_tr_b16 v[36:37], v13 offset:40960
  ds_read_b64_tr_b16 v[38:39], v13 offset:41472
  v_add_f32 v92, 1.0, v92
  v_rcp_f32 v92, v92
  s_add_u32 m0, s36, 0
  v_mul_f32 v92, v92, v56
  s_waitcnt lgkmcnt(4)
  v_mfma_f32_32x32x16_bf16 v[68:83], v[44:47], v[184:187], v[68:83]
  ds_read_b64_tr_b16 v[40:41], v14 offset:40960
  ds_read_b64_tr_b16 v[42:43], v14 offset:41472
  v_mul_f32 v93, v57, v57
  v_fma_f32 v93, v93, v19, v18
  v_mul_f32 v93, v93, v57
  v_exp_f32 v93, v93
  buffer_load_dwordx4 v6, s[12:15], s72 offen offset:0 lds
  s_waitcnt lgkmcnt(4)
  v_mfma_f32_16x16x32_bf16 v[24:27], v[252:255], v[32:35], v[24:27]
  v_mfma_f32_32x32x16_bf16 v[68:83], v[32:35], v[188:191], v[68:83]
  ds_read_b64_tr_b16 v[44:45], v15 offset:40960
  ds_read_b64_tr_b16 v[46:47], v15 offset:41472
  v_add_f32 v93, 1.0, v93
  v_rcp_f32 v93, v93
  v_cvt_pk_bf16_f32 v101, v94, v95
  v_mul_f32 v93, v93, v57
  s_waitcnt lgkmcnt(4)
  v_mfma_f32_32x32x16_bf16 v[68:83], v[36:39], v[192:195], v[68:83]
  ds_read_b64_tr_b16 v[32:33], v12 offset:49152
  ds_read_b64_tr_b16 v[34:35], v12 offset:49664
  v_mul_f32 v94, v58, v58
  v_fma_f32 v94, v94, v19, v18
  v_mul_f32 v94, v94, v58
  v_exp_f32 v94, v94
  s_waitcnt lgkmcnt(4)
  v_mfma_f32_32x32x16_bf16 v[68:83], v[40:43], v[196:199], v[68:83]
  ds_read_b64_tr_b16 v[36:37], v13 offset:49152
  ds_read_b64_tr_b16 v[38:39], v13 offset:49664
  v_add_f32 v94, 1.0, v94
  v_rcp_f32 v94, v94
  s_add_u32 m0, s36, 8192
  v_mul_f32 v94, v94, v58
  s_waitcnt lgkmcnt(4)
  v_mfma_f32_32x32x16_bf16 v[68:83], v[44:47], v[200:203], v[68:83]
  ds_read_b64_tr_b16 v[40:41], v14 offset:49152
  ds_read_b64_tr_b16 v[42:43], v14 offset:49664
  v_mul_f32 v95, v59, v59
  v_fma_f32 v95, v95, v19, v18
  v_mul_f32 v95, v95, v59
  v_exp_f32 v95, v95
  buffer_load_dwordx4 v6, s[12:15], s73 offen offset:0 lds
  s_waitcnt lgkmcnt(4)
  v_mfma_f32_16x16x32_bf16 v[24:27], v[252:255], v[32:35], v[24:27]
  v_mfma_f32_32x32x16_bf16 v[68:83], v[32:35], v[204:207], v[68:83]
  ds_read_b64_tr_b16 v[44:45], v15 offset:49152
  ds_read_b64_tr_b16 v[46:47], v15 offset:49664
  v_add_f32 v95, 1.0, v95
  v_rcp_f32 v95, v95
  v_cvt_pk_bf16_f32 v102, v92, v93
  v_mul_f32 v95, v95, v59
  s_waitcnt vmcnt(9)
  s_barrier
  s_waitcnt lgkmcnt(4)
  v_mfma_f32_32x32x16_bf16 v[68:83], v[36:39], v[208:211], v[68:83]
  ds_read_b64_tr_b16 v[32:33], v12 offset:57344
  ds_read_b64_tr_b16 v[34:35], v12 offset:57856
  v_mul_f32 v92, v60, v60
  v_fma_f32 v92, v92, v19, v18
  v_mul_f32 v92, v92, v60
  v_exp_f32 v92, v92
  s_lshl1_add_u32 s100, s4, s5
  s_lshl_b32 s100, s100, 12
  s_add_u32 s100, s100, 65536
  v_lshl_add_u32 v4, v0, 4, s100
  s_mul_i32 s100, s3, 12288
  v_lshl_add_u32 v5, v0, 4, s100
  s_waitcnt lgkmcnt(4)
  v_mfma_f32_32x32x16_bf16 v[68:83], v[40:43], v[212:215], v[68:83]
  ds_read_b64_tr_b16 v[36:37], v13 offset:57344
  ds_read_b64_tr_b16 v[38:39], v13 offset:57856
  v_add_f32 v92, 1.0, v92
  v_rcp_f32 v92, v92
  v_mov_b32 v8, v16
  v_mul_f32 v92, v92, v60
  s_add_u32 m0, s36, 16384
  s_waitcnt lgkmcnt(4)
  v_mfma_f32_32x32x16_bf16 v[68:83], v[44:47], v[216:219], v[68:83]
  ds_read_b64_tr_b16 v[40:41], v14 offset:57344
  ds_read_b64_tr_b16 v[42:43], v14 offset:57856
  v_mul_f32 v93, v61, v61
  v_fma_f32 v93, v93, v19, v18
  v_mul_f32 v93, v93, v61
  v_exp_f32 v93, v93
  buffer_load_dwordx4 v6, s[12:15], s39 offen offset:0 lds
  s_waitcnt lgkmcnt(4)
  v_mfma_f32_16x16x32_bf16 v[24:27], v[252:255], v[32:35], v[24:27]
  v_mfma_f32_32x32x16_bf16 v[68:83], v[32:35], v[220:223], v[68:83]
  ds_read_b64_tr_b16 v[44:45], v15 offset:57344
  ds_read_b64_tr_b16 v[46:47], v15 offset:57856
  v_add_f32 v93, 1.0, v93
  v_rcp_f32 v93, v93
  v_cvt_pk_bf16_f32 v103, v94, v95
  v_mul_f32 v93, v93, v61
  buffer_load_dword v9, v17, s[16:19], 0 offen offset:1152
  s_waitcnt lgkmcnt(4)
  v_mfma_f32_32x32x16_bf16 v[68:83], v[36:39], v[224:227], v[68:83]
  ds_read_b64_tr_b16 v[32:33], v96 offset:16384
  ds_read_b64_tr_b16 v[34:35], v96 offset:16896
  v_mul_f32 v94, v62, v62
  v_fma_f32 v94, v94, v19, v18
  v_mul_f32 v94, v94, v62
  v_exp_f32 v94, v94
  s_waitcnt lgkmcnt(4)
  v_mfma_f32_32x32x16_bf16 v[68:83], v[40:43], v[228:231], v[68:83]
  ds_read_b64_tr_b16 v[36:37], v97 offset:16384
  ds_read_b64_tr_b16 v[38:39], v97 offset:16896
  v_add_f32 v94, 1.0, v94
  v_rcp_f32 v94, v94
  v_cvt_pk_bf16_f32 v104, v92, v93
  v_mul_f32 v94, v94, v62
  s_waitcnt lgkmcnt(4)
  v_mfma_f32_32x32x16_bf16 v[68:83], v[44:47], v[232:235], v[68:83]
  ds_read_b64_tr_b16 v[40:41], v98 offset:16384
  ds_read_b64_tr_b16 v[42:43], v98 offset:16896
  v_mul_f32 v95, v63, v63
  v_fma_f32 v95, v95, v19, v18
  v_mul_f32 v95, v95, v63
  v_exp_f32 v95, v95
  s_waitcnt lgkmcnt(4)
  v_mfma_f32_16x16x32_bf16 v[24:27], v[252:255], v[32:35], v[24:27]
  v_mfma_f32_32x32x16_bf16 v[68:83], v[32:35], v[236:239], v[68:83]
  ds_read_b64_tr_b16 v[44:45], v99 offset:16384
  ds_read_b64_tr_b16 v[46:47], v99 offset:16896
  v_add_f32 v95, 1.0, v95
  v_rcp_f32 v95, v95
  s_add_u32 m0, s36, 24448
  v_mul_f32 v95, v95, v63
  s_waitcnt lgkmcnt(4)
  v_mfma_f32_32x32x16_bf16 v[68:83], v[36:39], v[240:243], v[68:83]
  ds_read_b64_tr_b16 v[32:33], v96 offset:24576
  ds_read_b64_tr_b16 v[34:35], v96 offset:25088
  v_mul_f32 v92, v64, v64
  v_fma_f32 v92, v92, v19, v18
  v_mul_f32 v92, v92, v64
  v_exp_f32 v92, v92
  ds_write_b32 v30, v24
  buffer_load_dwordx4 v6, s[12:15], s86 offen offset:128 lds
  s_waitcnt lgkmcnt(5)
  v_mfma_f32_32x32x16_bf16 v[68:83], v[40:43], v[244:247], v[68:83]
  ds_read_b64_tr_b16 v[36:37], v97 offset:24576
  ds_read_b64_tr_b16 v[38:39], v97 offset:25088
  v_add_f32 v92, 1.0, v92
  v_rcp_f32 v92, v92
  s_add_u32 m0, s36, 32640
  v_mul_f32 v92, v92, v64
  s_waitcnt lgkmcnt(2)
  s_waitcnt vmcnt(8)
  s_barrier
  ds_read_b64 v[10:11], v28
  v_mfma_f32_32x32x16_bf16 v[68:83], v[44:47], v[248:251], v[68:83]
  ds_read_b64_tr_b16 v[40:41], v98 offset:24576
  ds_read_b64_tr_b16 v[42:43], v98 offset:25088
  v_mul_f32 v93, v65, v65
  v_fma_f32 v93, v93, v19, v18
  v_mul_f32 v93, v93, v65
  v_exp_f32 v93, v93
  buffer_load_dwordx4 v6, s[12:15], s88 offen offset:128 lds
  v_add_f32 v93, 1.0, v93
  v_rcp_f32 v93, v93
  v_cvt_pk_bf16_f32 v105, v94, v95
  v_mul_f32 v93, v93, v65
  v_mul_f32 v94, v66, v66
  v_fma_f32 v94, v94, v19, v18
  v_mul_f32 v94, v94, v66
  v_exp_f32 v94, v94
  s_nop 0
  v_add_f32 v94, 1.0, v94
  v_rcp_f32 v94, v94
  v_cvt_pk_bf16_f32 v106, v92, v93
  v_mul_f32 v94, v94, v66
  v_mul_f32 v95, v67, v67
  v_fma_f32 v95, v95, v19, v18
  v_mul_f32 v95, v95, v67
  v_exp_f32 v95, v95
  s_nop 0
  v_add_f32 v95, 1.0, v95
  v_rcp_f32 v95, v95
  s_nop 0
  v_mul_f32 v95, v95, v67
  v_mfma_f32_16x16x32_bf16 v[24:27], v[252:255], v[32:35], 0
  v_mfma_f32_32x32x16_bf16 v[52:67], v[32:35], v[108:111], 0
  ds_read_b64_tr_b16 v[44:45], v99 offset:24576
  ds_read_b64_tr_b16 v[46:47], v99 offset:25088
  s_waitcnt lgkmcnt(4)
  v_add_f32 v10, v10, v11
  v_cvt_pk_bf16_f32 v11, v10, v10
  v_lshlrev_b32 v11, 16, v11
  v_sub_f32 v10, v10, v11
  v_cvt_pk_bf16_f32 v22, v11, v10
  s_nop 1
  v_mfma_f32_32x32x8_bf16 v[68:83], v[22:23], v[20:21], v[68:83]
  v_mfma_f32_32x32x16_bf16 v[52:67], v[36:39], v[112:115], v[52:67]
  ds_read_b64_tr_b16 v[32:33], v96 offset:32768
  ds_read_b64_tr_b16 v[34:35], v96 offset:33280
  v_cvt_pk_bf16_f32 v107, v94, v95
  v_permlane16_swap_b32 v100, v104
  v_permlane16_swap_b32 v101, v105
  s_add_u32 s92, s92, s74
  s_waitcnt lgkmcnt(4)
  v_mfma_f32_32x32x16_bf16 v[52:67], v[40:43], v[116:119], v[52:67]
  ds_read_b64_tr_b16 v[36:37], v97 offset:32768
  ds_read_b64_tr_b16 v[38:39], v97 offset:33280
  v_permlane16_swap_b32 v102, v106
  v_permlane16_swap_b32 v103, v107
  buffer_load_ushort v23, v31, s[20:23], s92 offen offset:0
  s_add_u32 m0, s36, 40832
  s_waitcnt lgkmcnt(4)
  v_mfma_f32_32x32x16_bf16 v[52:67], v[44:47], v[120:123], v[52:67]
  ds_read_b64_tr_b16 v[40:41], v98 offset:32768
  ds_read_b64_tr_b16 v[42:43], v98 offset:33280
  v_mul_f32 v92, v68, v68
  v_fma_f32 v92, v92, v19, v18
  v_mul_f32 v92, v92, v68
  v_exp_f32 v92, v92
  buffer_load_dwordx4 v6, s[12:15], s91 offen offset:128 lds
  s_waitcnt lgkmcnt(4)
  v_mfma_f32_16x16x32_bf16 v[24:27], v[252:255], v[32:35], v[24:27]
  v_mfma_f32_32x32x16_bf16 v[52:67], v[32:35], v[124:127], v[52:67]
  ds_read_b64_tr_b16 v[44:45], v99 offset:32768
  ds_read_b64_tr_b16 v[46:47], v99 offset:33280
  v_add_f32 v92, 1.0, v92
  v_rcp_f32 v92, v92
  s_nop 0
  v_mul_f32 v92, v92, v68
  buffer_load_dword v9, v17, s[16:19], 0 offen offset:2304
  s_waitcnt lgkmcnt(4)
  v_mfma_f32_32x32x16_bf16 v[52:67], v[36:39], v[128:131], v[52:67]
  ds_read_b64_tr_b16 v[32:33], v96 offset:40960
  ds_read_b64_tr_b16 v[34:35], v96 offset:41472
  v_mul_f32 v93, v69, v69
  v_fma_f32 v93, v93, v19, v18
  v_mul_f32 v93, v93, v69
  v_exp_f32 v93, v93
  s_waitcnt lgkmcnt(4)
  v_mfma_f32_32x32x16_bf16 v[52:67], v[40:43], v[132:135], v[52:67]
  ds_read_b64_tr_b16 v[36:37], v97 offset:40960
  ds_read_b64_tr_b16 v[38:39], v97 offset:41472
  v_add_f32 v93, 1.0, v93
  v_rcp_f32 v93, v93
  s_add_u32 m0, s36, 49024
  v_mul_f32 v93, v93, v69
  s_waitcnt lgkmcnt(4)
  v_mfma_f32_32x32x16_bf16 v[52:67], v[44:47], v[136:139], v[52:67]
  ds_read_b64_tr_b16 v[40:41], v98 offset:40960
  ds_read_b64_tr_b16 v[42:43], v98 offset:41472
  v_mul_f32 v94, v70, v70
  v_fma_f32 v94, v94, v19, v18
  v_mul_f32 v94, v94, v70
  v_exp_f32 v94, v94
  buffer_load_dwordx4 v6, s[12:15], s2 offen offset:128 lds
  s_waitcnt lgkmcnt(4)
  v_mfma_f32_16x16x32_bf16 v[24:27], v[252:255], v[32:35], v[24:27]
  v_mfma_f32_32x32x16_bf16 v[52:67], v[32:35], v[140:143], v[52:67]
  ds_read_b64_tr_b16 v[44:45], v99 offset:40960
  ds_read_b64_tr_b16 v[46:47], v99 offset:41472
  v_add_f32 v94, 1.0, v94
  v_rcp_f32 v94, v94
  v_cvt_pk_bf16_f32 v84, v92, v93
  v_mul_f32 v94, v94, v70
  s_waitcnt lgkmcnt(4)
  v_mfma_f32_32x32x16_bf16 v[52:67], v[36:39], v[144:147], v[52:67]
  ds_read_b64_tr_b16 v[32:33], v96 offset:49152
  ds_read_b64_tr_b16 v[34:35], v96 offset:49664
  v_mul_f32 v95, v71, v71
  v_fma_f32 v95, v95, v19, v18
  v_mul_f32 v95, v95, v71
  v_exp_f32 v95, v95
  s_waitcnt lgkmcnt(4)
  v_mfma_f32_32x32x16_bf16 v[52:67], v[40:43], v[148:151], v[52:67]
  ds_read_b64_tr_b16 v[36:37], v97 offset:49152
  ds_read_b64_tr_b16 v[38:39], v97 offset:49664
  v_add_f32 v95, 1.0, v95
  v_rcp_f32 v95, v95
  s_add_u32 m0, s36, 57216
  v_mul_f32 v95, v95, v71
  s_waitcnt lgkmcnt(4)
  v_mfma_f32_32x32x16_bf16 v[52:67], v[44:47], v[152:155], v[52:67]
  ds_read_b64_tr_b16 v[40:41], v98 offset:49152
  ds_read_b64_tr_b16 v[42:43], v98 offset:49664
  v_mul_f32 v92, v72, v72
  v_fma_f32 v92, v92, v19, v18
  v_mul_f32 v92, v92, v72
  v_exp_f32 v92, v92
  buffer_load_dwordx4 v6, s[12:15], s78 offen offset:128 lds
  s_waitcnt lgkmcnt(4)
  v_mfma_f32_16x16x32_bf16 v[24:27], v[252:255], v[32:35], v[24:27]
  v_mfma_f32_32x32x16_bf16 v[52:67], v[32:35], v[156:159], v[52:67]
  ds_read_b64_tr_b16 v[44:45], v99 offset:49152
  ds_read_b64_tr_b16 v[46:47], v99 offset:49664
  v_add_f32 v92, 1.0, v92
  v_rcp_f32 v92, v92
  v_cvt_pk_bf16_f32 v85, v94, v95
  v_mul_f32 v92, v92, v72
  s_waitcnt vmcnt(10)
  s_barrier
  s_waitcnt lgkmcnt(4)
  v_mfma_f32_32x32x16_bf16 v[52:67], v[36:39], v[160:163], v[52:67]
  ds_read_b64_tr_b16 v[32:33], v96 offset:57344
  ds_read_b64_tr_b16 v[34:35], v96 offset:57856
  v_mul_f32 v93, v73, v73
  v_fma_f32 v93, v93, v19, v18
  v_mul_f32 v93, v93, v73
  v_exp_f32 v93, v93
  s_waitcnt lgkmcnt(4)
  v_mfma_f32_32x32x16_bf16 v[52:67], v[40:43], v[164:167], v[52:67]
  ds_read_b64_tr_b16 v[36:37], v97 offset:57344
  ds_read_b64_tr_b16 v[38:39], v97 offset:57856
  v_add_f32 v93, 1.0, v93
  v_rcp_f32 v93, v93
  s_add_u32 m0, s36, 106368
  v_mul_f32 v93, v93, v73
  s_waitcnt lgkmcnt(4)
  v_mfma_f32_32x32x16_bf16 v[52:67], v[44:47], v[168:171], v[52:67]
  ds_read_b64_tr_b16 v[40:41], v98 offset:57344
  ds_read_b64_tr_b16 v[42:43], v98 offset:57856
  v_mul_f32 v94, v74, v74
  v_fma_f32 v94, v94, v19, v18
  v_mul_f32 v94, v94, v74
  v_exp_f32 v94, v94
  buffer_load_dwordx4 v6, s[12:15], s79 offen offset:128 lds
  s_waitcnt lgkmcnt(4)
  v_mfma_f32_16x16x32_bf16 v[24:27], v[252:255], v[32:35], v[24:27]
  v_mfma_f32_32x32x16_bf16 v[52:67], v[32:35], v[172:175], v[52:67]
  ds_read_b64_tr_b16 v[44:45], v99 offset:57344
  ds_read_b64_tr_b16 v[46:47], v99 offset:57856
  v_add_f32 v94, 1.0, v94
  v_rcp_f32 v94, v94
  v_cvt_pk_bf16_f32 v86, v92, v93
  v_mul_f32 v94, v94, v74
  s_waitcnt lgkmcnt(4)
  v_mfma_f32_32x32x16_bf16 v[52:67], v[36:39], v[176:179], v[52:67]
  ds_read_b64_tr_b16 v[32:33], v96 offset:8192
  ds_read_b64_tr_b16 v[34:35], v96 offset:8704
  v_mul_f32 v95, v75, v75
  v_fma_f32 v95, v95, v19, v18
  v_mul_f32 v95, v95, v75
  v_exp_f32 v95, v95
  s_waitcnt lgkmcnt(4)
  v_mfma_f32_32x32x16_bf16 v[52:67], v[40:43], v[180:183], v[52:67]
  ds_read_b64_tr_b16 v[36:37], v97 offset:8192
  ds_read_b64_tr_b16 v[38:39], v97 offset:8704
  v_add_f32 v95, 1.0, v95
  v_rcp_f32 v95, v95
  s_add_u32 m0, s36, 114560
  v_mul_f32 v95, v95, v75
  s_waitcnt lgkmcnt(4)
  v_mfma_f32_32x32x16_bf16 v[52:67], v[44:47], v[184:187], v[52:67]
  ds_read_b64_tr_b16 v[40:41], v98 offset:8192
  ds_read_b64_tr_b16 v[42:43], v98 offset:8704
  v_mul_f32 v92, v76, v76
  v_fma_f32 v92, v92, v19, v18
  v_mul_f32 v92, v92, v76
  v_exp_f32 v92, v92
  buffer_load_dwordx4 v6, s[12:15], s72 offen offset:128 lds
  s_waitcnt lgkmcnt(4)
  v_mfma_f32_16x16x32_bf16 v[24:27], v[252:255], v[32:35], v[24:27]
  v_mfma_f32_32x32x16_bf16 v[52:67], v[32:35], v[188:191], v[52:67]
  ds_read_b64_tr_b16 v[44:45], v99 offset:8192
  ds_read_b64_tr_b16 v[46:47], v99 offset:8704
  v_add_f32 v92, 1.0, v92
  v_rcp_f32 v92, v92
  v_cvt_pk_bf16_f32 v87, v94, v95
  v_mul_f32 v92, v92, v76
  s_waitcnt lgkmcnt(4)
  v_mfma_f32_32x32x16_bf16 v[52:67], v[36:39], v[192:195], v[52:67]
  ds_read_b64_tr_b16 v[32:33], v12 offset:0
  ds_read_b64_tr_b16 v[34:35], v12 offset:512
  v_mul_f32 v93, v77, v77
  v_fma_f32 v93, v93, v19, v18
  v_mul_f32 v93, v93, v77
  v_exp_f32 v93, v93
  s_waitcnt lgkmcnt(4)
  v_mfma_f32_32x32x16_bf16 v[52:67], v[40:43], v[196:199], v[52:67]
  ds_read_b64_tr_b16 v[36:37], v13 offset:0
  ds_read_b64_tr_b16 v[38:39], v13 offset:512
  v_add_f32 v93, 1.0, v93
  v_rcp_f32 v93, v93
  s_add_u32 m0, s36, 122752
  v_mul_f32 v93, v93, v77
  s_waitcnt lgkmcnt(4)
  v_mfma_f32_32x32x16_bf16 v[52:67], v[44:47], v[200:203], v[52:67]
  ds_read_b64_tr_b16 v[40:41], v14 offset:0
  ds_read_b64_tr_b16 v[42:43], v14 offset:512
  v_mul_f32 v94, v78, v78
  v_fma_f32 v94, v94, v19, v18
  v_mul_f32 v94, v94, v78
  v_exp_f32 v94, v94
  buffer_load_dwordx4 v6, s[12:15], s73 offen offset:128 lds
  s_waitcnt lgkmcnt(4)
  v_mfma_f32_16x16x32_bf16 v[24:27], v[252:255], v[32:35], v[24:27]
  v_mfma_f32_32x32x16_bf16 v[52:67], v[32:35], v[204:207], v[52:67]
  ds_read_b64_tr_b16 v[44:45], v15 offset:0
  ds_read_b64_tr_b16 v[46:47], v15 offset:512
  v_add_f32 v94, 1.0, v94
  v_rcp_f32 v94, v94
  v_cvt_pk_bf16_f32 v88, v92, v93
  v_mul_f32 v94, v94, v78
  s_waitcnt vmcnt(9)
  s_barrier
  s_waitcnt lgkmcnt(4)
  v_mfma_f32_32x32x16_bf16 v[52:67], v[36:39], v[208:211], v[52:67]
  ds_read_b64_tr_b16 v[32:33], v12 offset:8192
  ds_read_b64_tr_b16 v[34:35], v12 offset:8704
  v_mul_f32 v95, v79, v79
  v_fma_f32 v95, v95, v19, v18
  v_mul_f32 v95, v95, v79
  v_exp_f32 v95, v95
  s_waitcnt lgkmcnt(4)
  v_mfma_f32_32x32x16_bf16 v[52:67], v[40:43], v[212:215], v[52:67]
  ds_read_b64_tr_b16 v[36:37], v13 offset:8192
  ds_read_b64_tr_b16 v[38:39], v13 offset:8704
  v_add_f32 v95, 1.0, v95
  v_rcp_f32 v95, v95
  s_add_u32 m0, s36, 130944
  v_mul_f32 v95, v95, v79
  s_waitcnt lgkmcnt(4)
  v_mfma_f32_32x32x16_bf16 v[52:67], v[44:47], v[216:219], v[52:67]
  ds_read_b64_tr_b16 v[40:41], v14 offset:8192
  ds_read_b64_tr_b16 v[42:43], v14 offset:8704
  v_mul_f32 v92, v80, v80
  v_fma_f32 v92, v92, v19, v18
  v_mul_f32 v92, v92, v80
  v_exp_f32 v92, v92
  buffer_load_dwordx4 v6, s[12:15], s39 offen offset:128 lds
  s_waitcnt lgkmcnt(4)
  v_mfma_f32_16x16x32_bf16 v[24:27], v[252:255], v[32:35], v[24:27]
  v_mfma_f32_32x32x16_bf16 v[52:67], v[32:35], v[220:223], v[52:67]
  ds_read_b64_tr_b16 v[44:45], v15 offset:8192
  ds_read_b64_tr_b16 v[46:47], v15 offset:8704
  v_add_f32 v92, 1.0, v92
  v_rcp_f32 v92, v92
  v_cvt_pk_bf16_f32 v89, v94, v95
  v_mul_f32 v92, v92, v80
  s_waitcnt lgkmcnt(4)
  v_mfma_f32_32x32x16_bf16 v[52:67], v[36:39], v[224:227], v[52:67]
  ds_read_b64_tr_b16 v[32:33], v12 offset:16384
  ds_read_b64_tr_b16 v[34:35], v12 offset:16896
  v_mul_f32 v93, v81, v81
  v_fma_f32 v93, v93, v19, v18
  v_mul_f32 v93, v93, v81
  v_exp_f32 v93, v93
  s_waitcnt lgkmcnt(4)
  v_mfma_f32_32x32x16_bf16 v[52:67], v[40:43], v[228:231], v[52:67]
  ds_read_b64_tr_b16 v[36:37], v13 offset:16384
  ds_read_b64_tr_b16 v[38:39], v13 offset:16896
  v_add_f32 v93, 1.0, v93
  v_rcp_f32 v93, v93
  s_nop 0
  v_mul_f32 v93, v93, v81
  s_waitcnt lgkmcnt(4)
  v_mfma_f32_32x32x16_bf16 v[52:67], v[44:47], v[232:235], v[52:67]
  ds_read_b64_tr_b16 v[40:41], v14 offset:16384
  ds_read_b64_tr_b16 v[42:43], v14 offset:16896
  v_mul_f32 v94, v82, v82
  v_fma_f32 v94, v94, v19, v18
  v_mul_f32 v94, v94, v82
  v_exp_f32 v94, v94
  s_waitcnt lgkmcnt(4)
  v_mfma_f32_16x16x32_bf16 v[24:27], v[252:255], v[32:35], v[24:27]
  v_mfma_f32_32x32x16_bf16 v[52:67], v[32:35], v[236:239], v[52:67]
  ds_read_b64_tr_b16 v[44:45], v15 offset:16384
  ds_read_b64_tr_b16 v[46:47], v15 offset:16896
  v_add_f32 v94, 1.0, v94
  v_rcp_f32 v94, v94
  v_cvt_pk_bf16_f32 v90, v92, v93
  v_mul_f32 v94, v94, v82
  s_add_u32 m0, s36, 139264
  s_waitcnt lgkmcnt(4)
  v_mfma_f32_32x32x16_bf16 v[52:67], v[36:39], v[240:243], v[52:67]
  ds_read_b64_tr_b16 v[32:33], v12 offset:24576
  ds_read_b64_tr_b16 v[34:35], v12 offset:25088
  v_mul_f32 v95, v83, v83
  v_fma_f32 v95, v95, v19, v18
  v_mul_f32 v95, v95, v83
  v_exp_f32 v95, v95
  ds_write_b32 v30, v24
  v_add_u32 v6, s93, v6
  buffer_load_dwordx4 v6, s[12:15], s86 offen offset:0 lds
  s_waitcnt lgkmcnt(5)
  v_mfma_f32_32x32x16_bf16 v[52:67], v[40:43], v[244:247], v[52:67]
  ds_read_b64_tr_b16 v[36:37], v13 offset:24576
  ds_read_b64_tr_b16 v[38:39], v13 offset:25088
  v_add_f32 v95, 1.0, v95
  v_rcp_f32 v95, v95
  s_add_u32 m0, s36, 147456
  v_mul_f32 v95, v95, v83
  s_waitcnt lgkmcnt(2)
  s_waitcnt vmcnt(6)
  s_barrier
  ds_read_b64 v[10:11], v28
  v_mfma_f32_32x32x16_bf16 v[52:67], v[44:47], v[248:251], v[52:67]
  ds_read_b64_tr_b16 v[40:41], v14 offset:24576
  ds_read_b64_tr_b16 v[42:43], v14 offset:25088
  buffer_load_dwordx4 v6, s[12:15], s88 offen offset:0 lds
  v_mfma_f32_16x16x32_bf16 v[24:27], v[252:255], v[32:35], 0
  v_mfma_f32_32x32x16_bf16 v[68:83], v[32:35], v[108:111], 0
  ds_read_b64_tr_b16 v[44:45], v15 offset:24576
  ds_read_b64_tr_b16 v[46:47], v15 offset:25088
  s_waitcnt lgkmcnt(4)
  v_add_f32 v10, v10, v11
  v_cvt_pk_bf16_f32 v11, v10, v10
  v_lshlrev_b32 v11, 16, v11
  v_sub_f32 v10, v10, v11
  v_cvt_pk_bf16_f32 v22, v11, v10
  s_nop 1
  v_mfma_f32_32x32x8_bf16 v[52:67], v[22:23], v[20:21], v[52:67]
  v_mfma_f32_32x32x16_bf16 v[68:83], v[36:39], v[112:115], v[68:83]
  ds_read_b64_tr_b16 v[32:33], v12 offset:32768
  ds_read_b64_tr_b16 v[34:35], v12 offset:33280
  v_cvt_pk_bf16_f32 v91, v94, v95
  v_permlane16_swap_b32 v84, v88
  v_permlane16_swap_b32 v85, v89
  buffer_load_ushort v23, v31, s[20:23], s92 offen offset:128
  s_nop 1
  s_set_gpr_idx_on s82, gpr_idx(SRC0)
  s_nop 0
  v_mov_b32 v16, v108
  v_mov_b32 v17, v109
  v_mov_b32 v9, v110
  v_mov_b32 v29, v111
  s_set_gpr_idx_off
  s_waitcnt lgkmcnt(4)
  v_mfma_f32_32x32x16_bf16 v[68:83], v[40:43], v[116:119], v[68:83]
  ds_read_b64_tr_b16 v[36:37], v13 offset:32768
  ds_read_b64_tr_b16 v[38:39], v13 offset:33280
  v_permlane16_swap_b32 v86, v90
  v_permlane16_swap_b32 v87, v91
  s_waitcnt lgkmcnt(4)
  v_mfma_f32_32x32x16_bf16 v[68:83], v[44:47], v[120:123], v[68:83]
  ds_read_b64_tr_b16 v[40:41], v14 offset:32768
  ds_read_b64_tr_b16 v[42:43], v14 offset:33280
  v_mul_f32 v92, v52, v52
  v_fma_f32 v92, v92, v19, v18
  v_mul_f32 v92, v92, v52
  v_exp_f32 v92, v92
  s_waitcnt lgkmcnt(4)
  v_mfma_f32_16x16x32_bf16 v[24:27], v[252:255], v[32:35], v[24:27]
  v_mfma_f32_32x32x16_bf16 v[68:83], v[32:35], v[124:127], v[68:83]
  ds_read_b64_tr_b16 v[44:45], v15 offset:32768
  ds_read_b64_tr_b16 v[46:47], v15 offset:33280
  v_add_f32 v92, 1.0, v92
  v_rcp_f32 v92, v92
  s_nop 0
  v_mul_f32 v92, v92, v52
  ds_write_b128 v4, v[84:87] offset:0
  s_waitcnt lgkmcnt(5)
  v_mfma_f32_32x32x16_bf16 v[68:83], v[36:39], v[128:131], v[68:83]
  ds_read_b64_tr_b16 v[32:33], v12 offset:40960
  ds_read_b64_tr_b16 v[34:35], v12 offset:41472
  v_mul_f32 v93, v53, v53
  v_fma_f32 v93, v93, v19, v18
  v_mul_f32 v93, v93, v53
  v_exp_f32 v93, v93
  v_permlane16_swap_b32 v16, v9
  s_waitcnt lgkmcnt(5)
  v_mfma_f32_32x32x16_bf16 v[68:83], v[40:43], v[132:135], v[68:83]
  ds_read_b64_tr_b16 v[36:37], v13 offset:40960
  ds_read_b64_tr_b16 v[38:39], v13 offset:41472
  v_add_f32 v93, 1.0, v93
  v_rcp_f32 v93, v93
  s_add_u32 m0, s36, 98304
  v_mul_f32 v93, v93, v53
  ds_write_b128 v4, v[88:91] offset:1024
  s_waitcnt lgkmcnt(6)
  v_mfma_f32_32x32x16_bf16 v[68:83], v[44:47], v[136:139], v[68:83]
  ds_read_b64_tr_b16 v[40:41], v14 offset:40960
  ds_read_b64_tr_b16 v[42:43], v14 offset:41472
  v_mul_f32 v94, v54, v54
  v_fma_f32 v94, v94, v19, v18
  v_mul_f32 v94, v94, v54
  v_exp_f32 v94, v94
  buffer_load_dwordx4 v6, s[12:15], s91 offen offset:0 lds
  s_waitcnt lgkmcnt(5)
  v_mfma_f32_16x16x32_bf16 v[24:27], v[252:255], v[32:35], v[24:27]
  v_mfma_f32_32x32x16_bf16 v[68:83], v[32:35], v[140:143], v[68:83]
  ds_read_b64_tr_b16 v[44:45], v15 offset:40960
  ds_read_b64_tr_b16 v[46:47], v15 offset:41472
  v_add_f32 v94, 1.0, v94
  v_rcp_f32 v94, v94
  v_cvt_pk_bf16_f32 v84, v92, v93
  v_mul_f32 v94, v94, v54
  s_add_u32 m0, s36, 0
  s_waitcnt lgkmcnt(5)
  v_mfma_f32_32x32x16_bf16 v[68:83], v[36:39], v[144:147], v[68:83]
  ds_read_b64_tr_b16 v[32:33], v12 offset:49152
  ds_read_b64_tr_b16 v[34:35], v12 offset:49664
  v_mul_f32 v95, v55, v55
  v_fma_f32 v95, v95, v19, v18
  v_mul_f32 v95, v95, v55
  v_exp_f32 v95, v95
  buffer_load_dwordx4 v6, s[12:15], s2 offen offset:0 lds
  s_waitcnt lgkmcnt(4)
  v_mfma_f32_32x32x16_bf16 v[68:83], v[40:43], v[148:151], v[68:83]
  ds_read_b64_tr_b16 v[36:37], v13 offset:49152
  ds_read_b64_tr_b16 v[38:39], v13 offset:49664
  v_add_f32 v95, 1.0, v95
  v_rcp_f32 v95, v95
  s_add_u32 m0, s36, 8192
  v_mul_f32 v95, v95, v55
  s_waitcnt lgkmcnt(4)
  v_mfma_f32_32x32x16_bf16 v[68:83], v[44:47], v[152:155], v[68:83]
  ds_read_b64_tr_b16 v[40:41], v14 offset:49152
  ds_read_b64_tr_b16 v[42:43], v14 offset:49664
  v_mul_f32 v92, v56, v56
  v_fma_f32 v92, v92, v19, v18
  v_mul_f32 v92, v92, v56
  v_exp_f32 v92, v92
  buffer_load_dwordx4 v6, s[12:15], s78 offen offset:0 lds
  s_waitcnt lgkmcnt(4)
  v_mfma_f32_16x16x32_bf16 v[24:27], v[252:255], v[32:35], v[24:27]
  v_mfma_f32_32x32x16_bf16 v[68:83], v[32:35], v[156:159], v[68:83]
  ds_read_b64_tr_b16 v[44:45], v15 offset:49152
  ds_read_b64_tr_b16 v[46:47], v15 offset:49664
  v_add_f32 v92, 1.0, v92
  v_rcp_f32 v92, v92
  v_cvt_pk_bf16_f32 v85, v94, v95
  v_mul_f32 v92, v92, v56
  s_waitcnt vmcnt(8)
  s_barrier
  s_waitcnt lgkmcnt(4)
  v_mfma_f32_32x32x16_bf16 v[68:83], v[36:39], v[160:163], v[68:83]
  ds_read_b64_tr_b16 v[32:33], v12 offset:57344
  ds_read_b64_tr_b16 v[34:35], v12 offset:57856
  v_mul_f32 v93, v57, v57
  v_fma_f32 v93, v93, v19, v18
  v_mul_f32 v93, v93, v57
  v_exp_f32 v93, v93
  v_permlane16_swap_b32 v17, v29
  s_waitcnt lgkmcnt(4)
  v_mfma_f32_32x32x16_bf16 v[68:83], v[40:43], v[164:167], v[68:83]
  ds_read_b64_tr_b16 v[36:37], v13 offset:57344
  ds_read_b64_tr_b16 v[38:39], v13 offset:57856
  v_add_f32 v93, 1.0, v93
  v_rcp_f32 v93, v93
  s_add_u32 m0, s36, 16384
  v_mul_f32 v93, v93, v57
  s_waitcnt lgkmcnt(4)
  v_mfma_f32_32x32x16_bf16 v[68:83], v[44:47], v[168:171], v[68:83]
  ds_read_b64_tr_b16 v[40:41], v14 offset:57344
  ds_read_b64_tr_b16 v[42:43], v14 offset:57856
  v_mul_f32 v94, v58, v58
  v_fma_f32 v94, v94, v19, v18
  v_mul_f32 v94, v94, v58
  v_exp_f32 v94, v94
  buffer_load_dwordx4 v6, s[12:15], s79 offen offset:0 lds
  s_waitcnt lgkmcnt(4)
  v_mfma_f32_16x16x32_bf16 v[24:27], v[252:255], v[32:35], v[24:27]
  v_mfma_f32_32x32x16_bf16 v[68:83], v[32:35], v[172:175], v[68:83]
  ds_read_b64_tr_b16 v[44:45], v15 offset:57344
  ds_read_b64_tr_b16 v[46:47], v15 offset:57856
  v_add_f32 v94, 1.0, v94
  v_rcp_f32 v94, v94
  v_cvt_pk_bf16_f32 v86, v92, v93
  v_mul_f32 v94, v94, v58
  s_waitcnt lgkmcnt(4)
  v_mfma_f32_32x32x16_bf16 v[68:83], v[36:39], v[176:179], v[68:83]
  ds_read_b64_tr_b16 v[32:33], v96 offset:16384
  ds_read_b64_tr_b16 v[34:35], v96 offset:16896
  v_mul_f32 v95, v59, v59
  v_fma_f32 v95, v95, v19, v18
  v_mul_f32 v95, v95, v59
  v_exp_f32 v95, v95
  s_xor_b32 s82, s82, 4
  s_nop 1
  s_set_gpr_idx_on s82, gpr_idx(SRC0)
  s_nop 0
  v_mov_b32 v48, v108
  v_mov_b32 v49, v109
  v_mov_b32 v9, v110
  v_mov_b32 v29, v111
  s_set_gpr_idx_off
  s_waitcnt lgkmcnt(4)
  v_mfma_f32_32x32x16_bf16 v[68:83], v[40:43], v[180:183], v[68:83]
  ds_read_b64_tr_b16 v[36:37], v97 offset:16384
  ds_read_b64_tr_b16 v[38:39], v97 offset:16896
  v_add_f32 v95, 1.0, v95
  v_rcp_f32 v95, v95
  s_add_u32 m0, s36, 24576
  v_mul_f32 v95, v95, v59
  s_waitcnt lgkmcnt(4)
  v_mfma_f32_32x32x16_bf16 v[68:83], v[44:47], v[184:187], v[68:83]
  ds_read_b64_tr_b16 v[40:41], v98 offset:16384
  ds_read_b64_tr_b16 v[42:43], v98 offset:16896
  v_mul_f32 v92, v60, v60
  v_fma_f32 v92, v92, v19, v18
  v_mul_f32 v92, v92, v60
  v_exp_f32 v92, v92
  buffer_load_dwordx4 v6, s[12:15], s72 offen offset:0 lds
  s_waitcnt lgkmcnt(4)
  v_mfma_f32_16x16x32_bf16 v[24:27], v[252:255], v[32:35], v[24:27]
  v_mfma_f32_32x32x16_bf16 v[68:83], v[32:35], v[188:191], v[68:83]
  ds_read_b64_tr_b16 v[44:45], v99 offset:16384
  ds_read_b64_tr_b16 v[46:47], v99 offset:16896
  v_add_f32 v92, 1.0, v92
  v_rcp_f32 v92, v92
  v_cvt_pk_bf16_f32 v87, v94, v95
  v_mul_f32 v92, v92, v60
  s_waitcnt lgkmcnt(4)
  v_mfma_f32_32x32x16_bf16 v[68:83], v[36:39], v[192:195], v[68:83]
  ds_read_b64_tr_b16 v[32:33], v96 offset:24576
  ds_read_b64_tr_b16 v[34:35], v96 offset:25088
  v_mul_f32 v93, v61, v61
  v_fma_f32 v93, v93, v19, v18
  v_mul_f32 v93, v93, v61
  v_exp_f32 v93, v93
  v_permlane16_swap_b32 v48, v9
  s_waitcnt lgkmcnt(4)
  v_mfma_f32_32x32x16_bf16 v[68:83], v[40:43], v[196:199], v[68:83]
  ds_read_b64_tr_b16 v[36:37], v97 offset:24576
  ds_read_b64_tr_b16 v[38:39], v97 offset:25088
  v_add_f32 v93, 1.0, v93
  v_rcp_f32 v93, v93
  s_add_u32 m0, s36, 32768
  v_mul_f32 v93, v93, v61
  s_waitcnt lgkmcnt(4)
  v_mfma_f32_32x32x16_bf16 v[68:83], v[44:47], v[200:203], v[68:83]
  ds_read_b64_tr_b16 v[40:41], v98 offset:24576
  ds_read_b64_tr_b16 v[42:43], v98 offset:25088
  v_mul_f32 v94, v62, v62
  v_fma_f32 v94, v94, v19, v18
  v_mul_f32 v94, v94, v62
  v_exp_f32 v94, v94
  buffer_load_dwordx4 v6, s[12:15], s73 offen offset:0 lds
  s_waitcnt lgkmcnt(4)
  v_mfma_f32_16x16x32_bf16 v[24:27], v[252:255], v[32:35], v[24:27]
  v_mfma_f32_32x32x16_bf16 v[68:83], v[32:35], v[204:207], v[68:83]
  ds_read_b64_tr_b16 v[44:45], v99 offset:24576
  ds_read_b64_tr_b16 v[46:47], v99 offset:25088
  v_add_f32 v94, 1.0, v94
  v_rcp_f32 v94, v94
  v_cvt_pk_bf16_f32 v88, v92, v93
  v_mul_f32 v94, v94, v62
  s_waitcnt vmcnt(8)
  s_barrier
  s_waitcnt lgkmcnt(4)
  v_mfma_f32_32x32x16_bf16 v[68:83], v[36:39], v[208:211], v[68:83]
  ds_read_b64_tr_b16 v[32:33], v96 offset:32768
  ds_read_b64_tr_b16 v[34:35], v96 offset:33280
  v_mul_f32 v95, v63, v63
  v_fma_f32 v95, v95, v19, v18
  v_mul_f32 v95, v95, v63
  v_exp_f32 v95, v95
  v_permlane16_swap_b32 v49, v29
  s_waitcnt lgkmcnt(4)
  v_mfma_f32_32x32x16_bf16 v[68:83], v[40:43], v[212:215], v[68:83]
  ds_read_b64_tr_b16 v[36:37], v97 offset:32768
  ds_read_b64_tr_b16 v[38:39], v97 offset:33280
  v_add_f32 v95, 1.0, v95
  v_rcp_f32 v95, v95
  s_add_u32 m0, s36, 40960
  v_mul_f32 v95, v95, v63
  s_waitcnt lgkmcnt(4)
  v_mfma_f32_32x32x16_bf16 v[68:83], v[44:47], v[216:219], v[68:83]
  ds_read_b64_tr_b16 v[40:41], v98 offset:32768
  ds_read_b64_tr_b16 v[42:43], v98 offset:33280
  v_mul_f32 v92, v64, v64
  v_fma_f32 v92, v92, v19, v18
  v_mul_f32 v92, v92, v64
  v_exp_f32 v92, v92
  buffer_load_dwordx4 v6, s[12:15], s39 offen offset:0 lds
  s_waitcnt lgkmcnt(4)
  v_mfma_f32_16x16x32_bf16 v[24:27], v[252:255], v[32:35], v[24:27]
  v_mfma_f32_32x32x16_bf16 v[68:83], v[32:35], v[220:223], v[68:83]
  ds_read_b64_tr_b16 v[44:45], v99 offset:32768
  ds_read_b64_tr_b16 v[46:47], v99 offset:33280
  v_add_f32 v92, 1.0, v92
  v_rcp_f32 v92, v92
  v_cvt_pk_bf16_f32 v89, v94, v95
  v_mul_f32 v92, v92, v64
  s_waitcnt lgkmcnt(4)
  v_mfma_f32_32x32x16_bf16 v[68:83], v[36:39], v[224:227], v[68:83]
  ds_read_b64_tr_b16 v[32:33], v96 offset:40960
  ds_read_b64_tr_b16 v[34:35], v96 offset:41472
  v_mul_f32 v93, v65, v65
  v_fma_f32 v93, v93, v19, v18
  v_mul_f32 v93, v93, v65
  v_exp_f32 v93, v93
  s_nop 1
  s_set_gpr_idx_on s83, gpr_idx(SRC0)
  s_nop 0
  v_mov_b32 v50, v108
  v_mov_b32 v51, v109
  v_mov_b32 v9, v110
  v_mov_b32 v29, v111
  s_set_gpr_idx_off
  s_waitcnt lgkmcnt(4)
  v_mfma_f32_32x32x16_bf16 v[68:83], v[40:43], v[228:231], v[68:83]
  ds_read_b64_tr_b16 v[36:37], v97 offset:40960
  ds_read_b64_tr_b16 v[38:39], v97 offset:41472
  v_add_f32 v93, 1.0, v93
  v_rcp_f32 v93, v93
  s_nop 0
  v_mul_f32 v93, v93, v65
  s_waitcnt lgkmcnt(4)
  v_mfma_f32_32x32x16_bf16 v[68:83], v[44:47], v[232:235], v[68:83]
  ds_read_b64_tr_b16 v[40:41], v98 offset:40960
  ds_read_b64_tr_b16 v[42:43], v98 offset:41472
  v_mul_f32 v94, v66, v66
  v_fma_f32 v94, v94, v19, v18
  v_mul_f32 v94, v94, v66
  v_exp_f32 v94, v94
  s_waitcnt lgkmcnt(4)
  v_mfma_f32_16x16x32_bf16 v[24:27], v[252:255], v[32:35], v[24:27]
  v_mfma_f32_32x32x16_bf16 v[68:83], v[32:35], v[236:239], v[68:83]
  ds_read_b64_tr_b16 v[44:45], v99 offset:40960
  ds_read_b64_tr_b16 v[46:47], v99 offset:41472
  v_add_f32 v94, 1.0, v94
  v_rcp_f32 v94, v94
  v_cvt_pk_bf16_f32 v90, v92, v93
  v_mul_f32 v94, v94, v66
  s_add_u32 m0, s36, 49024
  s_waitcnt lgkmcnt(4)
  v_mfma_f32_32x32x16_bf16 v[68:83], v[36:39], v[240:243], v[68:83]
  ds_read_b64_tr_b16 v[32:33], v96 offset:49152
  ds_read_b64_tr_b16 v[34:35], v96 offset:49664
  v_mul_f32 v95, v67, v67
  v_fma_f32 v95, v95, v19, v18
  v_mul_f32 v95, v95, v67
  v_exp_f32 v95, v95
  ds_write_b32 v30, v24
  buffer_load_dwordx4 v6, s[12:15], s86 offen offset:128 lds
  s_waitcnt lgkmcnt(5)
  v_mfma_f32_32x32x16_bf16 v[68:83], v[40:43], v[244:247], v[68:83]
  ds_read_b64_tr_b16 v[36:37], v97 offset:49152
  ds_read_b64_tr_b16 v[38:39], v97 offset:49664
  v_add_f32 v95, 1.0, v95
  v_rcp_f32 v95, v95
  s_add_u32 m0, s36, 57216
  v_mul_f32 v95, v95, v67
  s_waitcnt lgkmcnt(2)
  s_waitcnt vmcnt(6)
  s_barrier
  ds_read_b64 v[10:11], v28
  v_mfma_f32_32x32x16_bf16 v[68:83], v[44:47], v[248:251], v[68:83]
  ds_read_b64_tr_b16 v[40:41], v98 offset:49152
  ds_read_b64_tr_b16 v[42:43], v98 offset:49664
  v_permlane16_swap_b32 v50, v9
  v_permlane16_swap_b32 v51, v29
  buffer_load_dwordx4 v6, s[12:15], s88 offen offset:128 lds
  v_mfma_f32_16x16x32_bf16 v[24:27], v[252:255], v[32:35], 0
  v_mfma_f32_32x32x16_bf16 v[52:67], v[32:35], v[108:111], 0
  ds_read_b64_tr_b16 v[44:45], v99 offset:49152
  ds_read_b64_tr_b16 v[46:47], v99 offset:49664
  s_waitcnt lgkmcnt(4)
  v_add_f32 v10, v10, v11
  v_cvt_pk_bf16_f32 v11, v10, v10
  v_lshlrev_b32 v11, 16, v11
  v_sub_f32 v10, v10, v11
  v_cvt_pk_bf16_f32 v22, v11, v10
  s_nop 1
  v_mfma_f32_32x32x8_bf16 v[68:83], v[22:23], v[20:21], v[68:83]
  v_mfma_f32_32x32x16_bf16 v[52:67], v[36:39], v[112:115], v[52:67]
  ds_read_b64_tr_b16 v[32:33], v96 offset:57344
  ds_read_b64_tr_b16 v[34:35], v96 offset:57856
  v_cvt_pk_bf16_f32 v91, v94, v95
  v_permlane16_swap_b32 v84, v88
  v_permlane16_swap_b32 v85, v89
  s_add_u32 s92, s92, s93
  s_waitcnt lgkmcnt(4)
  v_mfma_f32_32x32x16_bf16 v[52:67], v[40:43], v[116:119], v[52:67]
  ds_read_b64_tr_b16 v[36:37], v97 offset:57344
  ds_read_b64_tr_b16 v[38:39], v97 offset:57856
  v_permlane16_swap_b32 v86, v90
  v_permlane16_swap_b32 v87, v91
  buffer_load_ushort v23, v31, s[20:23], s92 offen offset:0
  s_waitcnt lgkmcnt(4)
  v_mfma_f32_32x32x16_bf16 v[52:67], v[44:47], v[120:123], v[52:67]
  ds_read_b64_tr_b16 v[40:41], v98 offset:57344
  ds_read_b64_tr_b16 v[42:43], v98 offset:57856
  v_mul_f32 v92, v68, v68
  v_fma_f32 v92, v92, v19, v18
  v_mul_f32 v92, v92, v68
  v_exp_f32 v92, v92
  s_waitcnt lgkmcnt(4)
  v_mfma_f32_16x16x32_bf16 v[24:27], v[252:255], v[32:35], v[24:27]
  v_mfma_f32_32x32x16_bf16 v[52:67], v[32:35], v[124:127], v[52:67]
  ds_read_b64_tr_b16 v[44:45], v99 offset:57344
  ds_read_b64_tr_b16 v[46:47], v99 offset:57856
  v_add_f32 v92, 1.0, v92
  v_rcp_f32 v92, v92
  s_nop 0
  v_mul_f32 v92, v92, v68
  ds_write_b128 v4, v[84:87] offset:2048
  s_waitcnt lgkmcnt(5)
  v_mfma_f32_32x32x16_bf16 v[52:67], v[36:39], v[128:131], v[52:67]
  ds_read_b64_tr_b16 v[32:33], v96 offset:8192
  ds_read_b64_tr_b16 v[34:35], v96 offset:8704
  v_mul_f32 v93, v69, v69
  v_fma_f32 v93, v93, v19, v18
  v_mul_f32 v93, v93, v69
  v_exp_f32 v93, v93
  s_waitcnt lgkmcnt(5)
  v_mfma_f32_32x32x16_bf16 v[52:67], v[40:43], v[132:135], v[52:67]
  ds_read_b64_tr_b16 v[36:37], v97 offset:8192
  ds_read_b64_tr_b16 v[38:39], v97 offset:8704
  v_add_f32 v93, 1.0, v93
  v_rcp_f32 v93, v93
  s_add_u32 m0, s36, 106368
  v_mul_f32 v93, v93, v69
  ds_write_b128 v4, v[88:91] offset:3072
  s_waitcnt lgkmcnt(6)
  v_mfma_f32_32x32x16_bf16 v[52:67], v[44:47], v[136:139], v[52:67]
  ds_read_b64_tr_b16 v[40:41], v98 offset:8192
  ds_read_b64_tr_b16 v[42:43], v98 offset:8704
  v_mul_f32 v94, v70, v70
  v_fma_f32 v94, v94, v19, v18
  v_mul_f32 v94, v94, v70
  v_exp_f32 v94, v94
  buffer_load_dwordx4 v6, s[12:15], s91 offen offset:128 lds
  s_waitcnt lgkmcnt(5)
  v_mfma_f32_16x16x32_bf16 v[24:27], v[252:255], v[32:35], v[24:27]
  v_mfma_f32_32x32x16_bf16 v[52:67], v[32:35], v[140:143], v[52:67]
  ds_read_b64_tr_b16 v[44:45], v99 offset:8192
  ds_read_b64_tr_b16 v[46:47], v99 offset:8704
  v_add_f32 v94, 1.0, v94
  v_rcp_f32 v94, v94
  v_cvt_pk_bf16_f32 v84, v92, v93
  v_mul_f32 v94, v94, v70
  s_add_u32 m0, s36, 114560
  s_waitcnt lgkmcnt(5)
  v_mfma_f32_32x32x16_bf16 v[52:67], v[36:39], v[144:147], v[52:67]
  ds_read_b64_tr_b16 v[32:33], v12 offset:0
  ds_read_b64_tr_b16 v[34:35], v12 offset:512
  v_mul_f32 v95, v71, v71
  v_fma_f32 v95, v95, v19, v18
  v_mul_f32 v95, v95, v71
  v_exp_f32 v95, v95
  buffer_load_dwordx4 v6, s[12:15], s2 offen offset:128 lds
  s_waitcnt lgkmcnt(4)
  v_mfma_f32_32x32x16_bf16 v[52:67], v[40:43], v[148:151], v[52:67]
  ds_read_b64_tr_b16 v[36:37], v13 offset:0
  ds_read_b64_tr_b16 v[38:39], v13 offset:512
  v_add_f32 v95, 1.0, v95
  v_rcp_f32 v95, v95
  s_add_u32 m0, s36, 122752
  v_mul_f32 v95, v95, v71
  s_waitcnt lgkmcnt(4)
  v_mfma_f32_32x32x16_bf16 v[52:67], v[44:47], v[152:155], v[52:67]
  ds_read_b64_tr_b16 v[40:41], v14 offset:0
  ds_read_b64_tr_b16 v[42:43], v14 offset:512
  v_mul_f32 v92, v72, v72
  v_fma_f32 v92, v92, v19, v18
  v_mul_f32 v92, v92, v72
  v_exp_f32 v92, v92
  buffer_load_dwordx4 v6, s[12:15], s78 offen offset:128 lds
  s_waitcnt lgkmcnt(4)
  v_mfma_f32_16x16x32_bf16 v[24:27], v[252:255], v[32:35], v[24:27]
  v_mfma_f32_32x32x16_bf16 v[52:67], v[32:35], v[156:159], v[52:67]
  ds_read_b64_tr_b16 v[44:45], v15 offset:0
  ds_read_b64_tr_b16 v[46:47], v15 offset:512
  v_add_f32 v92, 1.0, v92
  v_rcp_f32 v92, v92
  v_cvt_pk_bf16_f32 v85, v94, v95
  v_mul_f32 v92, v92, v72
  s_waitcnt vmcnt(8)
  s_barrier
  s_waitcnt lgkmcnt(4)
  v_mfma_f32_32x32x16_bf16 v[52:67], v[36:39], v[160:163], v[52:67]
  ds_read_b64_tr_b16 v[32:33], v12 offset:8192
  ds_read_b64_tr_b16 v[34:35], v12 offset:8704
  v_mul_f32 v93, v73, v73
  v_fma_f32 v93, v93, v19, v18
  v_mul_f32 v93, v93, v73
  v_exp_f32 v93, v93
  s_waitcnt lgkmcnt(4)
  v_mfma_f32_32x32x16_bf16 v[52:67], v[40:43], v[164:167], v[52:67]
  ds_read_b64_tr_b16 v[36:37], v13 offset:8192
  ds_read_b64_tr_b16 v[38:39], v13 offset:8704
  v_add_f32 v93, 1.0, v93
  v_rcp_f32 v93, v93
  s_add_u32 m0, s36, 130944
  v_mul_f32 v93, v93, v73
  s_add_u32 s43, s59, 0
  buffer_store_dwordx4 v[100:103], v5, s[52:55], s43 offen offset:0 sc1
  s_waitcnt lgkmcnt(4)
  v_mfma_f32_32x32x16_bf16 v[52:67], v[44:47], v[168:171], v[52:67]
  ds_read_b64_tr_b16 v[40:41], v14 offset:8192
  ds_read_b64_tr_b16 v[42:43], v14 offset:8704
  v_mul_f32 v94, v74, v74
  v_fma_f32 v94, v94, v19, v18
  v_mul_f32 v94, v94, v74
  v_exp_f32 v94, v94
  buffer_load_dwordx4 v6, s[12:15], s79 offen offset:128 lds
  s_waitcnt lgkmcnt(4)
  v_mfma_f32_16x16x32_bf16 v[24:27], v[252:255], v[32:35], v[24:27]
  v_mfma_f32_32x32x16_bf16 v[52:67], v[32:35], v[172:175], v[52:67]
  ds_read_b64_tr_b16 v[44:45], v15 offset:8192
  ds_read_b64_tr_b16 v[46:47], v15 offset:8704
  v_add_f32 v94, 1.0, v94
  v_rcp_f32 v94, v94
  v_cvt_pk_bf16_f32 v86, v92, v93
  v_mul_f32 v94, v94, v74
  buffer_load_dword v29, off, s[96:99], s87 sc1
  s_waitcnt lgkmcnt(4)
  v_mfma_f32_32x32x16_bf16 v[52:67], v[36:39], v[176:179], v[52:67]
  ds_read_b64_tr_b16 v[32:33], v12 offset:16384
  ds_read_b64_tr_b16 v[34:35], v12 offset:16896
  v_mul_f32 v95, v75, v75
  v_fma_f32 v95, v95, v19, v18
  v_mul_f32 v95, v95, v75
  v_exp_f32 v95, v95
  s_waitcnt lgkmcnt(4)
  v_mfma_f32_32x32x16_bf16 v[52:67], v[40:43], v[180:183], v[52:67]
  ds_read_b64_tr_b16 v[36:37], v13 offset:16384
  ds_read_b64_tr_b16 v[38:39], v13 offset:16896
  v_add_f32 v95, 1.0, v95
  v_rcp_f32 v95, v95
  s_add_u32 m0, s36, 139136
  v_mul_f32 v95, v95, v75
  s_add_u32 s41, s59, 0
  buffer_store_dwordx4 v[104:107], v5, s[52:55], s41 offen offset:1024 sc1
  s_waitcnt lgkmcnt(4)
  v_mfma_f32_32x32x16_bf16 v[52:67], v[44:47], v[184:187], v[52:67]
  ds_read_b64_tr_b16 v[40:41], v14 offset:16384
  ds_read_b64_tr_b16 v[42:43], v14 offset:16896
  v_mul_f32 v92, v76, v76
  v_fma_f32 v92, v92, v19, v18
  v_mul_f32 v92, v92, v76
  v_exp_f32 v92, v92
  buffer_load_dwordx4 v6, s[12:15], s72 offen offset:128 lds
  s_waitcnt lgkmcnt(4)
  v_mfma_f32_16x16x32_bf16 v[24:27], v[252:255], v[32:35], v[24:27]
  v_mfma_f32_32x32x16_bf16 v[52:67], v[32:35], v[188:191], v[52:67]
  ds_read_b64_tr_b16 v[44:45], v15 offset:16384
  ds_read_b64_tr_b16 v[46:47], v15 offset:16896
  v_add_f32 v92, 1.0, v92
  v_rcp_f32 v92, v92
  v_cvt_pk_bf16_f32 v87, v94, v95
  v_mul_f32 v92, v92, v76
  s_waitcnt lgkmcnt(4)
  v_mfma_f32_32x32x16_bf16 v[52:67], v[36:39], v[192:195], v[52:67]
  ds_read_b64_tr_b16 v[32:33], v12 offset:24576
  ds_read_b64_tr_b16 v[34:35], v12 offset:25088
  v_mul_f32 v93, v77, v77
  v_fma_f32 v93, v93, v19, v18
  v_mul_f32 v93, v93, v77
  v_exp_f32 v93, v93
  s_waitcnt lgkmcnt(4)
  v_mfma_f32_32x32x16_bf16 v[52:67], v[40:43], v[196:199], v[52:67]
  ds_read_b64_tr_b16 v[36:37], v13 offset:24576
  ds_read_b64_tr_b16 v[38:39], v13 offset:25088
  v_add_f32 v93, 1.0, v93
  v_rcp_f32 v93, v93
  s_add_u32 m0, s36, 147328
  v_mul_f32 v93, v93, v77
  s_waitcnt lgkmcnt(4)
  v_mfma_f32_32x32x16_bf16 v[52:67], v[44:47], v[200:203], v[52:67]
  ds_read_b64_tr_b16 v[40:41], v14 offset:24576
  ds_read_b64_tr_b16 v[42:43], v14 offset:25088
  v_mul_f32 v94, v78, v78
  v_fma_f32 v94, v94, v19, v18
  v_mul_f32 v94, v94, v78
  v_exp_f32 v94, v94
  buffer_load_dwordx4 v6, s[12:15], s73 offen offset:128 lds
  s_waitcnt lgkmcnt(4)
  v_mfma_f32_16x16x32_bf16 v[24:27], v[252:255], v[32:35], v[24:27]
  v_mfma_f32_32x32x16_bf16 v[52:67], v[32:35], v[204:207], v[52:67]
  ds_read_b64_tr_b16 v[44:45], v15 offset:24576
  ds_read_b64_tr_b16 v[46:47], v15 offset:25088
  v_add_f32 v94, 1.0, v94
  v_rcp_f32 v94, v94
  v_cvt_pk_bf16_f32 v88, v92, v93
  v_mul_f32 v94, v94, v78
  s_waitcnt vmcnt(11)
  s_barrier
  s_waitcnt lgkmcnt(4)
  v_mfma_f32_32x32x16_bf16 v[52:67], v[36:39], v[208:211], v[52:67]
  ds_read_b64_tr_b16 v[32:33], v12 offset:32768
  ds_read_b64_tr_b16 v[34:35], v12 offset:33280
  v_mul_f32 v95, v79, v79
  v_fma_f32 v95, v95, v19, v18
  v_mul_f32 v95, v95, v79
  v_exp_f32 v95, v95
  s_waitcnt vmcnt(3)
  v_cmp_ne_u32 vcc, 0xffff, v29
  s_nop 2
  s_and_b32 vcc_lo, vcc_lo, 1
  s_cbranch_scc1 SPIN_mc
BACK_mc:
  s_waitcnt lgkmcnt(4)
  v_mfma_f32_32x32x16_bf16 v[52:67], v[40:43], v[212:215], v[52:67]
  ds_read_b64_tr_b16 v[36:37], v13 offset:32768
  ds_read_b64_tr_b16 v[38:39], v13 offset:33280
  v_add_f32 v95, 1.0, v95
  v_rcp_f32 v95, v95
  s_add_u32 m0, s36, 98176
  v_mul_f32 v95, v95, v79
  s_waitcnt lgkmcnt(4)
  v_mfma_f32_32x32x16_bf16 v[52:67], v[44:47], v[216:219], v[52:67]
  ds_read_b64_tr_b16 v[40:41], v14 offset:32768
  ds_read_b64_tr_b16 v[42:43], v14 offset:33280
  v_mul_f32 v92, v80, v80
  v_fma_f32 v92, v92, v19, v18
  v_mul_f32 v92, v92, v80
  v_exp_f32 v92, v92
  buffer_load_dwordx4 v6, s[12:15], s39 offen offset:128 lds
  s_waitcnt lgkmcnt(4)
  v_mfma_f32_16x16x32_bf16 v[24:27], v[252:255], v[32:35], v[24:27]
  v_mfma_f32_32x32x16_bf16 v[52:67], v[32:35], v[220:223], v[52:67]
  ds_read_b64_tr_b16 v[44:45], v15 offset:32768
  ds_read_b64_tr_b16 v[46:47], v15 offset:33280
  v_add_f32 v92, 1.0, v92
  v_rcp_f32 v92, v92
  v_cvt_pk_bf16_f32 v89, v94, v95
  v_mul_f32 v92, v92, v80
  s_waitcnt lgkmcnt(4)
  v_mfma_f32_32x32x16_bf16 v[52:67], v[36:39], v[224:227], v[52:67]
  ds_read_b64_tr_b16 v[32:33], v12 offset:40960
  ds_read_b64_tr_b16 v[34:35], v12 offset:41472
  v_mul_f32 v93, v81, v81
  v_fma_f32 v93, v93, v19, v18
  v_mul_f32 v93, v93, v81
  v_exp_f32 v93, v93
  s_waitcnt lgkmcnt(4)
  v_mfma_f32_32x32x16_bf16 v[52:67], v[40:43], v[228:231], v[52:67]
  ds_read_b64_tr_b16 v[36:37], v13 offset:40960
  ds_read_b64_tr_b16 v[38:39], v13 offset:41472
  v_add_f32 v93, 1.0, v93
  v_rcp_f32 v93, v93
  s_nop 0
  v_mul_f32 v93, v93, v81
  s_waitcnt lgkmcnt(4)
  v_mfma_f32_32x32x16_bf16 v[52:67], v[44:47], v[232:235], v[52:67]
  ds_read_b64_tr_b16 v[40:41], v14 offset:40960
  ds_read_b64_tr_b16 v[42:43], v14 offset:41472
  v_mul_f32 v94, v82, v82
  v_fma_f32 v94, v94, v19, v18
  v_mul_f32 v94, v94, v82
  v_exp_f32 v94, v94
  s_waitcnt lgkmcnt(4)
  v_mfma_f32_16x16x32_bf16 v[24:27], v[252:255], v[32:35], v[24:27]
  v_mfma_f32_32x32x16_bf16 v[52:67], v[32:35], v[236:239], v[52:67]
  ds_read_b64_tr_b16 v[44:45], v15 offset:40960
  ds_read_b64_tr_b16 v[46:47], v15 offset:41472
  v_add_f32 v94, 1.0, v94
  v_rcp_f32 v94, v94
  v_cvt_pk_bf16_f32 v90, v92, v93
  v_mul_f32 v94, v94, v82
  s_add_u32 m0, s36, 0
  s_waitcnt lgkmcnt(4)
  v_mfma_f32_32x32x16_bf16 v[52:67], v[36:39], v[240:243], v[52:67]
  ds_read_b64_tr_b16 v[32:33], v12 offset:49152
  ds_read_b64_tr_b16 v[34:35], v12 offset:49664
  v_mul_f32 v95, v83, v83
  v_fma_f32 v95, v95, v19, v18
  v_mul_f32 v95, v95, v83
  v_exp_f32 v95, v95
  ds_write_b32 v30, v24
  buffer_load_dwordx4 v7, s[16:19], s56 offen lds
  s_waitcnt lgkmcnt(5)
  v_mfma_f32_32x32x16_bf16 v[52:67], v[40:43], v[244:247], v[52:67]
  ds_read_b64_tr_b16 v[36:37], v13 offset:49152
  ds_read_b64_tr_b16 v[38:39], v13 offset:49664
  v_add_f32 v95, 1.0, v95
  v_rcp_f32 v95, v95
  s_add_u32 m0, s36, 8192
  v_mul_f32 v95, v95, v83
  s_waitcnt lgkmcnt(2)
  s_barrier
  ds_read_b64 v[10:11], v28
  v_mfma_f32_32x32x16_bf16 v[52:67], v[44:47], v[248:251], v[52:67]
  ds_read_b64_tr_b16 v[40:41], v14 offset:49152
  ds_read_b64_tr_b16 v[42:43], v14 offset:49664
  buffer_load_dwordx4 v1, s[16:19], s63 offen lds
  v_mfma_f32_16x16x32_bf16 v[24:27], v[252:255], v[32:35], 0
  v_mfma_f32_32x32x16_bf16 v[68:83], v[32:35], v[108:111], 0
  ds_read_b64_tr_b16 v[44:45], v15 offset:49152
  ds_read_b64_tr_b16 v[46:47], v15 offset:49664
  s_waitcnt lgkmcnt(4)
  v_add_f32 v10, v10, v11
  v_cvt_pk_bf16_f32 v11, v10, v10
  v_lshlrev_b32 v11, 16, v11
  v_sub_f32 v10, v10, v11
  v_cvt_pk_bf16_f32 v22, v11, v10
  s_nop 1
  v_mfma_f32_32x32x8_bf16 v[52:67], v[22:23], v[20:21], v[52:67]
  v_mfma_f32_32x32x16_bf16 v[68:83], v[36:39], v[112:115], v[68:83]
  ds_read_b64_tr_b16 v[32:33], v12 offset:57344
  ds_read_b64_tr_b16 v[34:35], v12 offset:57856
  v_cvt_pk_bf16_f32 v91, v94, v95
  v_permlane16_swap_b32 v84, v88
  v_permlane16_swap_b32 v85, v89
  buffer_load_ushort v23, v31, s[20:23], s92 offen offset:128
  v_xor_b32 v9, 32, v8
  s_waitcnt lgkmcnt(4)
  v_mfma_f32_32x32x16_bf16 v[68:83], v[40:43], v[116:119], v[68:83]
  ds_read_b64_tr_b16 v[36:37], v13 offset:57344
  ds_read_b64_tr_b16 v[38:39], v13 offset:57856
  v_permlane16_swap_b32 v86, v90
  v_permlane16_swap_b32 v87, v91
  s_add_u32 s43, s59, 6144
  buffer_store_dwordx4 v[84:87], v5, s[52:55], s43 offen offset:0 sc1
  s_add_u32 m0, s36, 16384
  s_waitcnt lgkmcnt(4)
  v_mfma_f32_32x32x16_bf16 v[68:83], v[44:47], v[120:123], v[68:83]
  ds_read_b64_tr_b16 v[40:41], v14 offset:57344
  ds_read_b64_tr_b16 v[42:43], v14 offset:57856
  v_mul_f32 v92, v52, v52
  v_fma_f32 v92, v92, v19, v18
  v_mul_f32 v92, v92, v52
  v_exp_f32 v92, v92
  s_add_u32 s40, s56, s75
  s_add_u32 s40, s40, 73728
  buffer_load_dwordx4 v7, s[16:19], s40 offen lds
  s_waitcnt lgkmcnt(4)
  v_mfma_f32_16x16x32_bf16 v[24:27], v[252:255], v[32:35], v[24:27]
  v_mfma_f32_32x32x16_bf16 v[68:83], v[32:35], v[124:127], v[68:83]
  ds_read_b64_tr_b16 v[44:45], v15 offset:57344
  ds_read_b64_tr_b16 v[46:47], v15 offset:57856
  v_add_f32 v92, 1.0, v92
  v_rcp_f32 v92, v92
  v_xor_b32 v10, 64, v8
  v_mul_f32 v92, v92, v52
  v_xor_b32 v11, 96, v8
  s_waitcnt lgkmcnt(4)
  v_mfma_f32_32x32x16_bf16 v[68:83], v[36:39], v[128:131], v[68:83]
  ds_read_b64_tr_b16 v[32:33], v96 offset:16384
  ds_read_b64_tr_b16 v[34:35], v96 offset:16896
  v_mul_f32 v93, v53, v53
  v_fma_f32 v93, v93, v19, v18
  v_mul_f32 v93, v93, v53
  v_exp_f32 v93, v93
  s_waitcnt lgkmcnt(4)
  v_mfma_f32_32x32x16_bf16 v[68:83], v[40:43], v[132:135], v[68:83]
  ds_read_b64_tr_b16 v[36:37], v97 offset:16384
  ds_read_b64_tr_b16 v[38:39], v97 offset:16896
  v_add_f32 v93, 1.0, v93
  v_rcp_f32 v93, v93
  s_add_u32 m0, s36, 24576
  v_mul_f32 v93, v93, v53
  s_add_u32 s41, s59, 6144
  buffer_store_dwordx4 v[88:91], v5, s[52:55], s41 offen offset:1024 sc1
  s_waitcnt lgkmcnt(4)
  v_mfma_f32_32x32x16_bf16 v[68:83], v[44:47], v[136:139], v[68:83]
  ds_read_b64_tr_b16 v[40:41], v98 offset:16384
  ds_read_b64_tr_b16 v[42:43], v98 offset:16896
  v_mul_f32 v94, v54, v54
  v_fma_f32 v94, v94, v19, v18
  v_mul_f32 v94, v94, v54
  v_exp_f32 v94, v94
  s_add_u32 s42, s63, s75
  s_add_u32 s42, s42, 73728
  buffer_load_dwordx4 v1, s[16:19], s42 offen lds
  s_waitcnt lgkmcnt(4)
  v_mfma_f32_16x16x32_bf16 v[24:27], v[252:255], v[32:35], v[24:27]
  v_mfma_f32_32x32x16_bf16 v[68:83], v[32:35], v[140:143], v[68:83]
  ds_read_b64_tr_b16 v[44:45], v99 offset:16384
  ds_read_b64_tr_b16 v[46:47], v99 offset:16896
  v_add_f32 v94, 1.0, v94
  v_rcp_f32 v94, v94
  v_cvt_pk_bf16_f32 v108, v92, v93
  v_mul_f32 v94, v94, v54
  ds_read_b128 v[124:127], v4 offset:0
  s_waitcnt lgkmcnt(5)
  v_mfma_f32_32x32x16_bf16 v[68:83], v[36:39], v[144:147], v[68:83]
  ds_read_b64_tr_b16 v[32:33], v96 offset:24576
  ds_read_b64_tr_b16 v[34:35], v96 offset:25088
  v_mul_f32 v95, v55, v55
  v_fma_f32 v95, v95, v19, v18
  v_mul_f32 v95, v95, v55
  v_exp_f32 v95, v95
  ds_read_b128 v[128:131], v4 offset:1024
  s_waitcnt lgkmcnt(6)
  v_mfma_f32_32x32x16_bf16 v[68:83], v[40:43], v[148:151], v[68:83]
  ds_read_b64_tr_b16 v[36:37], v97 offset:24576
  ds_read_b64_tr_b16 v[38:39], v97 offset:25088
  v_add_f32 v95, 1.0, v95
  v_rcp_f32 v95, v95
  ds_read_b128 v[132:135], v4 offset:2048
  v_mul_f32 v95, v95, v55
  s_add_u32 m0, s36, 32768
  s_waitcnt lgkmcnt(7)
  v_mfma_f32_32x32x16_bf16 v[68:83], v[44:47], v[152:155], v[68:83]
  ds_read_b64_tr_b16 v[40:41], v98 offset:24576
  ds_read_b64_tr_b16 v[42:43], v98 offset:25088
  v_mul_f32 v92, v56, v56
  v_fma_f32 v92, v92, v19, v18
  v_mul_f32 v92, v92, v56
  v_exp_f32 v92, v92
  s_add_u32 s43, s56, 73728
  buffer_load_dwordx4 v7, s[16:19], s43 offen lds
  s_waitcnt lgkmcnt(6)
  v_mfma_f32_16x16x32_bf16 v[24:27], v[252:255], v[32:35], v[24:27]
  v_mfma_f32_32x32x16_bf16 v[68:83], v[32:35], v[156:159], v[68:83]
  ds_read_b64_tr_b16 v[44:45], v99 offset:24576
  ds_read_b64_tr_b16 v[46:47], v99 offset:25088
  v_add_f32 v92, 1.0, v92
  v_rcp_f32 v92, v92
  v_cvt_pk_bf16_f32 v109, v94, v95
  v_mul_f32 v92, v92, v56
  ds_read_b128 v[136:139], v4 offset:3072
  s_waitcnt vmcnt(10)
  s_barrier
  s_waitcnt lgkmcnt(6)
  v_mfma_f32_32x32x16_bf16 v[68:83], v[36:39], v[160:163], v[68:83]
  ds_read_b64_tr_b16 v[32:33], v96 offset:32768
  ds_read_b64_tr_b16 v[34:35], v96 offset:33280
  v_mul_f32 v93, v57, v57
  v_fma_f32 v93, v93, v19, v18
  v_mul_f32 v93, v93, v57
  v_exp_f32 v93, v93
  s_waitcnt lgkmcnt(5)
  v_mfma_f32_32x32x16_bf16 v[68:83], v[40:43], v[164:167], v[68:83]
  ds_read_b64_tr_b16 v[36:37], v97 offset:32768
  ds_read_b64_tr_b16 v[38:39], v97 offset:33280
  v_add_f32 v93, 1.0, v93
  v_rcp_f32 v93, v93
  s_add_u32 m0, s36, 40960
  v_mul_f32 v93, v93, v57
  s_add_u32 s40, s59, 2048
  buffer_store_dwordx4 v[124:127], v5, s[52:55], s40 offen offset:0 sc1
  s_waitcnt lgkmcnt(5)
  v_mfma_f32_32x32x16_bf16 v[68:83], v[44:47], v[168:171], v[68:83]
  ds_read_b64_tr_b16 v[40:41], v98 offset:32768
  ds_read_b64_tr_b16 v[42:43], v98 offset:33280
  v_mul_f32 v94, v58, v58
  v_fma_f32 v94, v94, v19, v18
  v_mul_f32 v94, v94, v58
  v_exp_f32 v94, v94
  s_add_u32 s41, s63, 73728
  buffer_load_dwordx4 v1, s[16:19], s41 offen lds
  s_waitcnt lgkmcnt(4)
  v_mfma_f32_16x16x32_bf16 v[24:27], v[252:255], v[32:35], v[24:27]
  v_mfma_f32_32x32x16_bf16 v[68:83], v[32:35], v[172:175], v[68:83]
  ds_read_b64_tr_b16 v[44:45], v99 offset:32768
  ds_read_b64_tr_b16 v[46:47], v99 offset:33280
  v_add_f32 v94, 1.0, v94
  v_rcp_f32 v94, v94
  v_cvt_pk_bf16_f32 v110, v92, v93
  v_mul_f32 v94, v94, v58
  v_mov_b32 v156, -1
  s_waitcnt lgkmcnt(4)
  v_mfma_f32_32x32x16_bf16 v[68:83], v[36:39], v[176:179], v[68:83]
  ds_read_b64_tr_b16 v[32:33], v96 offset:40960
  ds_read_b64_tr_b16 v[34:35], v96 offset:41472
  v_mul_f32 v95, v59, v59
  v_fma_f32 v95, v95, v19, v18
  v_mul_f32 v95, v95, v59
  v_exp_f32 v95, v95
  v_mov_b32 v157, -1
  s_waitcnt lgkmcnt(4)
  v_mfma_f32_32x32x16_bf16 v[68:83], v[40:43], v[180:183], v[68:83]
  ds_read_b64_tr_b16 v[36:37], v97 offset:40960
  ds_read_b64_tr_b16 v[38:39], v97 offset:41472
  v_add_f32 v95, 1.0, v95
  v_rcp_f32 v95, v95
  v_mov_b32 v158, -1
  v_mul_f32 v95, v95, v59
  s_add_u32 s42, s59, 2048
  buffer_store_dwordx4 v[128:131], v5, s[52:55], s42 offen offset:1024 sc1
  s_add_u32 m0, s36, 49152
  s_waitcnt lgkmcnt(4)
  v_mfma_f32_32x32x16_bf16 v[68:83], v[44:47], v[184:187], v[68:83]
  ds_read_b64_tr_b16 v[40:41], v98 offset:40960
  ds_read_b64_tr_b16 v[42:43], v98 offset:41472
  v_mul_f32 v92, v60, v60
  v_fma_f32 v92, v92, v19, v18
  v_mul_f32 v92, v92, v60
  v_exp_f32 v92, v92
  s_add_u32 s43, s56, s75
  buffer_load_dwordx4 v7, s[16:19], s43 offen lds
  s_waitcnt lgkmcnt(4)
  v_mfma_f32_16x16x32_bf16 v[24:27], v[252:255], v[32:35], v[24:27]
  v_mfma_f32_32x32x16_bf16 v[68:83], v[32:35], v[188:191], v[68:83]
  ds_read_b64_tr_b16 v[44:45], v99 offset:40960
  ds_read_b64_tr_b16 v[46:47], v99 offset:41472
  v_add_f32 v92, 1.0, v92
  v_rcp_f32 v92, v92
  v_cvt_pk_bf16_f32 v111, v94, v95
  v_mul_f32 v92, v92, v60
  v_mov_b32 v159, -1
  s_waitcnt lgkmcnt(4)
  v_mfma_f32_32x32x16_bf16 v[68:83], v[36:39], v[192:195], v[68:83]
  ds_read_b64_tr_b16 v[32:33], v96 offset:49152
  ds_read_b64_tr_b16 v[34:35], v96 offset:49664
  v_mul_f32 v93, v61, v61
  v_fma_f32 v93, v93, v19, v18
  v_mul_f32 v93, v93, v61
  v_exp_f32 v93, v93
  s_waitcnt lgkmcnt(4)
  v_mfma_f32_32x32x16_bf16 v[68:83], v[40:43], v[196:199], v[68:83]
  ds_read_b64_tr_b16 v[36:37], v97 offset:49152
  ds_read_b64_tr_b16 v[38:39], v97 offset:49664
  v_add_f32 v93, 1.0, v93
  v_rcp_f32 v93, v93
  s_add_u32 m0, s36, 57344
  v_mul_f32 v93, v93, v61
  s_add_u32 s40, s59, 4096
  buffer_store_dwordx4 v[132:135], v5, s[52:55], s40 offen offset:0 sc1
  s_waitcnt lgkmcnt(4)
  v_mfma_f32_32x32x16_bf16 v[68:83], v[44:47], v[200:203], v[68:83]
  ds_read_b64_tr_b16 v[40:41], v98 offset:49152
  ds_read_b64_tr_b16 v[42:43], v98 offset:49664
  v_mul_f32 v94, v62, v62
  v_fma_f32 v94, v94, v19, v18
  v_mul_f32 v94, v94, v62
  v_exp_f32 v94, v94
  s_add_u32 s41, s63, s75
  buffer_load_dwordx4 v1, s[16:19], s41 offen lds
  s_waitcnt lgkmcnt(4)
  v_mfma_f32_16x16x32_bf16 v[24:27], v[252:255], v[32:35], v[24:27]
  v_mfma_f32_32x32x16_bf16 v[68:83], v[32:35], v[204:207], v[68:83]
  ds_read_b64_tr_b16 v[44:45], v99 offset:49152
  ds_read_b64_tr_b16 v[46:47], v99 offset:49664
  v_add_f32 v94, 1.0, v94
  v_rcp_f32 v94, v94
  v_cvt_pk_bf16_f32 v112, v92, v93
  v_mul_f32 v94, v94, v62
  s_waitcnt vmcnt(8)
  s_barrier
  v_mov_b32 v31, 1
  s_mov_b64 exec, 1
  buffer_store_dword v31, off, s[28:31], 0 sc1
  s_mov_b64 exec, -1
  s_waitcnt lgkmcnt(4)
  v_mfma_f32_32x32x16_bf16 v[68:83], v[36:39], v[208:211], v[68:83]
  ds_read_b64_tr_b16 v[32:33], v96 offset:57344
  ds_read_b64_tr_b16 v[34:35], v96 offset:57856
  v_mul_f32 v95, v63, v63
  v_fma_f32 v95, v95, v19, v18
  v_mul_f32 v95, v95, v63
  v_exp_f32 v95, v95
  s_waitcnt lgkmcnt(4)
  v_mfma_f32_32x32x16_bf16 v[68:83], v[40:43], v[212:215], v[68:83]
  ds_read_b64_tr_b16 v[36:37], v97 offset:57344
  ds_read_b64_tr_b16 v[38:39], v97 offset:57856
  v_add_f32 v95, 1.0, v95
  v_rcp_f32 v95, v95
  s_add_u32 m0, s36, 106496
  v_mul_f32 v95, v95, v63
  s_add_u32 s42, s59, 4096
  buffer_store_dwordx4 v[136:139], v5, s[52:55], s42 offen offset:1024 sc1
  s_waitcnt lgkmcnt(4)
  v_mfma_f32_32x32x16_bf16 v[68:83], v[44:47], v[216:219], v[68:83]
  ds_read_b64_tr_b16 v[40:41], v98 offset:57344
  ds_read_b64_tr_b16 v[42:43], v98 offset:57856
  v_mul_f32 v92, v64, v64
  v_fma_f32 v92, v92, v19, v18
  v_mul_f32 v92, v92, v64
  v_exp_f32 v92, v92
  s_add_u32 s43, s56, s94
  buffer_load_dwordx4 v7, s[16:19], s43 offen lds
  s_waitcnt lgkmcnt(4)
  v_mfma_f32_16x16x32_bf16 v[24:27], v[252:255], v[32:35], v[24:27]
  v_mfma_f32_32x32x16_bf16 v[68:83], v[32:35], v[220:223], v[68:83]
  ds_read_b64_tr_b16 v[44:45], v99 offset:57344
  ds_read_b64_tr_b16 v[46:47], v99 offset:57856
  v_add_f32 v92, 1.0, v92
  v_rcp_f32 v92, v92
  v_cvt_pk_bf16_f32 v113, v94, v95
  v_mul_f32 v92, v92, v64
  s_waitcnt lgkmcnt(4)
  v_mfma_f32_32x32x16_bf16 v[68:83], v[36:39], v[224:227], v[68:83]
  ds_read_b64_tr_b16 v[32:33], v96 offset:8192
  ds_read_b64_tr_b16 v[34:35], v96 offset:8704
  v_mul_f32 v93, v65, v65
  v_fma_f32 v93, v93, v19, v18
  v_mul_f32 v93, v93, v65
  v_exp_f32 v93, v93
  s_waitcnt lgkmcnt(4)
  v_mfma_f32_32x32x16_bf16 v[68:83], v[40:43], v[228:231], v[68:83]
  ds_read_b64_tr_b16 v[36:37], v97 offset:8192
  ds_read_b64_tr_b16 v[38:39], v97 offset:8704
  v_add_f32 v93, 1.0, v93
  v_rcp_f32 v93, v93
  s_nop 0
  v_mul_f32 v93, v93, v65
  buffer_store_dwordx4 v[156:159], v5, s[24:27], s67 offen offset:2048 sc1
  s_waitcnt lgkmcnt(4)
  v_mfma_f32_32x32x16_bf16 v[68:83], v[44:47], v[232:235], v[68:83]
  ds_read_b64_tr_b16 v[40:41], v98 offset:8192
  ds_read_b64_tr_b16 v[42:43], v98 offset:8704
  v_mul_f32 v94, v66, v66
  v_fma_f32 v94, v94, v19, v18
  v_mul_f32 v94, v94, v66
  v_exp_f32 v94, v94
  s_waitcnt lgkmcnt(4)
  v_mfma_f32_16x16x32_bf16 v[24:27], v[252:255], v[32:35], v[24:27]
  v_mfma_f32_32x32x16_bf16 v[68:83], v[32:35], v[236:239], v[68:83]
  ds_read_b64_tr_b16 v[44:45], v99 offset:8192
  ds_read_b64_tr_b16 v[46:47], v99 offset:8704
  v_add_f32 v94, 1.0, v94
  v_rcp_f32 v94, v94
  v_cvt_pk_bf16_f32 v114, v92, v93
  v_mul_f32 v94, v94, v66
  s_add_u32 m0, s36, 114688
  s_waitcnt lgkmcnt(4)
  v_mfma_f32_32x32x16_bf16 v[68:83], v[36:39], v[240:243], v[68:83]
  ds_read_b64_tr_b16 v[32:33], v8 offset:0
  ds_read_b64_tr_b16 v[34:35], v8 offset:1024
  v_mul_f32 v95, v67, v67
  v_fma_f32 v95, v95, v19, v18
  v_mul_f32 v95, v95, v67
  v_exp_f32 v95, v95
  ds_write_b32 v30, v24
  s_add_u32 s40, s63, s94
  buffer_load_dwordx4 v1, s[16:19], s40 offen lds
  s_waitcnt lgkmcnt(5)
  v_mfma_f32_32x32x16_bf16 v[68:83], v[40:43], v[244:247], v[68:83]
  ds_read_b64_tr_b16 v[36:37], v9 offset:0
  ds_read_b64_tr_b16 v[38:39], v9 offset:1024
  v_add_f32 v95, 1.0, v95
  v_rcp_f32 v95, v95
  s_add_u32 m0, s36, 122880
  v_mul_f32 v95, v95, v67
  s_waitcnt lgkmcnt(2)
  s_barrier
  ds_read_b64 v[14:15], v28
  v_mfma_f32_32x32x16_bf16 v[68:83], v[44:47], v[248:251], v[68:83]
  ds_read_b64_tr_b16 v[40:41], v10 offset:0
  ds_read_b64_tr_b16 v[42:43], v10 offset:1024
  buffer_load_dwordx4 v1, s[16:19], s48 offen lds
  v_mfma_f32_16x16x32_bf16 v[172:175], v[32:35], v[104:107], 0
  ds_read_b64_tr_b16 v[44:45], v11 offset:0
  ds_read_b64_tr_b16 v[46:47], v11 offset:1024
  v_mfma_f32_16x16x32_bf16 v[156:159], v[32:35], v[100:103], 0
  s_add_u32 m0, s36, 131072
  s_add_u32 s42, s48, s75
  s_add_u32 s42, s42, 73728
  buffer_load_dwordx4 v1, s[16:19], s42 offen lds
  s_waitcnt lgkmcnt(4)
  v_add_f32 v14, v14, v15
  v_cvt_pk_bf16_f32 v15, v14, v14
  v_lshlrev_b32 v15, 16, v15
  v_sub_f32 v14, v14, v15
  v_cvt_pk_bf16_f32 v22, v15, v14
  s_nop 1
  v_mfma_f32_32x32x8_bf16 v[68:83], v[22:23], v[20:21], v[68:83]
  v_mfma_f32_16x16x32_bf16 v[176:179], v[36:39], v[104:107], 0
  ds_read_b64_tr_b16 v[32:33], v8 offset:8192
  ds_read_b64_tr_b16 v[34:35], v8 offset:9216
  v_mfma_f32_16x16x32_bf16 v[160:163], v[36:39], v[100:103], 0
  v_cvt_pk_bf16_f32 v115, v94, v95
  v_permlane16_swap_b32 v108, v112
  v_permlane16_swap_b32 v109, v113
  v_permlane16_swap_b32 v110, v114
  v_permlane16_swap_b32 v111, v115
  s_waitcnt lgkmcnt(4)
  v_mfma_f32_16x16x32_bf16 v[180:183], v[40:43], v[104:107], 0
  ds_read_b64_tr_b16 v[36:37], v9 offset:8192
  ds_read_b64_tr_b16 v[38:39], v9 offset:9216
  v_mfma_f32_16x16x32_bf16 v[164:167], v[40:43], v[100:103], 0
  s_add_u32 s43, s59, 8192
  buffer_store_dwordx4 v[108:111], v5, s[52:55], s43 offen offset:0 sc1
  v_mul_f32 v92, v68, v68
  v_mul_f32 v93, v69, v69
  v_fma_f32 v92, v92, v19, v18
  v_mul_f32 v94, v70, v70
  v_fma_f32 v93, v93, v19, v18
  v_mul_f32 v92, v92, v68
  s_waitcnt lgkmcnt(4)
  v_mfma_f32_16x16x32_bf16 v[184:187], v[44:47], v[104:107], 0
  ds_read_b64_tr_b16 v[40:41], v10 offset:8192
  ds_read_b64_tr_b16 v[42:43], v10 offset:9216
  v_mul_f32 v95, v71, v71
  v_exp_f32 v92, v92
  v_mfma_f32_16x16x32_bf16 v[168:171], v[44:47], v[100:103], 0
  s_add_u32 m0, s36, 139264
  s_add_u32 s40, s48, 73728
  buffer_load_dwordx4 v1, s[16:19], s40 offen lds
  v_fma_f32 v94, v94, v19, v18
  s_waitcnt lgkmcnt(4)
  v_mfma_f32_16x16x32_bf16 v[204:207], v[32:35], v[104:107], 0
  ds_read_b64_tr_b16 v[44:45], v11 offset:8192
  ds_read_b64_tr_b16 v[46:47], v11 offset:9216
  v_mul_f32 v93, v93, v69
  v_mul_f32 v96, v72, v72
  v_mfma_f32_16x16x32_bf16 v[188:191], v[32:35], v[100:103], 0
  v_exp_f32 v93, v93
  v_fma_f32 v95, v95, v19, v18
  s_waitcnt lgkmcnt(4)
  v_mfma_f32_16x16x32_bf16 v[208:211], v[36:39], v[104:107], 0
  ds_read_b64_tr_b16 v[32:33], v8 offset:16384
  ds_read_b64_tr_b16 v[34:35], v8 offset:17408
  v_mul_f32 v94, v94, v70
  v_add_f32 v92, 1.0, v92
  v_mul_f32 v97, v73, v73
  v_mfma_f32_16x16x32_bf16 v[192:195], v[36:39], v[100:103], 0
  v_exp_f32 v94, v94
  v_fma_f32 v96, v96, v19, v18
  s_waitcnt lgkmcnt(4)
  v_mfma_f32_16x16x32_bf16 v[212:215], v[40:43], v[104:107], 0
  ds_read_b64_tr_b16 v[36:37], v9 offset:16384
  ds_read_b64_tr_b16 v[38:39], v9 offset:17408
  v_mul_f32 v95, v95, v71
  v_rcp_f32 v92, v92
  v_mfma_f32_16x16x32_bf16 v[196:199], v[40:43], v[100:103], 0
  s_add_u32 s41, s59, 8192
  buffer_store_dwordx4 v[112:115], v5, s[52:55], s41 offen offset:1024 sc1
  v_and_b32 v244, 15, v0
  s_add_u32 m0, s36, 147456
  s_add_u32 s42, s56, s94
  s_add_u32 s42, s42, 73728
  buffer_load_dwordx4 v7, s[16:19], s42 offen lds
  v_add_f32 v93, 1.0, v93
  s_waitcnt lgkmcnt(4)
  v_mfma_f32_16x16x32_bf16 v[216:219], v[44:47], v[104:107], 0
  ds_read_b64_tr_b16 v[40:41], v10 offset:16384
  ds_read_b64_tr_b16 v[42:43], v10 offset:17408
  v_mul_f32 v98, v74, v74
  v_mfma_f32_16x16x32_bf16 v[200:203], v[44:47], v[100:103], 0
  s_lshl1_add_u32 s100, s4, s5
  s_lshl_b32 s100, s100, 4
  v_add_u32 v244, s100, v244
  v_exp_f32 v95, v95
  v_fma_f32 v97, v97, v19, v18
  v_mul_f32 v96, v96, v72
  s_mov_b64 exec, 0x7
  buffer_load_dword v29, v2, s[32:35], 0 offen sc1
  s_mov_b64 exec, -1
  s_waitcnt lgkmcnt(4)
  v_mfma_f32_16x16x32_bf16 v[172:175], v[32:35], v[88:91], v[172:175]
  ds_read_b64_tr_b16 v[44:45], v11 offset:16384
  ds_read_b64_tr_b16 v[46:47], v11 offset:17408
  v_mfma_f32_16x16x32_bf16 v[156:159], v[32:35], v[84:87], v[156:159]
  s_waitcnt vmcnt(16)
  s_barrier
  s_waitcnt lgkmcnt(4)
  v_mfma_f32_16x16x32_bf16 v[176:179], v[36:39], v[88:91], v[176:179]
  ds_read_b64_tr_b16 v[32:33], v8 offset:24576
  ds_read_b64_tr_b16 v[34:35], v8 offset:25600
  v_rcp_f32 v93, v93
  v_add_f32 v94, 1.0, v94
  v_mfma_f32_16x16x32_bf16 v[160:163], v[36:39], v[84:87], v[160:163]
  v_lshrrev_b32 v245, 4, v0
  s_add_u32 m0, s36, 98304
  s_add_u32 s43, s63, s94
  s_add_u32 s43, s43, 73728
  buffer_load_dwordx4 v1, s[16:19], s43 offen lds
  v_mul_f32 v92, v92, v68
  s_waitcnt lgkmcnt(4)
  v_mfma_f32_16x16x32_bf16 v[180:183], v[40:43], v[88:91], v[180:183]
  ds_read_b64_tr_b16 v[36:37], v9 offset:24576
  ds_read_b64_tr_b16 v[38:39], v9 offset:25600
  v_mul_f32 v99, v75, v75
  v_exp_f32 v96, v96
  v_mfma_f32_16x16x32_bf16 v[164:167], v[40:43], v[84:87], v[164:167]
  s_mov_b32 s100, 161792
  v_lshl_add_u32 v244, v244, 3, s100
  v_fma_f32 v98, v98, v19, v18
  v_mul_f32 v97, v97, v73
  s_waitcnt lgkmcnt(4)
  v_mfma_f32_16x16x32_bf16 v[184:187], v[44:47], v[88:91], v[184:187]
  ds_read_b64_tr_b16 v[40:41], v10 offset:24576
  ds_read_b64_tr_b16 v[42:43], v10 offset:25600
  v_rcp_f32 v94, v94
  v_add_f32 v95, 1.0, v95
  v_mfma_f32_16x16x32_bf16 v[168:171], v[44:47], v[84:87], v[168:171]
  s_mov_b32 s100, 162816
  v_lshl_add_u32 v245, v245, 3, s100
  v_mul_f32 v93, v93, v69
  v_cvt_pk_bf16_f32 v116, v92, v93
  v_mul_f32 v92, v76, v76
  s_waitcnt lgkmcnt(4)
  v_mfma_f32_16x16x32_bf16 v[204:207], v[32:35], v[88:91], v[204:207]
  ds_read_b64_tr_b16 v[44:45], v11 offset:24576
  ds_read_b64_tr_b16 v[46:47], v11 offset:25600
  v_exp_f32 v97, v97
  v_fma_f32 v99, v99, v19, v18
  v_mfma_f32_16x16x32_bf16 v[188:191], v[32:35], v[84:87], v[188:191]
  ds_read_b32 v246, v244
  s_add_u32 m0, s36, 0
  s_nop 0
  buffer_load_dwordx4 v7, s[16:19], s57 offen lds
  v_mul_f32 v98, v98, v74
  s_waitcnt lgkmcnt(5)
  v_mfma_f32_16x16x32_bf16 v[208:211], v[36:39], v[88:91], v[208:211]
  ds_read_b64_tr_b16 v[32:33], v8 offset:32768
  ds_read_b64_tr_b16 v[34:35], v8 offset:33792
  v_rcp_f32 v95, v95
  v_add_f32 v96, 1.0, v96
  v_mfma_f32_16x16x32_bf16 v[192:195], v[36:39], v[84:87], v[192:195]
  ds_read_b64 v[248:249], v245 offset:0
  v_mul_f32 v94, v94, v70
  v_mul_f32 v93, v77, v77
  s_waitcnt lgkmcnt(6)
  v_mfma_f32_16x16x32_bf16 v[212:215], v[40:43], v[88:91], v[212:215]
  ds_read_b64_tr_b16 v[36:37], v9 offset:32768
  ds_read_b64_tr_b16 v[38:39], v9 offset:33792
  v_exp_f32 v98, v98
  v_fma_f32 v92, v92, v19, v18
  v_mfma_f32_16x16x32_bf16 v[196:199], v[40:43], v[84:87], v[196:199]
  ds_read_b64 v[250:251], v245 offset:32
  v_mul_f32 v99, v99, v75
  v_rcp_f32 v96, v96
  s_waitcnt lgkmcnt(7)
  v_mfma_f32_16x16x32_bf16 v[216:219], v[44:47], v[88:91], v[216:219]
  ds_read_b64_tr_b16 v[40:41], v10 offset:32768
  ds_read_b64_tr_b16 v[42:43], v10 offset:33792
  v_add_f32 v97, 1.0, v97
  v_mul_f32 v95, v95, v71
  v_cvt_pk_bf16_f32 v117, v94, v95
  v_mfma_f32_16x16x32_bf16 v[200:203], v[44:47], v[84:87], v[200:203]
  s_waitcnt lgkmcnt(8)
  v_and_b32 v246, s90, v246
  s_add_u32 m0, s36, 8192
  s_nop 0
  buffer_load_dwordx4 v1, s[16:19], s64 offen lds
  v_mul_f32 v94, v78, v78
  s_waitcnt lgkmcnt(6)
  v_mfma_f32_16x16x32_bf16 v[172:175], v[32:35], v[128:131], v[172:175]
  ds_read_b64_tr_b16 v[44:45], v11 offset:32768
  ds_read_b64_tr_b16 v[46:47], v11 offset:33792
  v_exp_f32 v99, v99
  v_mfma_f32_16x16x32_bf16 v[156:159], v[32:35], v[124:127], v[156:159]
  s_waitcnt lgkmcnt(7)
  v_lshlrev_b32 v236, 16, v248
  v_fma_f32 v93, v93, v19, v18
  v_mul_f32 v92, v92, v76
  s_waitcnt lgkmcnt(5)
  v_mfma_f32_16x16x32_bf16 v[176:179], v[36:39], v[128:131], v[176:179]
  ds_read_b64_tr_b16 v[32:33], v8 offset:40960
  ds_read_b64_tr_b16 v[34:35], v8 offset:41984
  v_rcp_f32 v97, v97
  v_add_f32 v98, 1.0, v98
  v_mul_f32 v96, v96, v72
  v_mfma_f32_16x16x32_bf16 v[160:163], v[36:39], v[124:127], v[160:163]
  v_and_b32 v237, s90, v248
  v_mul_f32 v95, v79, v79
  v_exp_f32 v92, v92
  s_waitcnt lgkmcnt(4)
  v_mfma_f32_16x16x32_bf16 v[180:183], v[40:43], v[128:131], v[180:183]
  ds_read_b64_tr_b16 v[36:37], v9 offset:40960
  ds_read_b64_tr_b16 v[38:39], v9 offset:41984
  v_fma_f32 v94, v94, v19, v18
  v_mul_f32 v93, v93, v77
  v_mfma_f32_16x16x32_bf16 v[164:167], v[40:43], v[124:127], v[164:167]
  v_lshlrev_b32 v238, 16, v249
  v_rcp_f32 v98, v98
  v_add_f32 v99, 1.0, v99
  s_waitcnt lgkmcnt(4)
  v_mfma_f32_16x16x32_bf16 v[184:187], v[44:47], v[128:131], v[184:187]
  ds_read_b64_tr_b16 v[40:41], v10 offset:40960
  ds_read_b64_tr_b16 v[42:43], v10 offset:41984
  v_mul_f32 v97, v97, v73
  v_cvt_pk_bf16_f32 v118, v96, v97
  v_mul_f32 v96, v80, v80
  v_mfma_f32_16x16x32_bf16 v[168:171], v[44:47], v[124:127], v[168:171]
  v_and_b32 v239, s90, v249
  v_exp_f32 v93, v93
  v_fma_f32 v95, v95, v19, v18
  s_waitcnt lgkmcnt(4)
  v_mfma_f32_16x16x32_bf16 v[204:207], v[32:35], v[128:131], v[204:207]
  ds_read_b64_tr_b16 v[44:45], v11 offset:40960
  ds_read_b64_tr_b16 v[46:47], v11 offset:41984
  v_mfma_f32_16x16x32_bf16 v[188:191], v[32:35], v[124:127], v[188:191]
  s_waitcnt vmcnt(5)
  s_barrier
  v_mov_b32 v31, 2
  s_mov_b64 exec, 1
  buffer_store_dword v31, off, s[28:31], 0 sc1
  s_mov_b64 exec, -1
  s_waitcnt lgkmcnt(4)
  v_mfma_f32_16x16x32_bf16 v[208:211], v[36:39], v[128:131], v[208:211]
  ds_read_b64_tr_b16 v[32:33], v8 offset:49152
  ds_read_b64_tr_b16 v[34:35], v8 offset:50176
  v_mul_f32 v94, v94, v78
  v_mfma_f32_16x16x32_bf16 v[192:195], v[36:39], v[124:127], v[192:195]
  v_mul_f32 v236, v246, v236
  s_add_u32 m0, s36, 16384
  s_nop 0
  buffer_load_dwordx4 v7, s[16:19], s58 offen lds
  v_rcp_f32 v99, v99
  v_add_f32 v92, 1.0, v92
  s_waitcnt lgkmcnt(4)
  v_mfma_f32_16x16x32_bf16 v[212:215], v[40:43], v[128:131], v[212:215]
  ds_read_b64_tr_b16 v[36:37], v9 offset:49152
  ds_read_b64_tr_b16 v[38:39], v9 offset:50176
  v_mul_f32 v98, v98, v74
  v_mul_f32 v97, v81, v81
  v_mfma_f32_16x16x32_bf16 v[196:199], v[40:43], v[124:127], v[196:199]
  v_mul_f32 v237, v246, v237
  v_exp_f32 v94, v94
  v_fma_f32 v96, v96, v19, v18
  s_waitcnt vmcnt(5)
  v_cmp_gt_u32 vcc, 1, v29
  s_nop 2
  s_and_b32 vcc_lo, vcc_lo, s62
  s_cbranch_scc1 SPIN_mh0
BACK_mh0:
  s_add_u32 s43, s60, 0
  buffer_load_dwordx4 v[140:143], v5, s[52:55], s43 offen offset:0 sc1
  s_waitcnt lgkmcnt(4)
  v_mfma_f32_16x16x32_bf16 v[216:219], v[44:47], v[128:131], v[216:219]
  ds_read_b64_tr_b16 v[40:41], v10 offset:49152
  ds_read_b64_tr_b16 v[42:43], v10 offset:50176
  v_mul_f32 v95, v95, v79
  v_rcp_f32 v92, v92
  v_mfma_f32_16x16x32_bf16 v[200:203], v[44:47], v[124:127], v[200:203]
  v_mul_f32 v238, v246, v238
  v_add_f32 v93, 1.0, v93
  v_mul_f32 v99, v99, v75
  v_cvt_pk_bf16_f32 v119, v98, v99
  s_waitcnt lgkmcnt(4)
  v_mfma_f32_16x16x32_bf16 v[172:175], v[32:35], v[136:139], v[172:175]
  ds_read_b64_tr_b16 v[44:45], v11 offset:49152
  ds_read_b64_tr_b16 v[46:47], v11 offset:50176
  v_mul_f32 v98, v82, v82
  v_mfma_f32_16x16x32_bf16 v[156:159], v[32:35], v[132:135], v[156:159]
  v_mul_f32 v239, v246, v239
  s_add_u32 m0, s36, 24576
  s_nop 0
  buffer_load_dwordx4 v1, s[16:19], s65 offen lds
  v_exp_f32 v95, v95
  s_waitcnt lgkmcnt(4)
  v_mfma_f32_16x16x32_bf16 v[176:179], v[36:39], v[136:139], v[176:179]
  ds_read_b64_tr_b16 v[32:33], v8 offset:57344
  ds_read_b64_tr_b16 v[34:35], v8 offset:58368
  v_fma_f32 v97, v97, v19, v18
  v_mul_f32 v96, v96, v80
  v_mfma_f32_16x16x32_bf16 v[160:163], v[36:39], v[132:135], v[160:163]
  v_lshlrev_b32 v240, 16, v250
  v_rcp_f32 v93, v93
  v_add_f32 v94, 1.0, v94
  v_mul_f32 v92, v92, v76
  s_add_u32 s41, s60, 0
  buffer_load_dwordx4 v[144:147], v5, s[52:55], s41 offen offset:1024 sc1
  s_waitcnt lgkmcnt(4)
  v_mfma_f32_16x16x32_bf16 v[180:183], v[40:43], v[136:139], v[180:183]
  ds_read_b64_tr_b16 v[36:37], v9 offset:57344
  ds_read_b64_tr_b16 v[38:39], v9 offset:58368
  v_mul_f32 v99, v83, v83
  v_exp_f32 v96, v96
  v_mfma_f32_16x16x32_bf16 v[164:167], v[40:43], v[132:135], v[164:167]
  v_and_b32 v241, s90, v250
  v_fma_f32 v98, v98, v19, v18
  v_mul_f32 v97, v97, v81
  s_waitcnt lgkmcnt(4)
  v_mfma_f32_16x16x32_bf16 v[184:187], v[44:47], v[136:139], v[184:187]
  ds_read_b64_tr_b16 v[40:41], v10 offset:57344
  ds_read_b64_tr_b16 v[42:43], v10 offset:58368
  v_rcp_f32 v94, v94
  v_add_f32 v95, 1.0, v95
  v_mfma_f32_16x16x32_bf16 v[168:171], v[44:47], v[132:135], v[168:171]
  v_lshlrev_b32 v242, 16, v251
  s_add_u32 m0, s36, 32768
  s_add_u32 s42, s57, s75
  s_add_u32 s42, s42, 73728
  buffer_load_dwordx4 v7, s[16:19], s42 offen lds
  v_mul_f32 v93, v93, v77
  s_waitcnt lgkmcnt(4)
  v_mfma_f32_16x16x32_bf16 v[204:207], v[32:35], v[136:139], v[204:207]
  ds_read_b64_tr_b16 v[44:45], v11 offset:57344
  ds_read_b64_tr_b16 v[46:47], v11 offset:58368
  v_cvt_pk_bf16_f32 v120, v92, v93
  v_exp_f32 v97, v97
  v_mfma_f32_16x16x32_bf16 v[188:191], v[32:35], v[132:135], v[188:191]
  v_and_b32 v243, s90, v251
  v_fma_f32 v99, v99, v19, v18
  v_mul_f32 v98, v98, v82
  s_add_u32 s43, s61, 0
  buffer_load_dwordx4 v[148:151], v5, s[52:55], s43 offen offset:0 sc1
  s_waitcnt lgkmcnt(4)
  v_mfma_f32_16x16x32_bf16 v[208:211], v[36:39], v[136:139], v[208:211]
  v_add_u32 v8, 0x18000, v8
  ds_read_b64_tr_b16 v[32:33], v8 offset:8192
  ds_read_b64_tr_b16 v[34:35], v8 offset:9216
  v_rcp_f32 v95, v95
  v_add_f32 v96, 1.0, v96
  v_mul_f32 v94, v94, v78
  v_mfma_f32_16x16x32_bf16 v[192:195], v[36:39], v[132:135], v[192:195]
  v_mul_f32 v240, v246, v240
  v_exp_f32 v98, v98
  s_waitcnt lgkmcnt(4)
  v_mfma_f32_16x16x32_bf16 v[212:215], v[40:43], v[136:139], v[212:215]
  v_add_u32 v9, 0x18000, v9
  ds_read_b64_tr_b16 v[36:37], v9 offset:8192
  ds_read_b64_tr_b16 v[38:39], v9 offset:9216
  v_mul_f32 v99, v99, v83
  v_rcp_f32 v96, v96
  v_mfma_f32_16x16x32_bf16 v[196:199], v[40:43], v[132:135], v[196:199]
  v_mul_f32 v241, v246, v241
  v_add_f32 v97, 1.0, v97
  v_mul_f32 v95, v95, v79
  v_cvt_pk_bf16_f32 v121, v94, v95
  s_waitcnt lgkmcnt(4)
  v_mfma_f32_16x16x32_bf16 v[216:219], v[44:47], v[136:139], v[216:219]
  v_add_u32 v10, 0x18000, v10
  ds_read_b64_tr_b16 v[40:41], v10 offset:8192
  ds_read_b64_tr_b16 v[42:43], v10 offset:9216
  v_exp_f32 v99, v99
  v_mfma_f32_16x16x32_bf16 v[200:203], v[44:47], v[132:135], v[200:203]
  v_mul_f32 v242, v246, v242
  v_rcp_f32 v97, v97
  v_add_f32 v98, 1.0, v98
  s_add_u32 s40, s61, 0
  buffer_load_dwordx4 v[152:155], v5, s[52:55], s40 offen offset:1024 sc1
  s_waitcnt lgkmcnt(4)
  v_mfma_f32_16x16x32_bf16 v[172:175], v[32:35], v[112:115], v[172:175]
  v_add_u32 v11, 0x18000, v11
  ds_read_b64_tr_b16 v[44:45], v11 offset:8192
  ds_read_b64_tr_b16 v[46:47], v11 offset:9216
  v_mfma_f32_16x16x32_bf16 v[156:159], v[32:35], v[108:111], v[156:159]
  s_barrier
  s_waitcnt lgkmcnt(4)
  v_mfma_f32_16x16x32_bf16 v[176:179], v[36:39], v[112:115], v[176:179]
  ds_read_b64_tr_b16 v[32:33], v8 offset:16384
  ds_read_b64_tr_b16 v[34:35], v8 offset:17408
  v_mul_f32 v96, v96, v80
  v_rcp_f32 v98, v98
  v_mfma_f32_16x16x32_bf16 v[160:163], v[36:39], v[108:111], v[160:163]
  v_mul_f32 v243, v246, v243
  s_add_u32 m0, s36, 40960
  s_add_u32 s41, s64, s75
  s_add_u32 s41, s41, 73728
  buffer_load_dwordx4 v1, s[16:19], s41 offen lds
  v_add_f32 v99, 1.0, v99
  s_waitcnt lgkmcnt(4)
  v_mfma_f32_16x16x32_bf16 v[180:183], v[40:43], v[112:115], v[180:183]
  ds_read_b64_tr_b16 v[36:37], v9 offset:16384
  ds_read_b64_tr_b16 v[38:39], v9 offset:17408
  v_mul_f32 v97, v97, v81
  v_cvt_pk_bf16_f32 v122, v96, v97
  v_mfma_f32_16x16x32_bf16 v[164:167], v[40:43], v[108:111], v[164:167]
  v_rcp_f32 v99, v99
  v_mul_f32 v98, v98, v82
  v_mul_f32 v99, v99, v83
  s_add_u32 s42, s60, 6144
  buffer_load_dwordx4 v[252:255], v5, s[52:55], s42 offen offset:0 sc1
  s_waitcnt lgkmcnt(4)
  v_mfma_f32_16x16x32_bf16 v[184:187], v[44:47], v[112:115], v[184:187]
  ds_read_b64_tr_b16 v[40:41], v10 offset:16384
  ds_read_b64_tr_b16 v[42:43], v10 offset:17408
  v_cvt_pk_bf16_f32 v123, v98, v99
  v_permlane16_swap_b32 v116, v120
  v_mfma_f32_16x16x32_bf16 v[168:171], v[44:47], v[108:111], v[168:171]
  v_permlane16_swap_b32 v117, v121
  v_permlane16_swap_b32 v118, v122
  v_permlane16_swap_b32 v119, v123
  s_waitcnt lgkmcnt(4)
  v_mfma_f32_16x16x32_bf16 v[204:207], v[32:35], v[112:115], v[204:207]
  ds_read_b64_tr_b16 v[44:45], v11 offset:16384
  ds_read_b64_tr_b16 v[46:47], v11 offset:17408
  v_mfma_f32_16x16x32_bf16 v[188:191], v[32:35], v[108:111], v[188:191]
  s_add_u32 s43, s59, 10240
  buffer_store_dwordx4 v[116:119], v5, s[52:55], s43 offen offset:0 sc1
  s_add_u32 m0, s36, 49152
  s_add_u32 s40, s58, s75
  s_add_u32 s40, s40, 73728
  buffer_load_dwordx4 v7, s[16:19], s40 offen lds
  s_waitcnt lgkmcnt(4)
  v_mfma_f32_16x16x32_bf16 v[208:211], v[36:39], v[112:115], v[208:211]
  ds_read_b64_tr_b16 v[32:33], v10 offset:24576
  ds_read_b64_tr_b16 v[34:35], v10 offset:25600
  v_mfma_f32_16x16x32_bf16 v[192:195], v[36:39], v[108:111], v[192:195]
  s_add_u32 s41, s60, 6144
  buffer_load_dwordx4 v[12:15], v5, s[52:55], s41 offen offset:1024 sc1
  s_waitcnt lgkmcnt(4)
  v_mfma_f32_16x16x32_bf16 v[212:215], v[40:43], v[112:115], v[212:215]
  ds_read_b64_tr_b16 v[36:37], v11 offset:24576
  ds_read_b64_tr_b16 v[38:39], v11 offset:25600
  v_mfma_f32_16x16x32_bf16 v[196:199], v[40:43], v[108:111], v[196:199]
  s_waitcnt lgkmcnt(4)
  v_mfma_f32_16x16x32_bf16 v[216:219], v[44:47], v[112:115], v[216:219]
  ds_read_b64_tr_b16 v[40:41], v8 offset:24576
  ds_read_b64_tr_b16 v[42:43], v8 offset:25600
  v_mfma_f32_16x16x32_bf16 v[200:203], v[44:47], v[108:111], v[200:203]
  s_add_u32 m0, s36, 57344
  s_add_u32 s42, s65, s75
  s_add_u32 s42, s42, 73728
  buffer_load_dwordx4 v1, s[16:19], s42 offen lds
  s_waitcnt lgkmcnt(4)
  v_mfma_f32_16x16x32_bf16 v[228:231], v[32:35], v[104:107], 0
  ds_read_b64_tr_b16 v[44:45], v9 offset:24576
  ds_read_b64_tr_b16 v[46:47], v9 offset:25600
  v_mfma_f32_16x16x32_bf16 v[220:223], v[32:35], v[100:103], 0
  s_add_u32 s43, s59, 10240
  buffer_store_dwordx4 v[120:123], v5, s[52:55], s43 offen offset:1024 sc1
  s_sub_u32 s100, s68, s67
  s_sub_u32 s100, s100, 512
  v_lshrrev_b32 v6, 5, v0
  v_mul_lo_u32 v6, v6, s100
  s_add_u32 s40, s61, 6144
  buffer_load_dwordx4 v[52:55], v5, s[52:55], s40 offen offset:0 sc1
  s_waitcnt lgkmcnt(4)
  v_mfma_f32_16x16x32_bf16 v[232:235], v[36:39], v[104:107], 0
  ds_read_b64_tr_b16 v[32:33], v10 offset:32768
  ds_read_b64_tr_b16 v[34:35], v10 offset:33792
  v_mfma_f32_16x16x32_bf16 v[224:227], v[36:39], v[100:103], 0
  v_add3_u32 v6, v6, v5, s67
  s_waitcnt lgkmcnt(4)
  v_mfma_f32_16x16x32_bf16 v[244:247], v[40:43], v[104:107], 0
  ds_read_b64_tr_b16 v[36:37], v11 offset:32768
  ds_read_b64_tr_b16 v[38:39], v11 offset:33792
  v_mfma_f32_16x16x32_bf16 v[236:239], v[40:43], v[100:103], v[236:239]
  s_waitcnt lgkmcnt(4)
  v_mfma_f32_16x16x32_bf16 v[248:251], v[44:47], v[104:107], 0
  ds_read_b64_tr_b16 v[40:41], v8 offset:32768
  ds_read_b64_tr_b16 v[42:43], v8 offset:33792
  v_mfma_f32_16x16x32_bf16 v[240:243], v[44:47], v[100:103], v[240:243]
  s_add_u32 s41, s61, 6144
  buffer_load_dwordx4 v[56:59], v5, s[52:55], s41 offen offset:1024 sc1
  s_waitcnt lgkmcnt(4)
  v_mfma_f32_16x16x32_bf16 v[228:231], v[32:35], v[88:91], v[228:231]
  ds_read_b64_tr_b16 v[44:45], v9 offset:32768
  ds_read_b64_tr_b16 v[46:47], v9 offset:33792
  v_mfma_f32_16x16x32_bf16 v[220:223], v[32:35], v[84:87], v[220:223]
  s_waitcnt vmcnt(19)
  s_barrier
  s_waitcnt lgkmcnt(4)
  v_mfma_f32_16x16x32_bf16 v[232:235], v[36:39], v[88:91], v[232:235]
  ds_read_b64_tr_b16 v[32:33], v10 offset:40960
  ds_read_b64_tr_b16 v[34:35], v10 offset:41984
  v_mfma_f32_16x16x32_bf16 v[224:227], v[36:39], v[84:87], v[224:227]
  s_add_u32 m0, s36, 106496
  s_add_u32 s42, s57, 73728
  buffer_load_dwordx4 v7, s[16:19], s42 offen lds
  s_waitcnt lgkmcnt(4)
  v_mfma_f32_16x16x32_bf16 v[244:247], v[40:43], v[88:91], v[244:247]
  ds_read_b64_tr_b16 v[36:37], v11 offset:40960
  ds_read_b64_tr_b16 v[38:39], v11 offset:41984
  v_mfma_f32_16x16x32_bf16 v[236:239], v[40:43], v[84:87], v[236:239]
  s_mov_b64 exec, 0x7
  buffer_load_dword v29, v2, s[32:35], 0 offen sc1
  s_mov_b64 exec, -1
  s_waitcnt lgkmcnt(4)
  v_mfma_f32_16x16x32_bf16 v[248:251], v[44:47], v[88:91], v[248:251]
  ds_read_b64_tr_b16 v[40:41], v8 offset:40960
  ds_read_b64_tr_b16 v[42:43], v8 offset:41984
  v_mfma_f32_16x16x32_bf16 v[240:243], v[44:47], v[84:87], v[240:243]
  s_waitcnt lgkmcnt(4)
  v_mfma_f32_16x16x32_bf16 v[228:231], v[32:35], v[128:131], v[228:231]
  ds_read_b64_tr_b16 v[44:45], v9 offset:40960
  ds_read_b64_tr_b16 v[46:47], v9 offset:41984
  v_mfma_f32_16x16x32_bf16 v[220:223], v[32:35], v[124:127], v[220:223]
  s_add_u32 m0, s36, 114688
  s_add_u32 s43, s64, 73728
  buffer_load_dwordx4 v1, s[16:19], s43 offen lds
  s_waitcnt lgkmcnt(4)
  v_mfma_f32_16x16x32_bf16 v[232:235], v[36:39], v[128:131], v[232:235]
  ds_read_b64_tr_b16 v[32:33], v8 offset:49152
  ds_read_b64_tr_b16 v[34:35], v8 offset:50176
  v_mfma_f32_16x16x32_bf16 v[224:227], v[36:39], v[124:127], v[224:227]
  s_waitcnt lgkmcnt(4)
  v_mfma_f32_16x16x32_bf16 v[244:247], v[40:43], v[128:131], v[244:247]
  ds_read_b64_tr_b16 v[36:37], v9 offset:49152
  ds_read_b64_tr_b16 v[38:39], v9 offset:50176
  v_mfma_f32_16x16x32_bf16 v[236:239], v[40:43], v[124:127], v[236:239]
  s_waitcnt lgkmcnt(4)
  v_mfma_f32_16x16x32_bf16 v[248:251], v[44:47], v[128:131], v[248:251]
  ds_read_b64_tr_b16 v[40:41], v10 offset:49152
  ds_read_b64_tr_b16 v[42:43], v10 offset:50176
  v_mfma_f32_16x16x32_bf16 v[240:243], v[44:47], v[124:127], v[240:243]
  s_add_u32 m0, s36, 122880
  s_add_u32 s40, s58, 73728
  buffer_load_dwordx4 v7, s[16:19], s40 offen lds
  s_waitcnt lgkmcnt(4)
  v_mfma_f32_16x16x32_bf16 v[172:175], v[32:35], v[120:123], v[172:175]
  ds_read_b64_tr_b16 v[44:45], v11 offset:49152
  ds_read_b64_tr_b16 v[46:47], v11 offset:50176
  v_mfma_f32_16x16x32_bf16 v[156:159], v[32:35], v[116:119], v[156:159]
  s_waitcnt lgkmcnt(4)
  v_mfma_f32_16x16x32_bf16 v[176:179], v[36:39], v[120:123], v[176:179]
  ds_read_b64_tr_b16 v[32:33], v8 offset:0
  ds_read_b64_tr_b16 v[34:35], v8 offset:1024
  v_mfma_f32_16x16x32_bf16 v[160:163], v[36:39], v[116:119], v[160:163]
  s_waitcnt lgkmcnt(4)
  v_mfma_f32_16x16x32_bf16 v[180:183], v[40:43], v[120:123], v[180:183]
  ds_read_b64_tr_b16 v[36:37], v9 offset:0
  ds_read_b64_tr_b16 v[38:39], v9 offset:1024
  v_mfma_f32_16x16x32_bf16 v[164:167], v[40:43], v[116:119], v[164:167]
  s_waitcnt lgkmcnt(4)
  v_mfma_f32_16x16x32_bf16 v[184:187], v[44:47], v[120:123], v[184:187]
  ds_read_b64_tr_b16 v[40:41], v10 offset:0
  ds_read_b64_tr_b16 v[42:43], v10 offset:1024
  v_mfma_f32_16x16x32_bf16 v[168:171], v[44:47], v[116:119], v[168:171]
  s_waitcnt lgkmcnt(4)
  v_mfma_f32_16x16x32_bf16 v[204:207], v[32:35], v[120:123], v[204:207]
  ds_read_b64_tr_b16 v[44:45], v11 offset:0
  ds_read_b64_tr_b16 v[46:47], v11 offset:1024
  v_mfma_f32_16x16x32_bf16 v[188:191], v[32:35], v[116:119], v[188:191]
  s_waitcnt vmcnt(6)
  s_barrier
  v_mov_b32 v31, 3
  s_mov_b64 exec, 1
  buffer_store_dword v31, off, s[28:31], 0 sc1
  s_mov_b64 exec, -1
  s_waitcnt lgkmcnt(4)
  v_mfma_f32_16x16x32_bf16 v[208:211], v[36:39], v[120:123], v[208:211]
  v_add_u32 v8, 0xfffe8000, v8
  ds_read_b64_tr_b16 v[32:33], v8 offset:0
  ds_read_b64_tr_b16 v[34:35], v8 offset:1024
  v_mfma_f32_16x16x32_bf16 v[192:195], v[36:39], v[116:119], v[192:195]
  s_add_u32 m0, s36, 131072
  s_add_u32 s41, s65, 73728
  buffer_load_dwordx4 v1, s[16:19], s41 offen lds
  s_waitcnt lgkmcnt(4)
  v_mfma_f32_16x16x32_bf16 v[212:215], v[40:43], v[120:123], v[212:215]
  v_add_u32 v9, 0xfffe8000, v9
  ds_read_b64_tr_b16 v[36:37], v9 offset:0
  ds_read_b64_tr_b16 v[38:39], v9 offset:1024
  v_mfma_f32_16x16x32_bf16 v[196:199], v[40:43], v[116:119], v[196:199]
  s_waitcnt lgkmcnt(4)
  v_mfma_f32_16x16x32_bf16 v[216:219], v[44:47], v[120:123], v[216:219]
  v_add_u32 v10, 0xfffe8000, v10
  ds_read_b64_tr_b16 v[40:41], v10 offset:0
  ds_read_b64_tr_b16 v[42:43], v10 offset:1024
  v_mfma_f32_16x16x32_bf16 v[200:203], v[44:47], v[116:119], v[200:203]
  s_waitcnt vmcnt(4)
  v_cmp_gt_u32 vcc, 2, v29
  s_nop 2
  s_and_b32 vcc_lo, vcc_lo, s62
  s_cbranch_scc1 SPIN_mh1
BACK_mh1:
  s_add_u32 s42, s60, 2048
  buffer_load_dwordx4 v[60:63], v5, s[52:55], s42 offen offset:0 sc1
  s_waitcnt lgkmcnt(4)
  v_mfma_f32_16x16x32_bf16 v[172:175], v[32:35], v[144:147], v[172:175]
  v_add_u32 v11, 0xfffe8000, v11
  ds_read_b64_tr_b16 v[44:45], v11 offset:0
  ds_read_b64_tr_b16 v[46:47], v11 offset:1024
  v_mfma_f32_16x16x32_bf16 v[156:159], v[32:35], v[140:143], v[156:159]
  s_add_u32 m0, s36, 139264
  s_add_u32 s43, s57, s75
  buffer_load_dwordx4 v7, s[16:19], s43 offen lds
  s_waitcnt lgkmcnt(4)
  v_mfma_f32_16x16x32_bf16 v[176:179], v[36:39], v[144:147], v[176:179]
  ds_read_b64_tr_b16 v[32:33], v8 offset:8192
  ds_read_b64_tr_b16 v[34:35], v8 offset:9216
  v_mfma_f32_16x16x32_bf16 v[160:163], v[36:39], v[140:143], v[160:163]
  s_waitcnt lgkmcnt(4)
  v_mfma_f32_16x16x32_bf16 v[180:183], v[40:43], v[144:147], v[180:183]
  ds_read_b64_tr_b16 v[36:37], v9 offset:8192
  ds_read_b64_tr_b16 v[38:39], v9 offset:9216
  v_mfma_f32_16x16x32_bf16 v[164:167], v[40:43], v[140:143], v[164:167]
  s_add_u32 s40, s60, 2048
  buffer_load_dwordx4 v[64:67], v5, s[52:55], s40 offen offset:1024 sc1
  s_waitcnt lgkmcnt(4)
  v_mfma_f32_16x16x32_bf16 v[184:187], v[44:47], v[144:147], v[184:187]
  ds_read_b64_tr_b16 v[40:41], v10 offset:8192
  ds_read_b64_tr_b16 v[42:43], v10 offset:9216
  v_mfma_f32_16x16x32_bf16 v[168:171], v[44:47], v[140:143], v[168:171]
  s_add_u32 m0, s36, 147456
  s_add_u32 s41, s64, s75
  buffer_load_dwordx4 v1, s[16:19], s41 offen lds
  s_waitcnt lgkmcnt(4)
  v_mfma_f32_16x16x32_bf16 v[204:207], v[32:35], v[144:147], v[204:207]
  ds_read_b64_tr_b16 v[44:45], v11 offset:8192
  ds_read_b64_tr_b16 v[46:47], v11 offset:9216
  v_mfma_f32_16x16x32_bf16 v[188:191], v[32:35], v[140:143], v[188:191]
  s_waitcnt lgkmcnt(4)
  v_mfma_f32_16x16x32_bf16 v[208:211], v[36:39], v[144:147], v[208:211]
  ds_read_b64_tr_b16 v[32:33], v8 offset:16384
  ds_read_b64_tr_b16 v[34:35], v8 offset:17408
  v_mfma_f32_16x16x32_bf16 v[192:195], v[36:39], v[140:143], v[192:195]
  s_add_u32 s42, s61, 2048
  buffer_load_dwordx4 v[20:23], v5, s[52:55], s42 offen offset:0 sc1
  s_waitcnt lgkmcnt(4)
  v_mfma_f32_16x16x32_bf16 v[212:215], v[40:43], v[144:147], v[212:215]
  ds_read_b64_tr_b16 v[36:37], v9 offset:16384
  ds_read_b64_tr_b16 v[38:39], v9 offset:17408
  v_mfma_f32_16x16x32_bf16 v[196:199], v[40:43], v[140:143], v[196:199]
  s_waitcnt lgkmcnt(4)
  v_mfma_f32_16x16x32_bf16 v[216:219], v[44:47], v[144:147], v[216:219]
  ds_read_b64_tr_b16 v[40:41], v10 offset:16384
  ds_read_b64_tr_b16 v[42:43], v10 offset:17408
  v_mfma_f32_16x16x32_bf16 v[200:203], v[44:47], v[140:143], v[200:203]
  s_waitcnt lgkmcnt(4)
  v_mfma_f32_16x16x32_bf16 v[172:175], v[32:35], v[152:155], v[172:175]
  ds_read_b64_tr_b16 v[44:45], v11 offset:16384
  ds_read_b64_tr_b16 v[46:47], v11 offset:17408
  v_mfma_f32_16x16x32_bf16 v[156:159], v[32:35], v[148:151], v[156:159]
  s_barrier
  s_waitcnt lgkmcnt(4)
  v_mfma_f32_16x16x32_bf16 v[176:179], v[36:39], v[152:155], v[176:179]
  ds_read_b64_tr_b16 v[32:33], v8 offset:24576
  ds_read_b64_tr_b16 v[34:35], v8 offset:25600
  v_mfma_f32_16x16x32_bf16 v[160:163], v[36:39], v[148:151], v[160:163]
  s_add_u32 m0, s36, 98304
  s_add_u32 s43, s58, s75
  buffer_load_dwordx4 v7, s[16:19], s43 offen lds
  s_waitcnt lgkmcnt(4)
  v_mfma_f32_16x16x32_bf16 v[180:183], v[40:43], v[152:155], v[180:183]
  ds_read_b64_tr_b16 v[36:37], v9 offset:24576
  ds_read_b64_tr_b16 v[38:39], v9 offset:25600
  v_mfma_f32_16x16x32_bf16 v[164:167], v[40:43], v[148:151], v[164:167]
  s_add_u32 s40, s61, 2048
  buffer_load_dwordx4 v[24:27], v5, s[52:55], s40 offen offset:1024 sc1
  s_waitcnt lgkmcnt(4)
  v_mfma_f32_16x16x32_bf16 v[184:187], v[44:47], v[152:155], v[184:187]
  ds_read_b64_tr_b16 v[40:41], v10 offset:24576
  ds_read_b64_tr_b16 v[42:43], v10 offset:25600
  v_mfma_f32_16x16x32_bf16 v[168:171], v[44:47], v[148:151], v[168:171]
  s_waitcnt lgkmcnt(4)
  v_mfma_f32_16x16x32_bf16 v[204:207], v[32:35], v[152:155], v[204:207]
  ds_read_b64_tr_b16 v[44:45], v11 offset:24576
  ds_read_b64_tr_b16 v[46:47], v11 offset:25600
  v_mfma_f32_16x16x32_bf16 v[188:191], v[32:35], v[148:151], v[188:191]
  s_add_u32 m0, s36, 0
  s_add_u32 s41, s65, s75
  buffer_load_dwordx4 v1, s[16:19], s41 offen lds
  s_waitcnt lgkmcnt(4)
  v_mfma_f32_16x16x32_bf16 v[208:211], v[36:39], v[152:155], v[208:211]
  ds_read_b64_tr_b16 v[32:33], v8 offset:32768
  ds_read_b64_tr_b16 v[34:35], v8 offset:33792
  v_mfma_f32_16x16x32_bf16 v[192:195], v[36:39], v[148:151], v[192:195]
  s_add_u32 s42, s60, 4096
  buffer_load_dwordx4 v[68:71], v5, s[52:55], s42 offen offset:0 sc1
  s_waitcnt lgkmcnt(4)
  v_mfma_f32_16x16x32_bf16 v[212:215], v[40:43], v[152:155], v[212:215]
  ds_read_b64_tr_b16 v[36:37], v9 offset:32768
  ds_read_b64_tr_b16 v[38:39], v9 offset:33792
  v_mfma_f32_16x16x32_bf16 v[196:199], v[40:43], v[148:151], v[196:199]
  s_waitcnt lgkmcnt(4)
  v_mfma_f32_16x16x32_bf16 v[216:219], v[44:47], v[152:155], v[216:219]
  ds_read_b64_tr_b16 v[40:41], v10 offset:32768
  ds_read_b64_tr_b16 v[42:43], v10 offset:33792
  v_mfma_f32_16x16x32_bf16 v[200:203], v[44:47], v[148:151], v[200:203]
  s_add_u32 m0, s36, 8192
  s_add_u32 s43, s57, s94
  buffer_load_dwordx4 v7, s[16:19], s43 offen lds
  s_waitcnt lgkmcnt(4)
  v_mfma_f32_16x16x32_bf16 v[172:175], v[32:35], v[12:15], v[172:175]
  ds_read_b64_tr_b16 v[44:45], v11 offset:32768
  ds_read_b64_tr_b16 v[46:47], v11 offset:33792
  v_mfma_f32_16x16x32_bf16 v[156:159], v[32:35], v[252:255], v[156:159]
  s_add_u32 s40, s60, 4096
  buffer_load_dwordx4 v[72:75], v5, s[52:55], s40 offen offset:1024 sc1
  s_waitcnt lgkmcnt(4)
  v_mfma_f32_16x16x32_bf16 v[176:179], v[36:39], v[12:15], v[176:179]
  ds_read_b64_tr_b16 v[32:33], v8 offset:40960
  ds_read_b64_tr_b16 v[34:35], v8 offset:41984
  v_mfma_f32_16x16x32_bf16 v[160:163], v[36:39], v[252:255], v[160:163]
  s_waitcnt lgkmcnt(4)
  v_mfma_f32_16x16x32_bf16 v[180:183], v[40:43], v[12:15], v[180:183]
  ds_read_b64_tr_b16 v[36:37], v9 offset:40960
  ds_read_b64_tr_b16 v[38:39], v9 offset:41984
  v_mfma_f32_16x16x32_bf16 v[164:167], v[40:43], v[252:255], v[164:167]
  s_waitcnt lgkmcnt(4)
  v_mfma_f32_16x16x32_bf16 v[184:187], v[44:47], v[12:15], v[184:187]
  ds_read_b64_tr_b16 v[40:41], v10 offset:40960
  ds_read_b64_tr_b16 v[42:43], v10 offset:41984
  v_mfma_f32_16x16x32_bf16 v[168:171], v[44:47], v[252:255], v[168:171]
  s_add_u32 s41, s61, 4096
  buffer_load_dwordx4 v[76:79], v5, s[52:55], s41 offen offset:0 sc1
  s_waitcnt lgkmcnt(4)
  v_mfma_f32_16x16x32_bf16 v[204:207], v[32:35], v[12:15], v[204:207]
  ds_read_b64_tr_b16 v[44:45], v11 offset:40960
  ds_read_b64_tr_b16 v[46:47], v11 offset:41984
  v_mfma_f32_16x16x32_bf16 v[188:191], v[32:35], v[252:255], v[188:191]
  s_barrier
  s_waitcnt lgkmcnt(4)
  v_mfma_f32_16x16x32_bf16 v[208:211], v[36:39], v[12:15], v[208:211]
  ds_read_b64_tr_b16 v[32:33], v8 offset:49152
  ds_read_b64_tr_b16 v[34:35], v8 offset:50176
  v_mfma_f32_16x16x32_bf16 v[192:195], v[36:39], v[252:255], v[192:195]
  s_add_u32 m0, s36, 16384
  s_add_u32 s42, s58, s94
  buffer_load_dwordx4 v7, s[16:19], s42 offen lds
  s_waitcnt lgkmcnt(4)
  v_mfma_f32_16x16x32_bf16 v[212:215], v[40:43], v[12:15], v[212:215]
  ds_read_b64_tr_b16 v[36:37], v9 offset:49152
  ds_read_b64_tr_b16 v[38:39], v9 offset:50176
  v_mfma_f32_16x16x32_bf16 v[196:199], v[40:43], v[252:255], v[196:199]
  s_add_u32 s43, s61, 4096
  buffer_load_dwordx4 v[80:83], v5, s[52:55], s43 offen offset:1024 sc1
  s_waitcnt lgkmcnt(4)
  v_mfma_f32_16x16x32_bf16 v[216:219], v[44:47], v[12:15], v[216:219]
  ds_read_b64_tr_b16 v[40:41], v10 offset:49152
  ds_read_b64_tr_b16 v[42:43], v10 offset:50176
  v_mfma_f32_16x16x32_bf16 v[200:203], v[44:47], v[252:255], v[200:203]
  s_waitcnt lgkmcnt(4)
  v_mfma_f32_16x16x32_bf16 v[172:175], v[32:35], v[56:59], v[172:175]
  ds_read_b64_tr_b16 v[44:45], v11 offset:49152
  ds_read_b64_tr_b16 v[46:47], v11 offset:50176
  v_mfma_f32_16x16x32_bf16 v[156:159], v[32:35], v[52:55], v[156:159]
  s_add_u32 m0, s36, 24576
  s_add_u32 s40, s57, s94
  s_add_u32 s40, s40, 73728
  buffer_load_dwordx4 v7, s[16:19], s40 offen lds
  s_waitcnt lgkmcnt(4)
  v_mfma_f32_16x16x32_bf16 v[176:179], v[36:39], v[56:59], v[176:179]
  ds_read_b64_tr_b16 v[32:33], v8 offset:57344
  ds_read_b64_tr_b16 v[34:35], v8 offset:58368
  v_mfma_f32_16x16x32_bf16 v[160:163], v[36:39], v[52:55], v[160:163]
  s_add_u32 s41, s60, 8192
  buffer_load_dwordx4 v[92:95], v5, s[52:55], s41 offen offset:0 sc1
  s_waitcnt lgkmcnt(4)
  v_mfma_f32_16x16x32_bf16 v[180:183], v[40:43], v[56:59], v[180:183]
  ds_read_b64_tr_b16 v[36:37], v9 offset:57344
  ds_read_b64_tr_b16 v[38:39], v9 offset:58368
  v_mfma_f32_16x16x32_bf16 v[164:167], v[40:43], v[52:55], v[164:167]
  s_waitcnt lgkmcnt(4)
  v_mfma_f32_16x16x32_bf16 v[184:187], v[44:47], v[56:59], v[184:187]
  ds_read_b64_tr_b16 v[40:41], v10 offset:57344
  ds_read_b64_tr_b16 v[42:43], v10 offset:58368
  v_mfma_f32_16x16x32_bf16 v[168:171], v[44:47], v[52:55], v[168:171]
  s_add_u32 m0, s36, 32768
  s_add_u32 s42, s58, s94
  s_add_u32 s42, s42, 73728
  buffer_load_dwordx4 v7, s[16:19], s42 offen lds
  s_waitcnt lgkmcnt(4)
  v_mfma_f32_16x16x32_bf16 v[204:207], v[32:35], v[56:59], v[204:207]
  ds_read_b64_tr_b16 v[44:45], v11 offset:57344
  ds_read_b64_tr_b16 v[46:47], v11 offset:58368
  v_mfma_f32_16x16x32_bf16 v[188:191], v[32:35], v[52:55], v[188:191]
  s_add_u32 s43, s60, 8192
  buffer_load_dwordx4 v[96:99], v5, s[52:55], s43 offen offset:1024 sc1
  s_waitcnt lgkmcnt(4)
  v_mfma_f32_16x16x32_bf16 v[208:211], v[36:39], v[56:59], v[208:211]
  v_add_u32 v8, 0x18000, v8
  ds_read_b64_tr_b16 v[32:33], v8 offset:8192
  ds_read_b64_tr_b16 v[34:35], v8 offset:9216
  v_mfma_f32_16x16x32_bf16 v[192:195], v[36:39], v[52:55], v[192:195]
  s_mov_b64 exec, 0x7
  buffer_load_dword v19, v2, s[32:35], 0 offen sc1
  s_mov_b64 exec, -1
  s_waitcnt lgkmcnt(4)
  v_mfma_f32_16x16x32_bf16 v[212:215], v[40:43], v[56:59], v[212:215]
  v_add_u32 v9, 0x18000, v9
  ds_read_b64_tr_b16 v[36:37], v9 offset:8192
  ds_read_b64_tr_b16 v[38:39], v9 offset:9216
  v_mfma_f32_16x16x32_bf16 v[196:199], v[40:43], v[52:55], v[196:199]
  s_waitcnt lgkmcnt(4)
  v_mfma_f32_16x16x32_bf16 v[216:219], v[44:47], v[56:59], v[216:219]
  v_add_u32 v10, 0x18000, v10
  ds_read_b64_tr_b16 v[40:41], v10 offset:8192
  ds_read_b64_tr_b16 v[42:43], v10 offset:9216
  v_mfma_f32_16x16x32_bf16 v[200:203], v[44:47], v[52:55], v[200:203]
  s_add_u32 s40, s61, 8192
  buffer_load_dwordx4 v[100:103], v5, s[52:55], s40 offen offset:0 sc1
  s_waitcnt vmcnt(17) lgkmcnt(4)
  v_mfma_f32_16x16x32_bf16 v[172:175], v[32:35], v[64:67], v[172:175]
  v_add_u32 v11, 0x18000, v11
  ds_read_b64_tr_b16 v[44:45], v11 offset:8192
  ds_read_b64_tr_b16 v[46:47], v11 offset:9216
  v_mfma_f32_16x16x32_bf16 v[156:159], v[32:35], v[60:63], v[156:159]
  s_barrier
  s_waitcnt lgkmcnt(4)
  v_mfma_f32_16x16x32_bf16 v[176:179], v[36:39], v[64:67], v[176:179]
  ds_read_b64_tr_b16 v[32:33], v8 offset:16384
  ds_read_b64_tr_b16 v[34:35], v8 offset:17408
  v_mfma_f32_16x16x32_bf16 v[160:163], v[36:39], v[60:63], v[160:163]
  s_add_u32 m0, s36, 40960
  s_add_u32 s41, s64, s94
  buffer_load_dwordx4 v1, s[16:19], s41 offen lds
  s_waitcnt lgkmcnt(4)
  v_mfma_f32_16x16x32_bf16 v[180:183], v[40:43], v[64:67], v[180:183]
  ds_read_b64_tr_b16 v[36:37], v9 offset:16384
  ds_read_b64_tr_b16 v[38:39], v9 offset:17408
  v_mfma_f32_16x16x32_bf16 v[164:167], v[40:43], v[60:63], v[164:167]
  s_add_u32 s42, s61, 8192
  buffer_load_dwordx4 v[104:107], v5, s[52:55], s42 offen offset:1024 sc1
  s_waitcnt lgkmcnt(4)
  v_mfma_f32_16x16x32_bf16 v[184:187], v[44:47], v[64:67], v[184:187]
  ds_read_b64_tr_b16 v[40:41], v10 offset:16384
  ds_read_b64_tr_b16 v[42:43], v10 offset:17408
  v_mfma_f32_16x16x32_bf16 v[168:171], v[44:47], v[60:63], v[168:171]
  s_waitcnt lgkmcnt(4)
  v_mfma_f32_16x16x32_bf16 v[204:207], v[32:35], v[64:67], v[204:207]
  ds_read_b64_tr_b16 v[44:45], v11 offset:16384
  ds_read_b64_tr_b16 v[46:47], v11 offset:17408
  v_mfma_f32_16x16x32_bf16 v[188:191], v[32:35], v[60:63], v[188:191]
  s_add_u32 m0, s36, 49152
  s_add_u32 s43, s65, s94
  buffer_load_dwordx4 v1, s[16:19], s43 offen lds
  s_waitcnt lgkmcnt(4)
  v_mfma_f32_16x16x32_bf16 v[208:211], v[36:39], v[64:67], v[208:211]
  ds_read_b64_tr_b16 v[32:33], v8 offset:24576
  ds_read_b64_tr_b16 v[34:35], v8 offset:25600
  v_mfma_f32_16x16x32_bf16 v[192:195], v[36:39], v[60:63], v[192:195]
  s_waitcnt lgkmcnt(4)
  v_mfma_f32_16x16x32_bf16 v[212:215], v[40:43], v[64:67], v[212:215]
  ds_read_b64_tr_b16 v[36:37], v9 offset:24576
  ds_read_b64_tr_b16 v[38:39], v9 offset:25600
  v_mfma_f32_16x16x32_bf16 v[196:199], v[40:43], v[60:63], v[196:199]
  s_waitcnt lgkmcnt(4)
  v_mfma_f32_16x16x32_bf16 v[216:219], v[44:47], v[64:67], v[216:219]
  ds_read_b64_tr_b16 v[40:41], v10 offset:24576
  ds_read_b64_tr_b16 v[42:43], v10 offset:25600
  v_mfma_f32_16x16x32_bf16 v[200:203], v[44:47], v[60:63], v[200:203]
  s_add_u32 m0, s36, 57344
  s_add_u32 s40, s64, s94
  s_add_u32 s40, s40, 73728
  buffer_load_dwordx4 v1, s[16:19], s40 offen lds
  s_waitcnt vmcnt(17) lgkmcnt(4)
  v_mfma_f32_16x16x32_bf16 v[172:175], v[32:35], v[24:27], v[172:175]
  ds_read_b64_tr_b16 v[44:45], v11 offset:24576
  ds_read_b64_tr_b16 v[46:47], v11 offset:25600
  v_mfma_f32_16x16x32_bf16 v[156:159], v[32:35], v[20:23], v[156:159]
  s_waitcnt lgkmcnt(4)
  v_mfma_f32_16x16x32_bf16 v[176:179], v[36:39], v[24:27], v[176:179]
  ds_read_b64_tr_b16 v[32:33], v8 offset:32768
  ds_read_b64_tr_b16 v[34:35], v8 offset:33792
  v_mfma_f32_16x16x32_bf16 v[160:163], v[36:39], v[20:23], v[160:163]
  s_waitcnt lgkmcnt(4)
  v_mfma_f32_16x16x32_bf16 v[180:183], v[40:43], v[24:27], v[180:183]
  ds_read_b64_tr_b16 v[36:37], v9 offset:32768
  ds_read_b64_tr_b16 v[38:39], v9 offset:33792
  v_mfma_f32_16x16x32_bf16 v[164:167], v[40:43], v[20:23], v[164:167]
  s_waitcnt lgkmcnt(4)
  v_mfma_f32_16x16x32_bf16 v[184:187], v[44:47], v[24:27], v[184:187]
  ds_read_b64_tr_b16 v[40:41], v10 offset:32768
  ds_read_b64_tr_b16 v[42:43], v10 offset:33792
  v_mfma_f32_16x16x32_bf16 v[168:171], v[44:47], v[20:23], v[168:171]
  s_waitcnt vmcnt(5)
  v_cmp_gt_u32 vcc, 3, v19
  s_nop 2
  s_and_b32 vcc_lo, vcc_lo, s62
  s_cbranch_scc1 SPIN_mh2
BACK_mh2:
  s_add_u32 s41, s60, 10240
  buffer_load_dwordx4 v[84:87], v5, s[52:55], s41 offen offset:0 sc1
  s_waitcnt lgkmcnt(4)
  v_mfma_f32_16x16x32_bf16 v[204:207], v[32:35], v[24:27], v[204:207]
  ds_read_b64_tr_b16 v[44:45], v11 offset:32768
  ds_read_b64_tr_b16 v[46:47], v11 offset:33792
  v_mfma_f32_16x16x32_bf16 v[188:191], v[32:35], v[20:23], v[188:191]
  s_barrier
  s_waitcnt lgkmcnt(4)
  v_mfma_f32_16x16x32_bf16 v[208:211], v[36:39], v[24:27], v[208:211]
  ds_read_b64_tr_b16 v[32:33], v8 offset:40960
  ds_read_b64_tr_b16 v[34:35], v8 offset:41984
  v_mfma_f32_16x16x32_bf16 v[192:195], v[36:39], v[20:23], v[192:195]
  s_add_u32 m0, s36, 106496
  s_add_u32 s42, s65, s94
  s_add_u32 s42, s42, 73728
  buffer_load_dwordx4 v1, s[16:19], s42 offen lds
  s_waitcnt lgkmcnt(4)
  v_mfma_f32_16x16x32_bf16 v[212:215], v[40:43], v[24:27], v[212:215]
  ds_read_b64_tr_b16 v[36:37], v9 offset:40960
  ds_read_b64_tr_b16 v[38:39], v9 offset:41984
  v_mfma_f32_16x16x32_bf16 v[196:199], v[40:43], v[20:23], v[196:199]
  s_add_u32 s43, s60, 10240
  buffer_load_dwordx4 v[88:91], v5, s[52:55], s43 offen offset:1024 sc1
  s_waitcnt lgkmcnt(4)
  v_mfma_f32_16x16x32_bf16 v[216:219], v[44:47], v[24:27], v[216:219]
  ds_read_b64_tr_b16 v[40:41], v10 offset:40960
  ds_read_b64_tr_b16 v[42:43], v10 offset:41984
  v_mfma_f32_16x16x32_bf16 v[200:203], v[44:47], v[20:23], v[200:203]
  s_waitcnt lgkmcnt(4)
  v_mfma_f32_16x16x32_bf16 v[172:175], v[32:35], v[72:75], v[172:175]
  ds_read_b64_tr_b16 v[44:45], v11 offset:40960
  ds_read_b64_tr_b16 v[46:47], v11 offset:41984
  v_mfma_f32_16x16x32_bf16 v[156:159], v[32:35], v[68:71], v[156:159]
  s_add_u32 m0, s36, 114688
  s_add_u32 s40, s48, s75
  buffer_load_dwordx4 v1, s[16:19], s40 offen lds
  s_waitcnt lgkmcnt(4)
  v_mfma_f32_16x16x32_bf16 v[176:179], v[36:39], v[72:75], v[176:179]
  ds_read_b64_tr_b16 v[32:33], v8 offset:49152
  ds_read_b64_tr_b16 v[34:35], v8 offset:50176
  v_mfma_f32_16x16x32_bf16 v[160:163], v[36:39], v[68:71], v[160:163]
  s_add_u32 s41, s61, 10240
  buffer_load_dwordx4 v[124:127], v5, s[52:55], s41 offen offset:0 sc1
  s_waitcnt lgkmcnt(4)
  v_mfma_f32_16x16x32_bf16 v[180:183], v[40:43], v[72:75], v[180:183]
  ds_read_b64_tr_b16 v[36:37], v9 offset:49152
  ds_read_b64_tr_b16 v[38:39], v9 offset:50176
  v_mfma_f32_16x16x32_bf16 v[164:167], v[40:43], v[68:71], v[164:167]
  s_waitcnt lgkmcnt(4)
  v_mfma_f32_16x16x32_bf16 v[184:187], v[44:47], v[72:75], v[184:187]
  ds_read_b64_tr_b16 v[40:41], v10 offset:49152
  ds_read_b64_tr_b16 v[42:43], v10 offset:50176
  v_mfma_f32_16x16x32_bf16 v[168:171], v[44:47], v[68:71], v[168:171]
  s_add_u32 m0, s36, 122880
  s_add_u32 s42, s48, s94
  buffer_load_dwordx4 v1, s[16:19], s42 offen lds
  s_waitcnt lgkmcnt(4)
  v_mfma_f32_16x16x32_bf16 v[204:207], v[32:35], v[72:75], v[204:207]
  ds_read_b64_tr_b16 v[44:45], v11 offset:49152
  ds_read_b64_tr_b16 v[46:47], v11 offset:50176
  v_mfma_f32_16x16x32_bf16 v[188:191], v[32:35], v[68:71], v[188:191]
  s_add_u32 s43, s61, 10240
  buffer_load_dwordx4 v[128:131], v5, s[52:55], s43 offen offset:1024 sc1
  s_waitcnt lgkmcnt(4)
  v_mfma_f32_16x16x32_bf16 v[208:211], v[36:39], v[72:75], v[208:211]
  ds_read_b64_tr_b16 v[32:33], v8 offset:0
  ds_read_b64_tr_b16 v[34:35], v8 offset:1024
  v_mfma_f32_16x16x32_bf16 v[192:195], v[36:39], v[68:71], v[192:195]
  s_waitcnt lgkmcnt(4)
  v_mfma_f32_16x16x32_bf16 v[212:215], v[40:43], v[72:75], v[212:215]
  ds_read_b64_tr_b16 v[36:37], v9 offset:0
  ds_read_b64_tr_b16 v[38:39], v9 offset:1024
  v_mfma_f32_16x16x32_bf16 v[196:199], v[40:43], v[68:71], v[196:199]
  s_waitcnt lgkmcnt(4)
  v_mfma_f32_16x16x32_bf16 v[216:219], v[44:47], v[72:75], v[216:219]
  ds_read_b64_tr_b16 v[40:41], v10 offset:0
  ds_read_b64_tr_b16 v[42:43], v10 offset:1024
  v_mfma_f32_16x16x32_bf16 v[200:203], v[44:47], v[68:71], v[200:203]
  s_waitcnt lgkmcnt(4)
  v_mfma_f32_16x16x32_bf16 v[172:175], v[32:35], v[80:83], v[172:175]
  ds_read_b64_tr_b16 v[44:45], v11 offset:0
  ds_read_b64_tr_b16 v[46:47], v11 offset:1024
  v_mfma_f32_16x16x32_bf16 v[156:159], v[32:35], v[76:79], v[156:159]
  s_barrier
  s_waitcnt lgkmcnt(4)
  v_mfma_f32_16x16x32_bf16 v[176:179], v[36:39], v[80:83], v[176:179]
  v_add_u32 v8, 0xfffe8000, v8
  ds_read_b64_tr_b16 v[32:33], v8 offset:0
  ds_read_b64_tr_b16 v[34:35], v8 offset:1024
  v_mfma_f32_16x16x32_bf16 v[160:163], v[36:39], v[76:79], v[160:163]
  s_add_u32 m0, s36, 131072
  s_add_u32 s40, s48, s94
  s_add_u32 s40, s40, 73728
  buffer_load_dwordx4 v1, s[16:19], s40 offen lds
  s_waitcnt lgkmcnt(4)
  v_mfma_f32_16x16x32_bf16 v[180:183], v[40:43], v[80:83], v[180:183]
  v_add_u32 v9, 0xfffe8000, v9
  ds_read_b64_tr_b16 v[36:37], v9 offset:0
  ds_read_b64_tr_b16 v[38:39], v9 offset:1024
  v_mfma_f32_16x16x32_bf16 v[164:167], v[40:43], v[76:79], v[164:167]
  s_waitcnt lgkmcnt(4)
  v_mfma_f32_16x16x32_bf16 v[184:187], v[44:47], v[80:83], v[184:187]
  v_add_u32 v10, 0xfffe8000, v10
  ds_read_b64_tr_b16 v[40:41], v10 offset:0
  ds_read_b64_tr_b16 v[42:43], v10 offset:1024
  v_mfma_f32_16x16x32_bf16 v[168:171], v[44:47], v[76:79], v[168:171]
  s_waitcnt lgkmcnt(4)
  v_mfma_f32_16x16x32_bf16 v[204:207], v[32:35], v[80:83], v[204:207]
  v_add_u32 v11, 0xfffe8000, v11
  ds_read_b64_tr_b16 v[44:45], v11 offset:0
  ds_read_b64_tr_b16 v[46:47], v11 offset:1024
  v_mfma_f32_16x16x32_bf16 v[188:191], v[32:35], v[76:79], v[188:191]
  s_add_u32 m0, s36, 139264
  s_nop 0
  buffer_load_dwordx4 v1, s[16:19], s49 offen lds
  s_waitcnt lgkmcnt(4)
  v_mfma_f32_16x16x32_bf16 v[208:211], v[36:39], v[80:83], v[208:211]
  ds_read_b64_tr_b16 v[32:33], v8 offset:8192
  ds_read_b64_tr_b16 v[34:35], v8 offset:9216
  v_mfma_f32_16x16x32_bf16 v[192:195], v[36:39], v[76:79], v[192:195]
  s_waitcnt lgkmcnt(4)
  v_mfma_f32_16x16x32_bf16 v[212:215], v[40:43], v[80:83], v[212:215]
  ds_read_b64_tr_b16 v[36:37], v9 offset:8192
  ds_read_b64_tr_b16 v[38:39], v9 offset:9216
  v_mfma_f32_16x16x32_bf16 v[196:199], v[40:43], v[76:79], v[196:199]
  s_waitcnt lgkmcnt(4)
  v_mfma_f32_16x16x32_bf16 v[216:219], v[44:47], v[80:83], v[216:219]
  ds_read_b64_tr_b16 v[40:41], v10 offset:8192
  ds_read_b64_tr_b16 v[42:43], v10 offset:9216
  v_mfma_f32_16x16x32_bf16 v[200:203], v[44:47], v[76:79], v[200:203]
  s_add_u32 m0, s36, 147456
  s_nop 0
  buffer_load_dwordx4 v1, s[16:19], s50 offen lds
  s_waitcnt lgkmcnt(4)
  v_mfma_f32_16x16x32_bf16 v[172:175], v[32:35], v[96:99], v[172:175]
  ds_read_b64_tr_b16 v[44:45], v11 offset:8192
  ds_read_b64_tr_b16 v[46:47], v11 offset:9216
  v_mfma_f32_16x16x32_bf16 v[156:159], v[32:35], v[92:95], v[156:159]
  s_waitcnt lgkmcnt(4)
  v_mfma_f32_16x16x32_bf16 v[176:179], v[36:39], v[96:99], v[176:179]
  ds_read_b64_tr_b16 v[32:33], v8 offset:16384
  ds_read_b64_tr_b16 v[34:35], v8 offset:17408
  v_mfma_f32_16x16x32_bf16 v[160:163], v[36:39], v[92:95], v[160:163]
  s_waitcnt lgkmcnt(4)
  v_mfma_f32_16x16x32_bf16 v[180:183], v[40:43], v[96:99], v[180:183]
  ds_read_b64_tr_b16 v[36:37], v9 offset:16384
  ds_read_b64_tr_b16 v[38:39], v9 offset:17408
  v_mfma_f32_16x16x32_bf16 v[164:167], v[40:43], v[92:95], v[164:167]
  s_waitcnt lgkmcnt(4)
  v_mfma_f32_16x16x32_bf16 v[184:187], v[44:47], v[96:99], v[184:187]
  ds_read_b64_tr_b16 v[40:41], v10 offset:16384
  ds_read_b64_tr_b16 v[42:43], v10 offset:17408
  v_mfma_f32_16x16x32_bf16 v[168:171], v[44:47], v[92:95], v[168:171]
  s_waitcnt vmcnt(12) lgkmcnt(4)
  v_mfma_f32_16x16x32_bf16 v[172:175], v[32:35], v[104:107], v[172:175]
  ds_read_b64_tr_b16 v[44:45], v11 offset:16384
  ds_read_b64_tr_b16 v[46:47], v11 offset:17408
  v_mfma_f32_16x16x32_bf16 v[156:159], v[32:35], v[100:103], v[156:159]
  s_barrier
  s_waitcnt lgkmcnt(4)
  v_mfma_f32_16x16x32_bf16 v[176:179], v[36:39], v[104:107], v[176:179]
  ds_read_b64_tr_b16 v[32:33], v8 offset:24576
  ds_read_b64_tr_b16 v[34:35], v8 offset:25600
  v_mfma_f32_16x16x32_bf16 v[160:163], v[36:39], v[100:103], v[160:163]
  s_add_u32 m0, s36, 98304
  s_add_u32 s43, s49, s75
  s_add_u32 s43, s43, 73728
  buffer_load_dwordx4 v1, s[16:19], s43 offen lds
  s_waitcnt lgkmcnt(4)
  v_mfma_f32_16x16x32_bf16 v[180:183], v[40:43], v[104:107], v[180:183]
  ds_read_b64_tr_b16 v[36:37], v9 offset:24576
  ds_read_b64_tr_b16 v[38:39], v9 offset:25600
  v_mfma_f32_16x16x32_bf16 v[164:167], v[40:43], v[100:103], v[164:167]
  s_waitcnt lgkmcnt(4)
  v_mfma_f32_16x16x32_bf16 v[184:187], v[44:47], v[104:107], v[184:187]
  ds_read_b64_tr_b16 v[40:41], v10 offset:24576
  ds_read_b64_tr_b16 v[42:43], v10 offset:25600
  v_mfma_f32_16x16x32_bf16 v[168:171], v[44:47], v[100:103], v[168:171]
  s_waitcnt vmcnt(8) lgkmcnt(4)
  v_mfma_f32_16x16x32_bf16 v[172:175], v[32:35], v[88:91], v[172:175]
  ds_read_b64_tr_b16 v[44:45], v11 offset:24576
  ds_read_b64_tr_b16 v[46:47], v11 offset:25600
  v_mfma_f32_16x16x32_bf16 v[156:159], v[32:35], v[84:87], v[156:159]
  s_add_u32 m0, s36, 0
  s_add_u32 s40, s50, s75
  s_add_u32 s40, s40, 73728
  buffer_load_dwordx4 v1, s[16:19], s40 offen lds
  s_waitcnt lgkmcnt(4)
  v_mfma_f32_16x16x32_bf16 v[176:179], v[36:39], v[88:91], v[176:179]
  ds_read_b64_tr_b16 v[32:33], v8 offset:32768
  ds_read_b64_tr_b16 v[34:35], v8 offset:33792
  v_mfma_f32_16x16x32_bf16 v[160:163], v[36:39], v[84:87], v[160:163]
  s_waitcnt lgkmcnt(4)
  v_mfma_f32_16x16x32_bf16 v[180:183], v[40:43], v[88:91], v[180:183]
  ds_read_b64_tr_b16 v[36:37], v9 offset:32768
  ds_read_b64_tr_b16 v[38:39], v9 offset:33792
  v_mfma_f32_16x16x32_bf16 v[164:167], v[40:43], v[84:87], v[164:167]
  s_waitcnt lgkmcnt(4)
  v_mfma_f32_16x16x32_bf16 v[184:187], v[44:47], v[88:91], v[184:187]
  ds_read_b64_tr_b16 v[40:41], v10 offset:32768
  ds_read_b64_tr_b16 v[42:43], v10 offset:33792
  v_mfma_f32_16x16x32_bf16 v[168:171], v[44:47], v[84:87], v[168:171]
  s_waitcnt vmcnt(5) lgkmcnt(4)
  v_mfma_f32_16x16x32_bf16 v[172:175], v[32:35], v[128:131], v[172:175]
  ds_read_b64_tr_b16 v[44:45], v11 offset:32768
  ds_read_b64_tr_b16 v[46:47], v11 offset:33792
  v_mfma_f32_16x16x32_bf16 v[156:159], v[32:35], v[124:127], v[156:159]
  s_barrier
  s_waitcnt lgkmcnt(4)
  v_mfma_f32_16x16x32_bf16 v[176:179], v[36:39], v[128:131], v[176:179]
  ds_read_b64_tr_b16 v[32:33], v8 offset:40960
  ds_read_b64_tr_b16 v[34:35], v8 offset:41984
  v_mfma_f32_16x16x32_bf16 v[160:163], v[36:39], v[124:127], v[160:163]
  ds_write_b128 v4, v[172:175] offset:0
  s_waitcnt lgkmcnt(5)
  v_mfma_f32_16x16x32_bf16 v[180:183], v[40:43], v[128:131], v[180:183]
  ds_read_b64_tr_b16 v[36:37], v9 offset:40960
  ds_read_b64_tr_b16 v[38:39], v9 offset:41984
  v_mfma_f32_16x16x32_bf16 v[164:167], v[40:43], v[124:127], v[164:167]
  ds_write_b128 v4, v[176:179] offset:1024
  s_waitcnt lgkmcnt(6)
  v_mfma_f32_16x16x32_bf16 v[184:187], v[44:47], v[128:131], v[184:187]
  ds_read_b64_tr_b16 v[40:41], v10 offset:40960
  ds_read_b64_tr_b16 v[42:43], v10 offset:41984
  v_mfma_f32_16x16x32_bf16 v[168:171], v[44:47], v[124:127], v[168:171]
  ds_write_b128 v4, v[180:183] offset:2048
  s_waitcnt lgkmcnt(7)
  v_mfma_f32_16x16x32_bf16 v[204:207], v[32:35], v[96:99], v[204:207]
  ds_read_b64_tr_b16 v[44:45], v11 offset:40960
  ds_read_b64_tr_b16 v[46:47], v11 offset:41984
  v_mfma_f32_16x16x32_bf16 v[188:191], v[32:35], v[92:95], v[188:191]
  ds_write_b128 v4, v[184:187] offset:3072
  s_waitcnt lgkmcnt(7)
  v_mfma_f32_16x16x32_bf16 v[208:211], v[36:39], v[96:99], v[208:211]
  ds_read_b64_tr_b16 v[32:33], v8 offset:49152
  ds_read_b64_tr_b16 v[34:35], v8 offset:50176
  v_mfma_f32_16x16x32_bf16 v[192:195], v[36:39], v[92:95], v[192:195]
  s_add_u32 m0, s36, 8192
  s_add_u32 s41, s49, 73728
  buffer_load_dwordx4 v1, s[16:19], s41 offen lds
  s_waitcnt lgkmcnt(6)
  v_mfma_f32_16x16x32_bf16 v[212:215], v[40:43], v[96:99], v[212:215]
  ds_read_b64_tr_b16 v[36:37], v9 offset:49152
  ds_read_b64_tr_b16 v[38:39], v9 offset:50176
  v_mfma_f32_16x16x32_bf16 v[196:199], v[40:43], v[92:95], v[196:199]
  s_waitcnt lgkmcnt(5)
  v_mfma_f32_16x16x32_bf16 v[216:219], v[44:47], v[96:99], v[216:219]
  ds_read_b64_tr_b16 v[40:41], v10 offset:49152
  ds_read_b64_tr_b16 v[42:43], v10 offset:50176
  v_mfma_f32_16x16x32_bf16 v[200:203], v[44:47], v[92:95], v[200:203]
  s_waitcnt lgkmcnt(4)
  v_mfma_f32_16x16x32_bf16 v[204:207], v[32:35], v[104:107], v[204:207]
  ds_read_b64_tr_b16 v[44:45], v11 offset:49152
  ds_read_b64_tr_b16 v[46:47], v11 offset:50176
  v_mfma_f32_16x16x32_bf16 v[188:191], v[32:35], v[100:103], v[188:191]
  s_barrier
  v_xor_b32 v184, 0x1000, v4
  ds_read_b128 v[176:179], v184 offset:1024
  s_waitcnt lgkmcnt(5)
  v_mfma_f32_16x16x32_bf16 v[208:211], v[36:39], v[104:107], v[208:211]
  ds_read_b64_tr_b16 v[32:33], v8 offset:57344
  ds_read_b64_tr_b16 v[34:35], v8 offset:58368
  v_mfma_f32_16x16x32_bf16 v[192:195], v[36:39], v[100:103], v[192:195]
  s_add_u32 m0, s36, 16384
  s_add_u32 s42, s50, 73728
  buffer_load_dwordx4 v1, s[16:19], s42 offen lds
  ds_read_b128 v[180:183], v184 offset:2048
  s_waitcnt lgkmcnt(6)
  v_mfma_f32_16x16x32_bf16 v[212:215], v[40:43], v[104:107], v[212:215]
  ds_read_b64_tr_b16 v[36:37], v9 offset:57344
  ds_read_b64_tr_b16 v[38:39], v9 offset:58368
  v_mfma_f32_16x16x32_bf16 v[196:199], v[40:43], v[100:103], v[196:199]
  ds_read_b128 v[172:175], v184 offset:0
  s_waitcnt lgkmcnt(7)
  v_mfma_f32_16x16x32_bf16 v[216:219], v[44:47], v[104:107], v[216:219]
  ds_read_b64_tr_b16 v[40:41], v10 offset:57344
  ds_read_b64_tr_b16 v[42:43], v10 offset:58368
  v_mfma_f32_16x16x32_bf16 v[200:203], v[44:47], v[100:103], v[200:203]
  ds_read_b128 v[184:187], v184 offset:3072
  s_waitcnt lgkmcnt(7)
  v_mfma_f32_16x16x32_bf16 v[204:207], v[32:35], v[88:91], v[204:207]
  ds_read_b64_tr_b16 v[44:45], v11 offset:57344
  ds_read_b64_tr_b16 v[46:47], v11 offset:58368
  v_mfma_f32_16x16x32_bf16 v[188:191], v[32:35], v[84:87], v[188:191]
  s_add_u32 m0, s36, 24576
  s_add_u32 s43, s49, s75
  buffer_load_dwordx4 v1, s[16:19], s43 offen lds
  s_waitcnt lgkmcnt(6)
  v_mfma_f32_16x16x32_bf16 v[208:211], v[36:39], v[88:91], v[208:211]
  v_add_u32 v8, 0x18000, v8
  ds_read_b64_tr_b16 v[32:33], v8 offset:8192
  ds_read_b64_tr_b16 v[34:35], v8 offset:9216
  v_mfma_f32_16x16x32_bf16 v[192:195], v[36:39], v[84:87], v[192:195]
  v_add_f32 v160, v160, v176
  v_add_f32 v161, v161, v177
  v_add_f32 v162, v162, v178
  v_add_f32 v163, v163, v179
  v_add_f32 v164, v164, v180
  v_add_f32 v165, v165, v181
  v_add_f32 v166, v166, v182
  v_add_f32 v167, v167, v183
  s_waitcnt lgkmcnt(5)
  v_mfma_f32_16x16x32_bf16 v[212:215], v[40:43], v[88:91], v[212:215]
  v_add_u32 v9, 0x18000, v9
  ds_read_b64_tr_b16 v[36:37], v9 offset:8192
  ds_read_b64_tr_b16 v[38:39], v9 offset:9216
  v_cvt_pk_bf16_f32 v176, v160, v161
  v_cvt_pk_bf16_f32 v177, v162, v163
  v_cvt_pk_bf16_f32 v178, v164, v165
  v_cvt_pk_bf16_f32 v179, v166, v167
  v_mfma_f32_16x16x32_bf16 v[196:199], v[40:43], v[84:87], v[196:199]
  v_add_f32 v156, v156, v172
  v_add_f32 v157, v157, v173
  v_add_f32 v158, v158, v174
  s_waitcnt lgkmcnt(4)
  v_mfma_f32_16x16x32_bf16 v[216:219], v[44:47], v[88:91], v[216:219]
  v_add_u32 v10, 0x18000, v10
  ds_read_b64_tr_b16 v[40:41], v10 offset:8192
  ds_read_b64_tr_b16 v[42:43], v10 offset:9216
  v_add_f32 v159, v159, v175
  v_permlane32_swap_b32 v176, v178
  v_permlane32_swap_b32 v177, v179
  v_add_f32 v168, v168, v184
  v_mfma_f32_16x16x32_bf16 v[200:203], v[44:47], v[84:87], v[200:203]
  v_add_f32 v169, v169, v185
  v_add_f32 v170, v170, v186
  v_add_f32 v171, v171, v187
  s_waitcnt lgkmcnt(4)
  v_mfma_f32_16x16x32_bf16 v[204:207], v[32:35], v[128:131], v[204:207]
  v_add_u32 v11, 0x18000, v11
  ds_read_b64_tr_b16 v[44:45], v11 offset:8192
  ds_read_b64_tr_b16 v[46:47], v11 offset:9216
  v_mfma_f32_16x16x32_bf16 v[188:191], v[32:35], v[124:127], v[188:191]
  s_waitcnt vmcnt(7)
  s_barrier
  s_waitcnt lgkmcnt(4)
  v_mfma_f32_16x16x32_bf16 v[208:211], v[36:39], v[128:131], v[208:211]
  ds_read_b64_tr_b16 v[32:33], v10 offset:16384
  ds_read_b64_tr_b16 v[34:35], v10 offset:17408
  buffer_store_dwordx4 v[176:179], v6, s[24:27], 0 offen sc1
  v_mfma_f32_16x16x32_bf16 v[192:195], v[36:39], v[124:127], v[192:195]
  ds_write_b128 v4, v[204:207] offset:0
  s_add_u32 m0, s36, 32768
  s_add_u32 s40, s50, s75
  buffer_load_dwordx4 v1, s[16:19], s40 offen lds
  s_waitcnt lgkmcnt(5)
  v_mfma_f32_16x16x32_bf16 v[212:215], v[40:43], v[128:131], v[212:215]
  ds_read_b64_tr_b16 v[36:37], v11 offset:16384
  ds_read_b64_tr_b16 v[38:39], v11 offset:17408
  v_mfma_f32_16x16x32_bf16 v[196:199], v[40:43], v[124:127], v[196:199]
  ds_write_b128 v4, v[208:211] offset:1024
  s_waitcnt lgkmcnt(6)
  v_mfma_f32_16x16x32_bf16 v[216:219], v[44:47], v[128:131], v[216:219]
  ds_read_b64_tr_b16 v[40:41], v10 offset:24576
  ds_read_b64_tr_b16 v[42:43], v10 offset:25600
  v_mfma_f32_16x16x32_bf16 v[200:203], v[44:47], v[124:127], v[200:203]
  ds_write_b128 v4, v[212:215] offset:2048
  v_cvt_pk_bf16_f32 v180, v168, v169
  v_cvt_pk_bf16_f32 v181, v170, v171
  s_nop 0
  v_permlane32_swap_b32 v180, v182
  v_permlane32_swap_b32 v181, v183
  s_mov_b32 exec_hi, 0
  buffer_store_dwordx4 v[180:183], v5, s[24:27], s69 offen offset:0 sc1
  s_mov_b32 exec_hi, -1
  v_and_b32 v162, 15, v0
  s_lshl1_add_u32 s100, s4, s5
  s_lshl_b32 s100, s100, 4
  v_add_u32 v162, s100, v162
  v_lshrrev_b32 v163, 4, v0
  s_mov_b32 s100, 161792
  v_lshl_add_u32 v162, v162, 3, s100
  s_waitcnt lgkmcnt(7)
  v_mfma_f32_16x16x32_bf16 v[228:231], v[32:35], v[136:139], v[228:231]
  ds_read_b64_tr_b16 v[44:45], v11 offset:24576
  ds_read_b64_tr_b16 v[46:47], v11 offset:25600
  v_mfma_f32_16x16x32_bf16 v[220:223], v[32:35], v[132:135], v[220:223]
  ds_write_b128 v4, v[216:219] offset:3072
  s_add_u32 m0, s36, 40960
  s_add_u32 s41, s49, s94
  buffer_load_dwordx4 v1, s[16:19], s41 offen lds
  s_mov_b32 s100, 162816
  v_lshl_add_u32 v163, v163, 3, s100
  ds_read_b64 v[160:161], v162
  ds_read_b64 v[180:181], v163 offset:64
  s_waitcnt lgkmcnt(9)
  v_mfma_f32_16x16x32_bf16 v[232:235], v[36:39], v[136:139], v[232:235]
  ds_read_b64_tr_b16 v[32:33], v10 offset:32768
  ds_read_b64_tr_b16 v[34:35], v10 offset:33792
  v_mfma_f32_16x16x32_bf16 v[224:227], v[36:39], v[132:135], v[224:227]
  ds_read_b64 v[182:183], v163 offset:256
  ds_read_b64 v[184:185], v163 offset:288
  ds_read_b64 v[186:187], v163 offset:320
  s_waitcnt lgkmcnt(11)
  v_mfma_f32_16x16x32_bf16 v[228:231], v[40:43], v[112:115], v[228:231]
  ds_read_b64_tr_b16 v[36:37], v11 offset:32768
  ds_read_b64_tr_b16 v[38:39], v11 offset:33792
  v_mfma_f32_16x16x32_bf16 v[220:223], v[40:43], v[108:111], v[220:223]
  s_waitcnt lgkmcnt(9)
  s_waitcnt vmcnt(6)
  s_barrier
  v_xor_b32 v216, 0x1000, v4
  ds_read_b128 v[204:207], v216 offset:0
  v_mfma_f32_16x16x32_bf16 v[232:235], v[44:47], v[112:115], v[232:235]
  ds_read_b64_tr_b16 v[40:41], v10 offset:40960
  ds_read_b64_tr_b16 v[42:43], v10 offset:41984
  v_mfma_f32_16x16x32_bf16 v[224:227], v[44:47], v[108:111], v[224:227]
  s_add_u32 m0, s36, 49152
  s_add_u32 s42, s50, s94
  buffer_load_dwordx4 v1, s[16:19], s42 offen lds
  ds_read_b128 v[208:211], v216 offset:1024
  v_and_b32 v18, 15, v0
  s_lshl1_add_u32 s100, s4, s5
  s_lshl_b32 s100, s100, 4
  v_add_u32 v18, s100, v18
  v_mul_u32_u24 v18, 0x900, v18
  s_waitcnt lgkmcnt(9)
  v_mfma_f32_16x16x32_bf16 v[228:231], v[32:35], v[120:123], v[228:231]
  ds_read_b64_tr_b16 v[44:45], v11 offset:40960
  ds_read_b64_tr_b16 v[46:47], v11 offset:41984
  v_mfma_f32_16x16x32_bf16 v[220:223], v[32:35], v[116:119], v[220:223]
  ds_read_b128 v[212:215], v216 offset:2048
  v_and_b32 v176, 48, v0
  s_lshl_b32 s71, s71, 1
  s_lshl_b32 s100, s70, 1
  v_add3_u32 v18, v18, v176, s100
  s_mul_i32 s100, s6, 294912
  s_add_u32 s96, s76, s100
  s_addc_u32 s97, s77, 0
  s_mov_b32 s98, 294912
  s_mov_b32 s99, 0x00020000
  s_waitcnt lgkmcnt(7)
  v_mfma_f32_16x16x32_bf16 v[232:235], v[36:39], v[120:123], v[232:235]
  ds_read_b64_tr_b16 v[32:33], v10 offset:49152
  ds_read_b64_tr_b16 v[34:35], v10 offset:50176
  v_mfma_f32_16x16x32_bf16 v[224:227], v[36:39], v[116:119], v[224:227]
  ds_read_b128 v[216:219], v216 offset:3072
  v_lshlrev_b32 v162, 16, v160
  v_and_b32 v160, s90, v160
  v_mul_f32 v162, v161, v162
  s_waitcnt lgkmcnt(7)
  v_mfma_f32_16x16x32_bf16 v[228:231], v[40:43], v[144:147], v[228:231]
  ds_read_b64_tr_b16 v[36:37], v11 offset:49152
  ds_read_b64_tr_b16 v[38:39], v11 offset:50176
  v_mfma_f32_16x16x32_bf16 v[220:223], v[40:43], v[140:143], v[220:223]
  s_add_u32 m0, s36, 57344
  s_add_u32 s43, s49, s94
  s_add_u32 s43, s43, 73728
  buffer_load_dwordx4 v1, s[16:19], s43 offen lds
  v_lshlrev_b32 v176, 16, v180
  v_and_b32 v177, s90, v180
  v_lshlrev_b32 v178, 16, v181
  s_waitcnt lgkmcnt(6)
  v_mfma_f32_16x16x32_bf16 v[232:235], v[44:47], v[144:147], v[232:235]
  ds_read_b64_tr_b16 v[40:41], v10 offset:0
  ds_read_b64_tr_b16 v[42:43], v10 offset:1024
  v_mfma_f32_16x16x32_bf16 v[224:227], v[44:47], v[140:143], v[224:227]
  v_add_f32 v188, v188, v204
  v_add_f32 v189, v189, v205
  v_add_f32 v190, v190, v206
  v_add_f32 v191, v191, v207
  v_add_f32 v192, v192, v208
  v_add_f32 v193, v193, v209
  v_add_f32 v194, v194, v210
  v_add_f32 v195, v195, v211
  v_and_b32 v179, s90, v181
  v_fmac_f32 v156, v160, v176
  v_fmac_f32 v157, v160, v177
  s_waitcnt lgkmcnt(5)
  v_mfma_f32_16x16x32_bf16 v[228:231], v[32:35], v[152:155], v[228:231]
  ds_read_b64_tr_b16 v[44:45], v11 offset:0
  ds_read_b64_tr_b16 v[46:47], v11 offset:1024
  v_cvt_pk_bf16_f32 v204, v188, v189
  v_cvt_pk_bf16_f32 v205, v190, v191
  v_cvt_pk_bf16_f32 v206, v192, v193
  v_cvt_pk_bf16_f32 v207, v194, v195
  v_mfma_f32_16x16x32_bf16 v[220:223], v[32:35], v[148:151], v[220:223]
  buffer_store_dwordx4 v[204:207], v5, s[24:27], s68 offen offset:2560 sc1
  v_add_f32 v196, v196, v212
  v_add_f32 v197, v197, v213
  v_fmac_f32 v158, v160, v178
  v_fmac_f32 v159, v160, v179
  v_lshlrev_b32 v164, 16, v182
  s_waitcnt lgkmcnt(4)
  v_mfma_f32_16x16x32_bf16 v[232:235], v[36:39], v[152:155], v[232:235]
  v_add_u32 v10, 0xfffe8000, v10
  ds_read_b64_tr_b16 v[32:33], v10 offset:0
  ds_read_b64_tr_b16 v[34:35], v10 offset:1024
  v_add_f32 v198, v198, v214
  v_add_f32 v199, v199, v215
  v_add_f32 v200, v200, v216
  v_add_f32 v201, v201, v217
  v_mfma_f32_16x16x32_bf16 v[224:227], v[36:39], v[148:151], v[224:227]
  s_add_u32 m0, s36, 106496
  s_add_u32 s40, s50, s94
  s_add_u32 s40, s40, 73728
  buffer_load_dwordx4 v1, s[16:19], s40 offen lds
  v_add_f32 v202, v202, v218
  v_and_b32 v165, s90, v182
  v_lshlrev_b32 v166, 16, v183
  v_and_b32 v167, s90, v183
  s_waitcnt lgkmcnt(4)
  v_mfma_f32_16x16x32_bf16 v[228:231], v[40:43], v[12:15], v[228:231]
  v_add_u32 v11, 0xfffe8000, v11
  ds_read_b64_tr_b16 v[36:37], v11 offset:0
  ds_read_b64_tr_b16 v[38:39], v11 offset:1024
  v_add_f32 v203, v203, v219
  v_cvt_pk_bf16_f32 v212, v196, v197
  v_cvt_pk_bf16_f32 v213, v198, v199
  v_cvt_pk_bf16_f32 v214, v200, v201
  v_mfma_f32_16x16x32_bf16 v[220:223], v[40:43], v[252:255], v[220:223]
  v_cvt_pk_bf16_f32 v215, v202, v203
  buffer_store_dwordx4 v[212:215], v5, s[24:27], s69 offen offset:3072 sc1
  v_lshlrev_b32 v168, 16, v184
  v_and_b32 v169, s90, v184
  v_lshlrev_b32 v170, 16, v185
  s_waitcnt lgkmcnt(4)
  v_mfma_f32_16x16x32_bf16 v[232:235], v[44:47], v[12:15], v[232:235]
  ds_read_b64_tr_b16 v[40:41], v10 offset:8192
  ds_read_b64_tr_b16 v[42:43], v10 offset:9216
  v_mfma_f32_16x16x32_bf16 v[224:227], v[44:47], v[252:255], v[224:227]
  v_and_b32 v171, s90, v185
  v_lshlrev_b32 v172, 16, v186
  v_and_b32 v173, s90, v186
  s_waitcnt lgkmcnt(4)
  v_mfma_f32_16x16x32_bf16 v[228:231], v[32:35], v[56:59], v[228:231]
  ds_read_b64_tr_b16 v[44:45], v11 offset:8192
  ds_read_b64_tr_b16 v[46:47], v11 offset:9216
  v_mfma_f32_16x16x32_bf16 v[220:223], v[32:35], v[52:55], v[220:223]
  s_waitcnt vmcnt(3)
  s_barrier
  s_waitcnt lgkmcnt(4)
  v_mfma_f32_16x16x32_bf16 v[232:235], v[36:39], v[56:59], v[232:235]
  ds_read_b64_tr_b16 v[32:33], v10 offset:16384
  ds_read_b64_tr_b16 v[34:35], v10 offset:17408
  v_mfma_f32_16x16x32_bf16 v[224:227], v[36:39], v[52:55], v[224:227]
  v_lshlrev_b32 v174, 16, v187
  v_and_b32 v175, s90, v187
  v_and_b32 v163, 1, v0
  s_waitcnt lgkmcnt(4)
  v_mfma_f32_16x16x32_bf16 v[228:231], v[40:43], v[64:67], v[228:231]
  ds_read_b64_tr_b16 v[36:37], v11 offset:16384
  ds_read_b64_tr_b16 v[38:39], v11 offset:17408
  v_mfma_f32_16x16x32_bf16 v[220:223], v[40:43], v[60:63], v[220:223]
  v_lshlrev_b32 v163, 4, v163
  s_movk_i32 s100, 0x3f80
  v_lshlrev_b32 v163, v163, s100
  v_mov_b32 v176, 0
  s_waitcnt lgkmcnt(4)
  v_mfma_f32_16x16x32_bf16 v[232:235], v[44:47], v[64:67], v[232:235]
  ds_read_b64_tr_b16 v[40:41], v10 offset:24576
  ds_read_b64_tr_b16 v[42:43], v10 offset:25600
  v_mfma_f32_16x16x32_bf16 v[224:227], v[44:47], v[60:63], v[224:227]
  v_mov_b32 v177, 0
  v_mov_b32 v180, 0
  v_mov_b32 v181, 0
  s_waitcnt lgkmcnt(4)
  v_mfma_f32_16x16x32_bf16 v[228:231], v[32:35], v[24:27], v[228:231]
  ds_read_b64_tr_b16 v[44:45], v11 offset:24576
  ds_read_b64_tr_b16 v[46:47], v11 offset:25600
  v_mfma_f32_16x16x32_bf16 v[220:223], v[32:35], v[20:23], v[220:223]
  s_mov_b32 vcc_lo, 0x300003
  s_mov_b32 vcc_hi, 0x30000300
  v_cndmask_b32 v178, 0, v163
  s_mov_b32 vcc_lo, 0xc0000c
  s_mov_b32 vcc_hi, 0xc0000c00
  v_cndmask_b32 v179, 0, v163
  s_mov_b32 vcc_lo, 0x300003
  s_mov_b32 vcc_hi, 0x300003
  v_cndmask_b32 v216, 0, v163
  s_waitcnt lgkmcnt(4)
  v_mfma_f32_16x16x32_bf16 v[232:235], v[36:39], v[24:27], v[232:235]
  ds_read_b64_tr_b16 v[32:33], v10 offset:32768
  ds_read_b64_tr_b16 v[34:35], v10 offset:33792
  v_mfma_f32_16x16x32_bf16 v[224:227], v[36:39], v[20:23], v[224:227]
  s_mov_b32 vcc_lo, 0xc0000c
  s_mov_b32 vcc_hi, 0xc0000c
  v_cndmask_b32 v217, 0, v163
  s_mov_b32 vcc_lo, 0x30000300
  s_mov_b32 vcc_hi, 0x30000300
  v_cndmask_b32 v218, 0, v163
  s_mov_b32 vcc_lo, 0xc0000c00
  s_mov_b32 vcc_hi, 0xc0000c00
  v_cndmask_b32 v219, 0, v163
  s_waitcnt lgkmcnt(4)
  v_mfma_f32_16x16x32_bf16 v[228:231], v[40:43], v[72:75], v[228:231]
  ds_read_b64_tr_b16 v[36:37], v11 offset:32768
  ds_read_b64_tr_b16 v[38:39], v11 offset:33792
  v_mfma_f32_16x16x32_bf16 v[220:223], v[40:43], v[68:71], v[220:223]
  v_lshlrev_b32 v188, 16, v16
  v_and_b32 v189, s90, v16
  v_lshlrev_b32 v190, 16, v17
  s_waitcnt lgkmcnt(4)
  v_mfma_f32_16x16x32_bf16 v[232:235], v[44:47], v[72:75], v[232:235]
  ds_read_b64_tr_b16 v[40:41], v10 offset:40960
  ds_read_b64_tr_b16 v[42:43], v10 offset:41984
  v_mfma_f32_16x16x32_bf16 v[224:227], v[44:47], v[68:71], v[224:227]
  v_and_b32 v191, s90, v17
  v_fma_f32 v182, v188, v161, v162
  v_fma_f32 v183, v189, v161, v162
  s_mov_b64 exec, 0xff0
  buffer_load_dword v19, v2, s[32:35], 0 offen sc1
  s_mov_b64 exec, -1
  s_waitcnt lgkmcnt(4)
  v_mfma_f32_16x16x32_bf16 v[228:231], v[32:35], v[80:83], v[228:231]
  ds_read_b64_tr_b16 v[44:45], v11 offset:40960
  ds_read_b64_tr_b16 v[46:47], v11 offset:41984
  v_mfma_f32_16x16x32_bf16 v[220:223], v[32:35], v[76:79], v[220:223]
  v_fma_f32 v184, v190, v161, v162
  v_fma_f32 v185, v191, v161, v162
  v_mul_f32 v164, v182, v164
  s_waitcnt lgkmcnt(4)
  v_mfma_f32_16x16x32_bf16 v[232:235], v[36:39], v[80:83], v[232:235]
  ds_read_b64_tr_b16 v[32:33], v10 offset:49152
  ds_read_b64_tr_b16 v[34:35], v10 offset:50176
  v_mfma_f32_16x16x32_bf16 v[224:227], v[36:39], v[76:79], v[224:227]
  v_mul_f32 v165, v183, v165
  v_mul_f32 v166, v184, v166
  v_mul_f32 v167, v185, v167
  s_waitcnt lgkmcnt(4)
  v_mfma_f32_16x16x32_bf16 v[228:231], v[40:43], v[96:99], v[228:231]
  ds_read_b64_tr_b16 v[36:37], v11 offset:49152
  ds_read_b64_tr_b16 v[38:39], v11 offset:50176
  v_mfma_f32_16x16x32_bf16 v[220:223], v[40:43], v[92:95], v[220:223]
  v_lshlrev_b32 v192, 16, v48
  v_and_b32 v193, s90, v48
  v_lshlrev_b32 v194, 16, v49
  s_waitcnt lgkmcnt(4)
  v_mfma_f32_16x16x32_bf16 v[232:235], v[44:47], v[96:99], v[232:235]
  ds_read_b64_tr_b16 v[40:41], v10 offset:57344
  ds_read_b64_tr_b16 v[42:43], v10 offset:58368
  v_mfma_f32_16x16x32_bf16 v[224:227], v[44:47], v[92:95], v[224:227]
  v_and_b32 v195, s90, v49
  v_fma_f32 v182, v192, v161, v162
  v_fma_f32 v183, v193, v161, v162
  s_waitcnt lgkmcnt(4)
  v_mfma_f32_16x16x32_bf16 v[228:231], v[32:35], v[104:107], v[228:231]
  ds_read_b64_tr_b16 v[44:45], v11 offset:57344
  ds_read_b64_tr_b16 v[46:47], v11 offset:58368
  v_mfma_f32_16x16x32_bf16 v[220:223], v[32:35], v[100:103], v[220:223]
  s_waitcnt vmcnt(1)
  s_barrier
  v_mov_b32 v31, 4
  s_mov_b64 exec, 1
  buffer_store_dword v31, off, s[28:31], 0 sc1
  s_mov_b64 exec, -1
  s_waitcnt lgkmcnt(4)
  v_mfma_f32_16x16x32_bf16 v[232:235], v[36:39], v[104:107], v[232:235]
  v_add_u32 v10, 0x1a000, v10
  ds_read_b64_tr_b16 v[32:33], v10 offset:0
  ds_read_b64_tr_b16 v[34:35], v10 offset:1024
  v_mfma_f32_16x16x32_bf16 v[224:227], v[36:39], v[100:103], v[224:227]
  v_fma_f32 v184, v194, v161, v162
  v_fma_f32 v185, v195, v161, v162
  v_mul_f32 v168, v182, v168
  s_waitcnt lgkmcnt(4)
  v_mfma_f32_16x16x32_bf16 v[228:231], v[40:43], v[88:91], v[228:231]
  v_add_u32 v11, 0x1a000, v11
  ds_read_b64_tr_b16 v[36:37], v11 offset:0
  ds_read_b64_tr_b16 v[38:39], v11 offset:1024
  v_mfma_f32_16x16x32_bf16 v[220:223], v[40:43], v[84:87], v[220:223]
  v_mul_f32 v169, v183, v169
  v_mul_f32 v170, v184, v170
  v_mul_f32 v171, v185, v171
  s_waitcnt lgkmcnt(4)
  v_mfma_f32_16x16x32_bf16 v[232:235], v[44:47], v[88:91], v[232:235]
  ds_read_b64_tr_b16 v[40:41], v8 offset:16384
  ds_read_b64_tr_b16 v[42:43], v8 offset:17408
  v_mfma_f32_16x16x32_bf16 v[224:227], v[44:47], v[84:87], v[224:227]
  v_lshlrev_b32 v196, 16, v50
  v_and_b32 v197, s90, v50
  v_lshlrev_b32 v198, 16, v51
  s_waitcnt lgkmcnt(4)
  v_mfma_f32_16x16x32_bf16 v[228:231], v[32:35], v[128:131], v[228:231]
  ds_read_b64_tr_b16 v[44:45], v9 offset:16384
  ds_read_b64_tr_b16 v[46:47], v9 offset:17408
  v_mfma_f32_16x16x32_bf16 v[220:223], v[32:35], v[124:127], v[220:223]
  v_and_b32 v199, s90, v51
  v_fma_f32 v182, v196, v161, v162
  v_fma_f32 v183, v197, v161, v162
  s_waitcnt lgkmcnt(4)
  v_mfma_f32_16x16x32_bf16 v[232:235], v[36:39], v[128:131], v[232:235]
  ds_read_b64_tr_b16 v[32:33], v8 offset:24576
  ds_read_b64_tr_b16 v[34:35], v8 offset:25600
  v_mfma_f32_16x16x32_bf16 v[224:227], v[36:39], v[124:127], v[224:227]
  ds_write_b128 v4, v[228:231] offset:0
  v_fma_f32 v184, v198, v161, v162
  v_fma_f32 v185, v199, v161, v162
  v_mul_f32 v172, v182, v172
  s_waitcnt lgkmcnt(5)
  v_mfma_f32_16x16x32_bf16 v[244:247], v[40:43], v[136:139], v[244:247]
  ds_read_b64_tr_b16 v[36:37], v9 offset:24576
  ds_read_b64_tr_b16 v[38:39], v9 offset:25600
  v_mfma_f32_16x16x32_bf16 v[236:239], v[40:43], v[132:135], v[236:239]
  ds_write_b128 v4, v[232:235] offset:1024
  v_mul_f32 v173, v183, v173
  v_mul_f32 v174, v184, v174
  v_mul_f32 v175, v185, v175
  s_waitcnt vmcnt(1)
  v_cmp_gt_u32 vcc, 2, v19
  s_nop 2
  s_and_b32 s72, vcc_lo, 0xff0
  s_add_u32 s100, s66, 8192
  buffer_load_dwordx4 v[200:203], v5, s[24:27], s100 offen offset:0 sc1
  s_waitcnt lgkmcnt(6)
  v_mfma_f32_16x16x32_bf16 v[248:251], v[44:47], v[136:139], v[248:251]
  ds_read_b64_tr_b16 v[40:41], v8 offset:32768
  ds_read_b64_tr_b16 v[42:43], v8 offset:33792
  v_mfma_f32_16x16x32_bf16 v[240:243], v[44:47], v[132:135], v[240:243]
  v_mul_f32 v161, 0xbfb8aa3b, v161
  s_add_u32 s100, s66, 8192
  buffer_load_dwordx4 v[204:207], v5, s[24:27], s100 offen offset:1024 sc1
  s_waitcnt lgkmcnt(6)
  v_mfma_f32_16x16x32_bf16 v[244:247], v[32:35], v[112:115], v[244:247]
  ds_read_b64_tr_b16 v[44:45], v9 offset:32768
  ds_read_b64_tr_b16 v[46:47], v9 offset:33792
  v_mfma_f32_16x16x32_bf16 v[236:239], v[32:35], v[108:111], v[236:239]
  s_waitcnt lgkmcnt(4)
  s_barrier
  v_xor_b32 v232, 0x1000, v4
  ds_read_b128 v[228:231], v232 offset:0
  v_mfma_f32_16x16x32_bf16 v[248:251], v[36:39], v[112:115], v[248:251]
  ds_read_b64_tr_b16 v[32:33], v8 offset:40960
  ds_read_b64_tr_b16 v[34:35], v8 offset:41984
  v_mfma_f32_16x16x32_bf16 v[240:243], v[36:39], v[108:111], v[240:243]
  ds_read_b128 v[232:235], v232 offset:1024
  s_add_u32 s100, s66, 8192
  buffer_load_dwordx4 v[208:211], v5, s[24:27], s100 offen offset:2048 sc1
  s_waitcnt lgkmcnt(6)
  v_mfma_f32_16x16x32_bf16 v[244:247], v[40:43], v[120:123], v[244:247]
  ds_read_b64_tr_b16 v[36:37], v9 offset:40960
  ds_read_b64_tr_b16 v[38:39], v9 offset:41984
  v_mfma_f32_16x16x32_bf16 v[236:239], v[40:43], v[116:119], v[236:239]
  s_add_u32 s100, s66, 8192
  buffer_load_dwordx4 v[212:215], v5, s[24:27], s100 offen offset:3072 sc1
  s_waitcnt lgkmcnt(6)
  v_mfma_f32_16x16x32_bf16 v[248:251], v[44:47], v[120:123], v[248:251]
  ds_read_b64_tr_b16 v[40:41], v8 offset:49152
  ds_read_b64_tr_b16 v[42:43], v8 offset:50176
  v_mfma_f32_16x16x32_bf16 v[240:243], v[44:47], v[116:119], v[240:243]
  s_waitcnt lgkmcnt(7)
  v_add_f32 v220, v220, v228
  v_add_f32 v221, v221, v229
  v_add_f32 v222, v222, v230
  v_add_f32 v223, v223, v231
  s_waitcnt lgkmcnt(4)
  v_add_f32 v224, v224, v232
  v_add_f32 v225, v225, v233
  v_add_f32 v226, v226, v234
  v_add_f32 v227, v227, v235
  v_mfma_f32_16x16x32_bf16 v[244:247], v[32:35], v[144:147], v[244:247]
  ds_read_b64_tr_b16 v[44:45], v9 offset:49152
  ds_read_b64_tr_b16 v[46:47], v9 offset:50176
  v_cvt_pk_bf16_f32 v228, v220, v221
  v_cvt_pk_bf16_f32 v229, v222, v223
  v_cvt_pk_bf16_f32 v230, v224, v225
  v_cvt_pk_bf16_f32 v231, v226, v227
  v_mfma_f32_16x16x32_bf16 v[236:239], v[32:35], v[140:143], v[236:239]
  buffer_store_dwordx4 v[228:231], v5, s[24:27], s67 offen offset:2048 sc1
  s_mov_b64 exec, 0xff0
  buffer_load_dword v29, v2, s[32:35], 0 offen sc1
  s_mov_b64 exec, -1
  s_waitcnt lgkmcnt(4)
  v_mfma_f32_16x16x32_bf16 v[248:251], v[36:39], v[144:147], v[248:251]
  v_readfirstlane_b32 s90, v18
  v_readfirstlane_b32 s91, v4
  ds_read_b64_tr_b16 v[32:33], v8 offset:0
  ds_read_b64_tr_b16 v[34:35], v8 offset:1024
  v_mfma_f32_16x16x32_bf16 v[240:243], v[36:39], v[140:143], v[240:243]
  s_mov_b32 s101, 0x4800
  v_lshrrev_b32 v48, 3, v0
  s_waitcnt lgkmcnt(4)
  v_mfma_f32_16x16x32_bf16 v[244:247], v[40:43], v[152:155], v[244:247]
  v_and_b32 v49, 7, v0
  v_mul_u32_u24 v182, 0x900, v48
  ds_read_b64_tr_b16 v[36:37], v9 offset:0
  ds_read_b64_tr_b16 v[38:39], v9 offset:1024
  v_mfma_f32_16x16x32_bf16 v[236:239], v[40:43], v[148:151], v[236:239]
  v_lshlrev_b32 v50, 4, v49
  v_add3_u32 v182, v182, v50, s90
  s_waitcnt lgkmcnt(4)
  v_mfma_f32_16x16x32_bf16 v[248:251], v[44:47], v[152:155], v[248:251]
  v_xor_b32 v50, v49, v48
  v_lshlrev_b32 v50, 4, v50
  v_add_u32 v8, 0xfffe8000, v8
  ds_read_b64_tr_b16 v[40:41], v8 offset:0
  ds_read_b64_tr_b16 v[42:43], v8 offset:1024
  v_mfma_f32_16x16x32_bf16 v[240:243], v[44:47], v[148:151], v[240:243]
  v_lshlrev_b32 v51, 7, v48
  v_add3_u32 v183, v50, v51, s91
  v_mov_b32 v152, 0
  v_mov_b32 v153, 0
  v_mov_b32 v154, 0
  v_mov_b32 v155, 0
  s_waitcnt lgkmcnt(4)
  v_mfma_f32_16x16x32_bf16 v[244:247], v[32:35], v[12:15], v[244:247]
  v_lshrrev_b32 v232, 4, v0
  v_and_b32 v233, 15, v0
  v_add_u32 v9, 0xfffe8000, v9
  ds_read_b64_tr_b16 v[44:45], v9 offset:0
  ds_read_b64_tr_b16 v[46:47], v9 offset:1024
  v_mfma_f32_16x16x32_bf16 v[236:239], v[32:35], v[252:255], v[236:239]
  v_xor_b32 v50, v232, v49
  v_lshlrev_b32 v50, 4, v50
  s_waitcnt lgkmcnt(4)
  v_mfma_f32_16x16x32_bf16 v[248:251], v[36:39], v[12:15], v[248:251]
  v_lshlrev_b32 v51, 7, v233
  v_add3_u32 v184, v50, v51, s91
  ds_read_b64_tr_b16 v[32:33], v8 offset:8192
  ds_read_b64_tr_b16 v[34:35], v8 offset:9216
  v_mfma_f32_16x16x32_bf16 v[240:243], v[36:39], v[252:255], v[240:243]
  v_xor_b32 v185, 64, v184
  v_bfe_u32 v50, v0, 1, 2
  s_waitcnt lgkmcnt(4)
  v_mfma_f32_16x16x32_bf16 v[244:247], v[40:43], v[56:59], v[244:247]
  v_xor_b32 v50, v50, v232
  v_lshlrev_b32 v50, 4, v50
  ds_read_b64_tr_b16 v[36:37], v9 offset:8192
  ds_read_b64_tr_b16 v[38:39], v9 offset:9216
  v_mfma_f32_16x16x32_bf16 v[236:239], v[40:43], v[52:55], v[236:239]
  v_lshlrev_b32 v51, 6, v233
  v_add3_u32 v186, v50, v51, s91
  s_waitcnt lgkmcnt(4)
  v_mfma_f32_16x16x32_bf16 v[248:251], v[44:47], v[56:59], v[248:251]
  v_lshrrev_b32 v234, 2, v0
  v_and_b32 v235, 3, v0
  ds_read_b64_tr_b16 v[40:41], v8 offset:16384
  ds_read_b64_tr_b16 v[42:43], v8 offset:17408
  v_mfma_f32_16x16x32_bf16 v[240:243], v[44:47], v[52:55], v[240:243]
  v_bfe_u32 v50, v0, 3, 2
  v_xor_b32 v50, v50, v235
  s_waitcnt lgkmcnt(4)
  v_mfma_f32_16x16x32_bf16 v[244:247], v[32:35], v[64:67], v[244:247]
  v_lshlrev_b32 v50, 4, v50
  v_lshlrev_b32 v51, 6, v234
  ds_read_b64_tr_b16 v[44:45], v9 offset:16384
  ds_read_b64_tr_b16 v[46:47], v9 offset:17408
  v_mfma_f32_16x16x32_bf16 v[236:239], v[32:35], v[60:63], v[236:239]
  v_add3_u32 v187, v50, v51, s91
  v_mul_u32_u24 v162, 0x900, v234
  s_waitcnt lgkmcnt(4)
  v_mfma_f32_16x16x32_bf16 v[248:251], v[36:39], v[64:67], v[248:251]
  v_lshlrev_b32 v50, 4, v235
  v_add3_u32 v162, v162, v50, s90
  ds_read_b64_tr_b16 v[32:33], v8 offset:24576
  ds_read_b64_tr_b16 v[34:35], v8 offset:25600
  v_mfma_f32_16x16x32_bf16 v[240:243], v[36:39], v[60:63], v[240:243]
  s_waitcnt lgkmcnt(4)
  v_mfma_f32_16x16x32_bf16 v[244:247], v[40:43], v[24:27], v[244:247]
  ds_read_b64_tr_b16 v[36:37], v9 offset:24576
  ds_read_b64_tr_b16 v[38:39], v9 offset:25600
  v_mfma_f32_16x16x32_bf16 v[236:239], v[40:43], v[20:23], v[236:239]
  s_waitcnt lgkmcnt(4)
  v_mfma_f32_16x16x32_bf16 v[248:251], v[44:47], v[24:27], v[248:251]
  ds_read_b64_tr_b16 v[40:41], v8 offset:32768
  ds_read_b64_tr_b16 v[42:43], v8 offset:33792
  v_mfma_f32_16x16x32_bf16 v[240:243], v[44:47], v[20:23], v[240:243]
  s_waitcnt vmcnt(5)
  v_mfma_f32_16x16x32_bf16 v[220:223], v[178:181], v[200:203], v[164:167]
  s_waitcnt vmcnt(0)
  v_cmp_gt_u32 vcc, 4, v29
  s_nop 2
  s_and_b32 s73, vcc_lo, s51
  s_mov_b32 s95, s72
  s_cmp_eq_u32 s72, 0
  s_cbranch_scc1 SKIP_3B
  v_cmp_gt_u32 vcc, 2, v29
  s_add_u32 s100, s66, 8192
  buffer_load_dwordx4 v[200:203], v5, s[24:27], s100 offen offset:0 sc1
  buffer_load_dwordx4 v[204:207], v5, s[24:27], s100 offen offset:1024 sc1
  buffer_load_dwordx4 v[208:211], v5, s[24:27], s100 offen offset:2048 sc1
  buffer_load_dwordx4 v[212:215], v5, s[24:27], s100 offen offset:3072 sc1
  s_and_b32 s72, vcc_lo, 0xff0
SKIP_3B:
  buffer_load_dwordx4 v[148:151], v5, s[24:27], s66 offen offset:2048 sc1
  s_waitcnt lgkmcnt(4)
  v_mfma_f32_16x16x32_bf16 v[244:247], v[32:35], v[72:75], v[244:247]
  ds_read_b64_tr_b16 v[44:45], v9 offset:32768
  ds_read_b64_tr_b16 v[46:47], v9 offset:33792
  v_mfma_f32_16x16x32_bf16 v[224:227], v[176:179], v[200:203], v[168:171]
  v_mfma_f32_16x16x32_bf16 v[236:239], v[32:35], v[68:71], v[236:239]
  s_mov_b32 exec_hi, 0
  buffer_load_dwordx4 v[152:155], v5, s[24:27], s66 offen offset:3072 sc1
  s_mov_b32 exec_hi, -1
  s_waitcnt lgkmcnt(4)
  v_mfma_f32_16x16x32_bf16 v[248:251], v[36:39], v[72:75], v[248:251]
  ds_read_b64_tr_b16 v[32:33], v8 offset:40960
  ds_read_b64_tr_b16 v[34:35], v8 offset:41984
  v_mfma_f32_16x16x32_bf16 v[220:223], v[178:181], v[204:207], v[220:223]
  v_mfma_f32_16x16x32_bf16 v[240:243], v[36:39], v[68:71], v[240:243]
  s_add_u32 s100, s66, 4096
  buffer_load_dwordx4 v[112:115], v5, s[24:27], s100 offen offset:1024 sc1
  s_waitcnt lgkmcnt(4)
  v_mfma_f32_16x16x32_bf16 v[244:247], v[40:43], v[80:83], v[244:247]
  ds_read_b64_tr_b16 v[36:37], v9 offset:40960
  ds_read_b64_tr_b16 v[38:39], v9 offset:41984
  v_mfma_f32_16x16x32_bf16 v[224:227], v[176:179], v[204:207], v[224:227]
  v_mfma_f32_16x16x32_bf16 v[236:239], v[40:43], v[76:79], v[236:239]
  s_add_u32 s100, s66, 4096
  buffer_load_dwordx4 v[116:119], v5, s[24:27], s100 offen offset:2048 sc1
  s_waitcnt lgkmcnt(4)
  v_mfma_f32_16x16x32_bf16 v[248:251], v[44:47], v[80:83], v[248:251]
  ds_read_b64_tr_b16 v[40:41], v8 offset:49152
  ds_read_b64_tr_b16 v[42:43], v8 offset:50176
  v_mfma_f32_16x16x32_bf16 v[220:223], v[178:181], v[208:211], v[220:223]
  v_mfma_f32_16x16x32_bf16 v[240:243], v[44:47], v[76:79], v[240:243]
  buffer_load_dwordx4 v[140:143], v5, s[24:27], s66 offen offset:0 sc1
  s_waitcnt lgkmcnt(4)
  v_mfma_f32_16x16x32_bf16 v[244:247], v[32:35], v[96:99], v[244:247]
  ds_read_b64_tr_b16 v[44:45], v9 offset:49152
  ds_read_b64_tr_b16 v[46:47], v9 offset:50176
  v_mfma_f32_16x16x32_bf16 v[224:227], v[176:179], v[208:211], v[224:227]
  v_mfma_f32_16x16x32_bf16 v[236:239], v[32:35], v[92:95], v[236:239]
  buffer_load_dwordx4 v[144:147], v5, s[24:27], s66 offen offset:1024 sc1
  s_waitcnt lgkmcnt(4)
  v_mfma_f32_16x16x32_bf16 v[248:251], v[36:39], v[96:99], v[248:251]
  ds_read_b64_tr_b16 v[32:33], v8 offset:57344
  ds_read_b64_tr_b16 v[34:35], v8 offset:58368
  v_mfma_f32_16x16x32_bf16 v[220:223], v[178:181], v[212:215], v[220:223]
  v_mfma_f32_16x16x32_bf16 v[240:243], v[36:39], v[92:95], v[240:243]
  s_add_u32 s100, s66, 4096
  buffer_load_dwordx4 v[108:111], v5, s[24:27], s100 offen offset:0 sc1
  s_or_b32 s73, s73, s72
  s_cbranch_scc0 SKIP_RP
  s_mov_b64 exec, 0xff0
  buffer_load_dword v19, v2, s[32:35], 0 offen sc1
  s_mov_b64 exec, -1
SKIP_RP:
  s_waitcnt lgkmcnt(4)
  v_mfma_f32_16x16x32_bf16 v[244:247], v[40:43], v[104:107], v[244:247]
  ds_read_b64_tr_b16 v[36:37], v9 offset:57344
  ds_read_b64_tr_b16 v[38:39], v9 offset:58368
  v_mfma_f32_16x16x32_bf16 v[224:227], v[176:179], v[212:215], v[224:227]
  v_mfma_f32_16x16x32_bf16 v[236:239], v[40:43], v[100:103], v[236:239]
  s_waitcnt lgkmcnt(4)
  v_mfma_f32_16x16x32_bf16 v[248:251], v[44:47], v[104:107], v[248:251]
  v_add_u32 v8, 0x1a000, v8
  ds_read_b64_tr_b16 v[40:41], v8 offset:0
  ds_read_b64_tr_b16 v[42:43], v8 offset:1024
  v_mfma_f32_16x16x32_bf16 v[240:243], v[44:47], v[100:103], v[240:243]
  s_waitcnt lgkmcnt(4)
  v_mfma_f32_16x16x32_bf16 v[244:247], v[32:35], v[88:91], v[244:247]
  v_add_u32 v9, 0x1a000, v9
  ds_read_b64_tr_b16 v[44:45], v9 offset:0
  ds_read_b64_tr_b16 v[46:47], v9 offset:1024
  v_mfma_f32_16x16x32_bf16 v[236:239], v[32:35], v[84:87], v[236:239]
  s_waitcnt lgkmcnt(4)
  v_mfma_f32_16x16x32_bf16 v[248:251], v[36:39], v[88:91], v[248:251]
  v_mfma_f32_16x16x32_bf16 v[240:243], v[36:39], v[84:87], v[240:243]
  s_waitcnt lgkmcnt(2)
  v_mfma_f32_16x16x32_bf16 v[244:247], v[40:43], v[128:131], v[244:247]
  v_mfma_f32_16x16x32_bf16 v[236:239], v[40:43], v[124:127], v[236:239]
  s_waitcnt lgkmcnt(0)
  v_mfma_f32_16x16x32_bf16 v[248:251], v[44:47], v[128:131], v[248:251]
  v_mfma_f32_16x16x32_bf16 v[240:243], v[44:47], v[124:127], v[240:243]
  s_nop 3
  ds_write_b128 v4, v[244:247] offset:2048
  s_nop 1
  ds_write_b128 v4, v[248:251] offset:3072
  s_waitcnt lgkmcnt(0)
  s_barrier
  v_xor_b32 v248, 0x1000, v4
  ds_read_b128 v[244:247], v248 offset:2048
  ds_read_b128 v[248:251], v248 offset:3072
  s_waitcnt lgkmcnt(1)
  v_add_f32 v236, v236, v244
  v_add_f32 v237, v237, v245
  v_add_f32 v238, v238, v246
  v_add_f32 v239, v239, v247
  s_waitcnt lgkmcnt(0)
  v_add_f32 v240, v240, v248
  v_add_f32 v241, v241, v249
  v_add_f32 v242, v242, v250
  v_add_f32 v243, v243, v251
  s_cmp_eq_u32 s73, 0
  s_cbranch_scc1 LBACK_4
LATE_W:
  s_waitcnt vmcnt(0)
  v_cmp_gt_u32 vcc, 2, v19
  v_cmp_gt_u32 s[90:91], 4, v19
  s_nop 2
  s_and_b32 vcc_lo, vcc_lo, 0xff0
  s_and_b32 s90, s90, s51
  s_or_b32 s90, s90, vcc_lo
  s_cbranch_scc1 LATE_P
LATE_L:
  s_cmp_eq_u32 s72, 0
  s_cbranch_scc1 LATE_G
  s_add_u32 s100, s66, 8192
  buffer_load_dwordx4 v[200:203], v5, s[24:27], s100 offen offset:0 sc1
  buffer_load_dwordx4 v[204:207], v5, s[24:27], s100 offen offset:1024 sc1
  buffer_load_dwordx4 v[208:211], v5, s[24:27], s100 offen offset:2048 sc1
  buffer_load_dwordx4 v[212:215], v5, s[24:27], s100 offen offset:3072 sc1
LATE_G:
  buffer_load_dwordx4 v[148:151], v5, s[24:27], s66 offen offset:2048 sc1
  s_mov_b32 exec_hi, 0
  buffer_load_dwordx4 v[152:155], v5, s[24:27], s66 offen offset:3072 sc1
  s_mov_b32 exec_hi, -1
  s_add_u32 s100, s66, 4096
  buffer_load_dwordx4 v[112:115], v5, s[24:27], s100 offen offset:1024 sc1
  buffer_load_dwordx4 v[116:119], v5, s[24:27], s100 offen offset:2048 sc1
  buffer_load_dwordx4 v[140:143], v5, s[24:27], s66 offen offset:0 sc1
  buffer_load_dwordx4 v[144:147], v5, s[24:27], s66 offen offset:1024 sc1
  buffer_load_dwordx4 v[108:111], v5, s[24:27], s100 offen offset:0 sc1
LBACK_4:
  s_waitcnt vmcnt(6)
  s_cmp_eq_u32 s95, 0
  s_cbranch_scc1 NO_REDO
  v_mfma_f32_16x16x32_bf16 v[220:223], v[178:181], v[200:203], v[164:167]
  v_mfma_f32_16x16x32_bf16 v[224:227], v[176:179], v[200:203], v[168:171]
  v_mfma_f32_16x16x32_bf16 v[220:223], v[178:181], v[204:207], v[220:223]
  v_mfma_f32_16x16x32_bf16 v[224:227], v[176:179], v[204:207], v[224:227]
  v_mfma_f32_16x16x32_bf16 v[220:223], v[178:181], v[208:211], v[220:223]
  v_mfma_f32_16x16x32_bf16 v[224:227], v[176:179], v[208:211], v[224:227]
  v_mfma_f32_16x16x32_bf16 v[220:223], v[178:181], v[212:215], v[220:223]
  v_mfma_f32_16x16x32_bf16 v[224:227], v[176:179], v[212:215], v[224:227]
NO_REDO:
  v_mfma_f32_16x16x32_bf16 v[156:159], v[216:219], v[148:151], v[156:159]
  s_waitcnt vmcnt(5)
  v_mfma_f32_16x16x32_bf16 v[156:159], v[216:219], v[152:155], v[156:159]
  s_waitcnt vmcnt(4)
  v_mfma_f32_16x16x32_bf16 v[236:239], v[178:181], v[112:115], v[236:239]
  v_mfma_f32_16x16x32_bf16 v[240:243], v[176:179], v[112:115], v[240:243]
  s_waitcnt vmcnt(3)
  v_mfma_f32_16x16x32_bf16 v[236:239], v[178:181], v[116:119], v[236:239]
  v_mfma_f32_16x16x32_bf16 v[240:243], v[176:179], v[116:119], v[240:243]
  s_nop 3
  v_mul_f32 v120, v161, v156
  v_mul_f32 v121, v161, v157
  v_mul_f32 v122, v161, v158
  v_mul_f32 v123, v161, v159
  v_exp_f32 v120, v120
  v_exp_f32 v121, v121
  v_exp_f32 v122, v122
  v_exp_f32 v123, v123
  v_fma_f32 v120, v120, v160, v160
  v_fma_f32 v121, v121, v160, v160
  v_fma_f32 v122, v122, v160, v160
  v_fma_f32 v123, v123, v160, v160
  v_rcp_f32 v120, v120
  v_rcp_f32 v121, v121
  v_rcp_f32 v122, v122
  v_rcp_f32 v123, v123
  v_mul_f32 v156, v120, v156
  v_mul_f32 v157, v121, v157
  v_mul_f32 v158, v122, v158
  v_mul_f32 v159, v123, v159
  s_waitcnt vmcnt(0)
  v_max3_u32 v132, v108, v109, v110
  v_max_u32 v132, v132, v111
  v_cmp_eq_u32 vcc, -1, v132
  s_nop 2
  s_or_b32 vcc_lo, vcc_lo, vcc_hi
  s_cbranch_scc1 SPIN_mg3
BACK_mg3:
  v_mfma_f32_16x16x32_bf16 v[236:239], v[178:181], v[108:111], v[236:239]
  v_mfma_f32_16x16x32_bf16 v[240:243], v[176:179], v[108:111], v[240:243]
  v_mfma_f32_16x16x32_bf16 v[44:47], v[216:219], v[140:143], v[172:175]
  v_mfma_f32_16x16x32_bf16 v[44:47], v[216:219], v[144:147], v[44:47]
  v_max3_u32 v124, v140, v141, v142
  v_max3_u32 v124, v124, v143, v144
  v_max3_u32 v124, v124, v145, v146
  v_max_u32 v124, v124, v147
  v_cmp_eq_u32 vcc, -1, v124
  v_mul_f32 v132, v161, v236
  v_mul_f32 v133, v161, v237
  v_mul_f32 v134, v161, v238
  v_mul_f32 v135, v161, v239
  v_mul_f32 v136, v161, v240
  v_mul_f32 v137, v161, v241
  v_mul_f32 v138, v161, v242
  v_mul_f32 v139, v161, v243
  v_exp_f32 v132, v132
  v_mul_f32 v236, v220, v236
  v_exp_f32 v133, v133
  v_mul_f32 v237, v221, v237
  v_exp_f32 v134, v134
  v_mul_f32 v238, v222, v238
  v_exp_f32 v135, v135
  v_mul_f32 v239, v223, v239
  v_exp_f32 v136, v136
  v_mul_f32 v240, v224, v240
  v_exp_f32 v137, v137
  v_mul_f32 v241, v225, v241
  v_exp_f32 v138, v138
  v_mul_f32 v242, v226, v242
  v_exp_f32 v139, v139
  v_mul_f32 v243, v227, v243
  v_fma_f32 v132, v132, v160, v160
  v_fma_f32 v133, v133, v160, v160
  v_fma_f32 v134, v134, v160, v160
  v_fma_f32 v135, v135, v160, v160
  v_fma_f32 v136, v136, v160, v160
  v_fma_f32 v137, v137, v160, v160
  v_fma_f32 v138, v138, v160, v160
  v_fma_f32 v139, v139, v160, v160
  v_rcp_f32 v132, v132
  v_rcp_f32 v133, v133
  v_rcp_f32 v134, v134
  v_rcp_f32 v135, v135
  v_rcp_f32 v136, v136
  v_rcp_f32 v137, v137
  v_rcp_f32 v138, v138
  v_rcp_f32 v139, v139
  v_fmac_f32 v188, v132, v236
  v_fmac_f32 v189, v133, v237
  v_fmac_f32 v190, v134, v238
  v_fmac_f32 v191, v135, v239
  ds_write_b128 v184, v[188:191]
  v_fmac_f32 v192, v136, v240
  v_fmac_f32 v193, v137, v241
  v_fmac_f32 v194, v138, v242
  v_fmac_f32 v195, v139, v243
  ds_write_b128 v185, v[192:195]
  ds_read_b128 v[32:35], v183
  ds_read_b128 v[36:39], v183 offset:1024
  s_or_b32 vcc_lo, vcc_lo, vcc_hi
  s_cbranch_scc1 SPIN_mg2
  v_fmac_f32 v196, v44, v156
  v_fmac_f32 v197, v45, v157
  v_fmac_f32 v198, v46, v158
  v_fmac_f32 v199, v47, v159
  ds_write_b128 v186, v[196:199]
  ds_read_b128 v[40:43], v187
  s_waitcnt lgkmcnt(3)
  buffer_store_dwordx4 v[32:35], v182, s[96:99], 0 offen sc0 sc1
  s_waitcnt lgkmcnt(2)
  buffer_store_dwordx4 v[36:39], v182, s[96:99], s101 offen sc0 sc1
BACK_mg2:
  s_waitcnt lgkmcnt(0)
  buffer_store_dwordx4 v[40:43], v162, s[96:99], s71 offen sc0 sc1
  s_endpgm
SPIN_mc:
  s_add_u32 s89, s89, 1
  s_cmp_gt_u32 s89, 200000
  s_cbranch_scc1 BACK_mc
  s_sleep 1
  buffer_load_dword v29, off, s[96:99], s87 sc1
  s_waitcnt vmcnt(0)
  v_cmp_ne_u32 vcc, 0xffff, v29
  s_nop 3
  s_and_b32 vcc_lo, vcc_lo, 1
  s_cbranch_scc1 SPIN_mc
  s_branch BACK_mc
SPIN_mh0:
  s_add_u32 s89, s89, 1
  s_cmp_gt_u32 s89, 200000
  s_cbranch_scc1 BACK_mh0
  s_sleep 1
  s_mov_b64 exec, 0x7
  buffer_load_dword v29, v2, s[32:35], 0 offen sc1
  s_mov_b64 exec, -1
  s_waitcnt vmcnt(0)
  v_cmp_gt_u32 vcc, 1, v29
  s_nop 3
  s_and_b32 vcc_lo, vcc_lo, s62
  s_cbranch_scc1 SPIN_mh0
  s_branch BACK_mh0
SPIN_mh1:
  s_add_u32 s89, s89, 1
  s_cmp_gt_u32 s89, 200000
  s_cbranch_scc1 BACK_mh1
  s_sleep 1
  s_mov_b64 exec, 0x7
  buffer_load_dword v29, v2, s[32:35], 0 offen sc1
  s_mov_b64 exec, -1
  s_waitcnt vmcnt(0)
  v_cmp_gt_u32 vcc, 2, v29
  s_nop 3
  s_and_b32 vcc_lo, vcc_lo, s62
  s_cbranch_scc1 SPIN_mh1
  s_branch BACK_mh1
SPIN_mh2:
  s_add_u32 s89, s89, 1
  s_cmp_gt_u32 s89, 200000
  s_cbranch_scc1 BACK_mh2
  s_sleep 1
  s_mov_b64 exec, 0x7
  buffer_load_dword v19, v2, s[32:35], 0 offen sc1
  s_mov_b64 exec, -1
  s_waitcnt vmcnt(0)
  v_cmp_gt_u32 vcc, 3, v19
  s_nop 3
  s_and_b32 vcc_lo, vcc_lo, s62
  s_cbranch_scc1 SPIN_mh2
  s_branch BACK_mh2
SPIN_mg3:
  s_add_u32 s89, s89, 1
  s_cmp_gt_u32 s89, 200000
  s_cbranch_scc1 BACK_mg3
  s_sleep 1
  s_add_u32 s100, s66, 4096
  buffer_load_dwordx4 v[108:111], v5, s[24:27], s100 offen offset:0 sc1
  s_waitcnt vmcnt(0)
  v_max3_u32 v132, v108, v109, v110
  v_max_u32 v132, v132, v111
  v_cmp_eq_u32 vcc, -1, v132
  s_nop 3
  s_or_b32 vcc_lo, vcc_lo, vcc_hi
  s_cbranch_scc1 SPIN_mg3
  s_branch BACK_mg3
SPIN_mg2:
  s_waitcnt lgkmcnt(0)
  buffer_store_dwordx4 v[32:35], v182, s[96:99], 0 offen sc0 sc1
  buffer_store_dwordx4 v[36:39], v182, s[96:99], s101 offen sc0 sc1
SPIN_mg2L:
  s_add_u32 s89, s89, 1
  s_cmp_gt_u32 s89, 200000
  s_cbranch_scc1 FIX_mg2
  s_sleep 1
  buffer_load_dwordx4 v[140:143], v5, s[24:27], s66 offen offset:0 sc1
  buffer_load_dwordx4 v[144:147], v5, s[24:27], s66 offen offset:1024 sc1
  s_waitcnt vmcnt(0)
  v_max3_u32 v124, v140, v141, v142
  v_max3_u32 v124, v124, v143, v144
  v_max3_u32 v124, v124, v145, v146
  v_max_u32 v124, v124, v147
  v_cmp_eq_u32 vcc, -1, v124
  s_nop 3
  s_or_b32 vcc_lo, vcc_lo, vcc_hi
  s_cbranch_scc1 SPIN_mg2L
FIX_mg2:
  v_mfma_f32_16x16x32_bf16 v[44:47], v[216:219], v[140:143], v[172:175]
  v_mfma_f32_16x16x32_bf16 v[44:47], v[216:219], v[144:147], v[44:47]
  s_nop 7
  v_fmac_f32 v196, v44, v156
  v_fmac_f32 v197, v45, v157
  v_fmac_f32 v198, v46, v158
  v_fmac_f32 v199, v47, v159
  ds_write_b128 v186, v[196:199]
  ds_read_b128 v[40:43], v187
  s_branch BACK_mg2
LATE_P:
  s_add_u32 s89, s89, 1
  s_cmp_gt_u32 s89, 200000
  s_cbranch_scc1 LATE_L
  s_mov_b64 exec, 0xff0
  buffer_load_dword v19, v2, s[32:35], 0 offen sc1
  s_mov_b64 exec, -1
  s_branch LATE_W
K1_SSM:
  s_sub_u32 s82, s7, 12
  s_bitcmp1_b32 s3, 1
  s_cselect_b32 s44, s56, s54
  s_cselect_b32 s45, s57, s55
  s_cselect_b32 s46, s60, s58
  s_cselect_b32 s47, s61, s59
  s_lshl_b32 s40, s82, 4
  s_lshl_b32 s41, s5, 1
  s_add_u32 s40, s40, s41
  s_and_b32 s42, s3, 1
  s_add_u32 s40, s40, s42
  s_mul_i32 s40, s40, 9216
  s_sub_u32 s41, 663552, s40
  s_add_u32 s12, s44, s40
  s_addc_u32 s13, s45, 0
  s_mov_b32 s14, s41
  s_mov_b32 s15, 0x00020000
  v_lshrrev_b32 v101, 3, v0
  v_mul_u32_u24 v101, 0x480, v101
  v_lshrrev_b32 v102, 4, v0
  v_xor_b32 v102, v102, v0
  s_lshl_b32 s42, s42, 2
  v_xor_b32 v102, s42, v102
  v_and_b32 v102, 7, v102
  v_lshl_add_u32 v6, v102, 4, v101
  s_lshl_b32 s40, s82, 5
  s_add_u32 s40, s40, 1024
  s_sub_u32 s41, 663552, s40
  s_add_u32 s92, s46, s40
  s_addc_u32 s93, s47, 0
  s_mov_b32 s94, s41
  s_mov_b32 s95, 0x00020000
  v_and_b32 v101, 31, v0
  s_lshl_b32 s40, s82, 8
  v_lshl_add_u32 v102, v101, 1, s40
  v_and_b32 v103, 15, v0
  s_lshl_b32 s40, s82, 5
  v_lshl_add_u32 v103, v103, 1, s40
  s_mov_b32 s96, s50
  s_mov_b32 s97, s51
  s_mov_b32 s98, 1152
  s_mov_b32 s99, 0x00020000
  buffer_load_ushort v76, v102, s[96:99], 0 offen offset:0
  buffer_load_ushort v78, v102, s[96:99], 0 offen offset:64
  buffer_load_ushort v80, v102, s[96:99], 0 offen offset:128
  buffer_load_ushort v82, v102, s[96:99], 0 offen offset:192
  buffer_load_ushort v84, v103, s[96:99], 0 offen offset:1024
  s_mov_b32 s96, s52
  s_mov_b32 s97, s53
  s_mov_b32 s98, 1152
  s_mov_b32 s99, 0x00020000
  buffer_load_ushort v77, v102, s[96:99], 0 offen offset:0
  buffer_load_ushort v79, v102, s[96:99], 0 offen offset:64
  buffer_load_ushort v81, v102, s[96:99], 0 offen offset:128
  buffer_load_ushort v83, v102, s[96:99], 0 offen offset:192
  buffer_load_ushort v85, v103, s[96:99], 0 offen offset:1024
  s_mov_b32 s96, s62
  s_mov_b32 s97, s63
  s_mov_b32 s98, 1152
  s_mov_b32 s99, 0x00020000
  buffer_load_ushort v86, v102, s[96:99], 0 offen offset:0
  buffer_load_ushort v87, v102, s[96:99], 0 offen offset:64
  buffer_load_ushort v88, v102, s[96:99], 0 offen offset:128
  buffer_load_ushort v89, v102, s[96:99], 0 offen offset:192
  buffer_load_ushort v90, v103, s[96:99], 0 offen offset:1024
  s_bfe_u32 s40, s0, 0x40000
  s_add_u32 m0, s39, 106496
  s_lshl_b32 s40, s40, 7
  buffer_load_dwordx4 v4, s[8:11], s40 offen lds
  s_bfe_u32 s41, s0, 0x40000
  s_add_u32 m0, s39, 107520
  s_lshl_b32 s41, s41, 7
  buffer_load_dwordx4 v5, s[8:11], s41 offen lds
  s_add_u32 m0, s36, 122880
  s_bfe_u32 s42, s0, 0x40000
  s_lshl_b32 s42, s42, 7
  buffer_load_dwordx4 v6, s[12:15], s42 offen lds
  s_bfe_u32 s43, s0, 0x40004
  s_add_u32 m0, s39, 131072
  s_lshl_b32 s43, s43, 7
  buffer_load_dwordx4 v4, s[8:11], s43 offen lds
  s_bfe_u32 s44, s0, 0x40004
  s_add_u32 m0, s39, 132096
  s_lshl_b32 s44, s44, 7
  buffer_load_dwordx4 v5, s[8:11], s44 offen lds
  s_add_u32 m0, s36, 147456
  s_bfe_u32 s45, s0, 0x40004
  s_lshl_b32 s45, s45, 7
  buffer_load_dwordx4 v6, s[12:15], s45 offen lds
  v_and_b32 v101, 15, v0
  s_lshl_b32 s40, s5, 7
  s_add_u32 s40, s40, 139264
  v_lshl_add_u32 v15, v101, 3, s40
  v_bfe_u32 v102, v0, 4, 1
  v_lshrrev_b32 v103, 5, v0
  v_lshl_add_u32 v102, v102, 1, v103
  v_lshl_add_u32 v16, v102, 8, v15
  s_lshl_b32 s40, s4, 8
  v_add_u32 v17, s40, v15
  s_lshl_b32 s40, s3, 7
  s_add_u32 s40, s40, 162816
  v_lshl_add_u32 v14, v102, 5, s40
  s_lshl_b32 s40, s4, 12
  s_add_u32 s40, s40, 106496
  s_lshl_b32 s41, s5, 11
  s_add_u32 s41, s41, s40
  v_lshl_add_u32 v101, v101, 6, s41
  v_bfe_u32 v100, v0, 1, 1
  v_xor_b32 v102, v102, v100
  v_lshl_add_u32 v18, v102, 4, v101
  v_lshl_add_u32 v101, v103, 9, s40
  v_bfe_u32 v102, v0, 2, 2
  v_lshl_add_u32 v101, v102, 6, v101
  v_bfe_u32 v102, v0, 4, 1
  v_lshl_add_u32 v101, v102, 5, v101
  v_and_b32 v102, 3, v0
  v_lshl_add_u32 v19, v102, 3, v101
  v_lshlrev_b32 v102, 1, v0
  v_and_b32 v102, 16, v102
  v_xor_b32 v19, v102, v19
  s_mul_i32 s40, s82, 20480
  s_lshl_b32 s41, s6, 8
  s_sub_u32 s40, s40, s41
  s_add_u32 s40, s40, 37695232
  s_cmp_eq_u32 s4, 3
  s_cselect_b32 s42, 139520, 0
  s_cselect_b32 s43, 0, 0x1000
  s_add_u32 s28, s80, s40
  s_addc_u32 s29, s81, 0
  s_mov_b32 s30, s42
  s_mov_b32 s31, 0x00020000
  s_sub_u32 s40, s40, 16128
  s_add_u32 s41, s41, 139264
  s_add_u32 s32, s80, s40
  s_addc_u32 s33, s81, 0
  s_mov_b32 s34, s41
  s_mov_b32 s35, 0x00020000
  s_lshl4_add_u32 s40, s6, s7
  s_lshl_b32 s40, s40, 7
  s_add_u32 s40, s40, 37945344
  s_cmp_eq_u32 s3, 0
  s_cselect_b32 s41, 4, 0
  s_add_u32 s24, s80, s40
  s_addc_u32 s25, s81, 0
  s_mov_b32 s26, s41
  s_mov_b32 s27, 0x00020000
  v_mov_b32 v101, 0
  s_mov_b64 exec, 1
  buffer_store_dword v101, off, s[24:27], 0 sc1
  s_mov_b64 exec, -1
  s_mov_b32 s96, s78
  s_mov_b32 s97, s79
  s_mov_b32 s98, 256
  s_mov_b32 s99, 0x00020000
  s_lshl_b32 s40, s82, 1
  s_add_u32 s40, s40, s5
  s_lshl_b32 s101, s40, 4
  s_add_u32 s43, s43, s101
  v_mov_b32 v62, s43
  s_lshl_b32 s40, 1, s6
  v_mov_b32 v63, s40
  s_sub_u32 s87, s40, 1
  s_bfe_u32 s46, s0, 0x40008
  s_add_u32 m0, s39, 81920
  s_lshl_b32 s46, s46, 7
  buffer_load_dwordx4 v4, s[8:11], s46 offen lds
  s_bfe_u32 s47, s0, 0x40008
  s_add_u32 m0, s39, 82944
  s_lshl_b32 s47, s47, 7
  buffer_load_dwordx4 v5, s[8:11], s47 offen lds
  s_add_u32 m0, s36, 98304
  s_bfe_u32 s40, s0, 0x40008
  s_lshl_b32 s40, s40, 7
  buffer_load_dwordx4 v6, s[12:15], s40 offen lds
  s_mul_i32 s40, s3, 9216
  s_lshl_b32 s41, s82, 8
  s_add_u32 s40, s40, s41
  s_sub_u32 s41, 663552, s40
  s_add_u32 s16, s58, s40
  s_addc_u32 s17, s59, 0
  s_mov_b32 s18, s41
  s_mov_b32 s19, 0x00020000
  s_add_u32 s20, s60, s40
  s_addc_u32 s21, s61, 0
  s_mov_b32 s22, s41
  s_mov_b32 s23, 0x00020000
  s_lshl_b32 s40, s6, 4
  s_add_u32 s40, s40, s7
  s_lshl_b32 s40, s40, 2
  s_add_u32 s40, s40, s4
  s_mul_i32 s40, s40, 36864
  s_mul_i32 s40, s6, 24
  s_add_u32 s40, s40, s5
  s_mul_i32 s40, s40, 192
  s_add_u32 s40, s40, s82
  s_lshl_b32 s40, s40, 9
  s_add_u32 s24, s80, s40
  s_addc_u32 s25, s81, 0
  s_mov_b32 s26, 2162688
  s_mov_b32 s27, 0x00020000
  s_mul_i32 s40, s82, 7
  s_add_u32 s40, s40, s5
  s_sub_u32 s40, 32, s40
  s_mul_i32 s83, s40, 18432
  s_mul_i32 s86, s5, 73728
  s_mov_b32 s90, 0
  s_mov_b32 s89, 0
  s_mov_b32 s91, -1
  v_and_b32 v101, 31, v0
  s_lshl_b32 s40, s5, 5
  v_add_u32 v102, s40, v101
  v_bfe_u32 v103, v101, 1, 3
  v_lshrrev_b32 v100, 5, v0
  v_xor_b32 v103, v103, v100
  s_lshl_b32 s40, s38, 1
  v_xor_b32 v103, s40, v103
  v_lshlrev_b32 v103, 4, v103
  v_lshl_add_u32 v8, v102, 7, v103
  v_xor_b32 v9, 32, v8
  v_xor_b32 v10, 64, v8
  v_xor_b32 v11, 96, v8
  v_and_b32 v101, 31, v0
  v_lshrrev_b32 v102, 1, v0
  v_xor_b32 v102, v102, v0
  v_bfe_u32 v102, v102, 2, 1
  v_mul_u32_u24 v102, 12, v102
  v_xor_b32 v101, v101, v102
  s_lshl_b32 s40, s4, 5
  v_add_u32 v102, s40, v101
  v_bfe_u32 v103, v101, 1, 3
  v_lshrrev_b32 v100, 5, v0
  v_xor_b32 v103, v103, v100
  s_lshl_b32 s40, s38, 1
  v_xor_b32 v103, s40, v103
  v_lshlrev_b32 v103, 4, v103
  v_lshl_add_u32 v64, v102, 7, v103
  v_xor_b32 v65, 32, v64
  v_xor_b32 v66, 64, v64
  v_xor_b32 v67, 96, v64
  s_lshl_b32 s40, s3, 7
  s_add_u32 s40, s40, 162816
  v_lshl_add_u32 v1, v101, 2, s40
  v_and_b32 v101, 31, v0
  s_lshl_b32 s40, s5, 9
  s_add_u32 s40, s40, 159744
  v_lshl_add_u32 v103, v101, 4, s40
  v_lshl_add_u32 v7, v100, 3, v103
  s_lshl_b32 s41, s4, 2
  v_add_u32 v13, s41, v103
  s_lshl_b32 s40, s4, 10
  s_add_u32 s40, s40, 106496
  v_lshl_add_u32 v2, v101, 5, s40
  s_lshl_b32 s41, s5, 4
  v_lshl_add_u32 v70, v100, 3, v2
  v_add_u32 v70, s41, v70
  v_lshrrev_b32 v24, 2, v0
  v_xor_b32 v24, v24, v0
  v_bfe_u32 v24, v24, 2, 1
  v_add_u32 v24, -1, v24
  v_and_b32 v24, s37, v24
  v_mov_b32 v25, v24
  v_mov_b32 v26, v24
  v_mov_b32 v27, v24
  v_mov_b32 v72, 0
  v_mov_b32 v73, 0
  ds_write_b64 v17, v[72:73] offset:21504
  s_lshl_b32 s40, s3, 9
  s_add_u32 s40, s40, 139264
  v_lshl_add_u32 v106, v0, 3, s40
  s_lshr_b32 s40, s3, 1
  s_lshl_b32 s41, s40, 3
  s_lshr_b32 s41, 0x20800800, s41
  s_and_b32 s41, s41, 0xff
  s_and_b32 s42, s3, 1
  s_mul_i32 s42, s42, s41
  s_lshl_b32 s42, s42, 1
  s_cmp_eq_u32 s40, 0
  s_cselect_b32 s41, 511, s41
  s_cselect_b32 s42, 1, s42
  v_mul_u32_u24 v91, s41, v100
  v_add_u32 v91, s42, v91
  v_cvt_f32_u32 v91, v91
  s_cmp_eq_u32 s40, 2
  s_cselect_b32 s100, 1.0, 0
  s_cselect_b32 s41, 0, 1.0
  s_cmp_eq_u32 s3, 1
  s_cselect_b32 s41, 0, s41
  v_mov_b32 v107, s41
  s_waitcnt vmcnt(14)
  v_lshlrev_b32 v86, 16, v86
  v_lshlrev_b32 v76, 16, v76
  v_lshlrev_b32 v77, 16, v77
  v_mul_f32 v86, 0x3fb8aa3b, v86
  v_exp_f32 v86, v86
  v_mul_f32 v252, v76, v76
  v_fmac_f32 v252, v77, v77
  v_cvt_pk_bf16_f32 v86, v86, v86
  v_rcp_f32 v252, v252
  v_lshlrev_b32 v86, 16, v86
  v_mul_f32 v40, v86, v76
  v_mul_f32 v41, v86, v77
  v_mul_f32 v40, 0x3fb8aa3b, v40
  v_mul_f32 v41, 0x3e22f983, v41
  v_exp_f32 v253, v40
  v_fract_f32 v86, v41
  v_cos_f32 v42, v86
  v_sin_f32 v43, v86
  v_mul_f32 v252, s100, v252
  v_add_f32 v252, v252, v252
  v_fma_f32 v42, v42, v253, -1.0
  v_mul_f32 v43, v43, v253
  v_mul_f32 v40, v91, v40
  v_mul_f32 v41, v91, v41
  v_mul_f32 v254, v42, v76
  v_mul_f32 v255, v43, v76
  v_exp_f32 v40, v40
  v_fract_f32 v41, v41
  v_fmac_f32 v254, v43, v77
  v_fma_f32 v255, -v42, v77, v255
  v_cos_f32 v42, v41
  v_sin_f32 v43, v41
  v_fma_f32 v254, v254, v252, v107
  v_mul_f32 v255, v255, v252
  v_mul_f32 v42, v42, v40
  v_mul_f32 v43, v43, v40
  v_mul_f32 v76, v254, v42
  v_mul_f32 v77, v254, v43
  v_fma_f32 v76, -v255, v43, v76
  v_fmac_f32 v77, v255, v42
  s_waitcnt lgkmcnt(0)
  s_waitcnt vmcnt(7)
  s_barrier
  v_add_u32 v64, 0x1a000, v64
  v_add_u32 v65, 0x1a000, v65
  v_add_u32 v66, 0x1a000, v66
  v_add_u32 v67, 0x1a000, v67
  ds_read_b128 v[108:111], v64 offset:0
  v_add_u32 v8, 0x1e000, v8
  v_add_u32 v9, 0x1e000, v9
  v_add_u32 v10, 0x1e000, v10
  v_add_u32 v11, 0x1e000, v11
  ds_read_b128 v[28:31], v8 offset:0
  ds_read_b128 v[112:115], v65 offset:0
  ds_read_b128 v[32:35], v9 offset:0
  s_waitcnt lgkmcnt(2)
  v_mfma_f32_32x32x16_bf16 v[44:59], v[108:111], v[28:31], 0
  v_mfma_f32_16x16x32_bf16 v[20:23], v[24:27], v[28:31], 0
  ds_read_b128 v[116:119], v66 offset:0
  ds_read_b128 v[36:39], v10 offset:0
  s_bfe_u32 s41, s0, 0x4000c
  s_add_u32 m0, s39, 8192
  s_lshl_b32 s41, s41, 7
  buffer_load_dwordx4 v4, s[8:11], s41 offen lds
  s_bfe_u32 s42, s0, 0x4000c
  s_add_u32 m0, s39, 9216
  s_lshl_b32 s42, s42, 7
  buffer_load_dwordx4 v5, s[8:11], s42 offen lds
  ds_write_b64 v106, v[76:77] offset:16384
  v_lshlrev_b32 v87, 16, v87
  v_lshlrev_b32 v78, 16, v78
  s_waitcnt lgkmcnt(3)
  v_mfma_f32_32x32x16_bf16 v[44:59], v[112:115], v[32:35], v[44:59]
  ds_read_b128 v[120:123], v67 offset:0
  ds_read_b128 v[28:31], v11 offset:0
  s_waitcnt lgkmcnt(2)
  s_waitcnt vmcnt(6)
  s_barrier
  s_add_u32 m0, s36, 24576
  s_bfe_u32 s43, s0, 0x4000c
  s_lshl_b32 s43, s43, 7
  buffer_load_dwordx4 v6, s[12:15], s43 offen lds
  s_bfe_u32 s44, s0, 0x40010
  s_add_u32 m0, s39, 32768
  s_lshl_b32 s44, s44, 7
  buffer_load_dwordx4 v4, s[8:11], s44 offen lds
  v_lshlrev_b32 v79, 16, v79
  v_mul_f32 v87, 0x3fb8aa3b, v87
  v_mfma_f32_32x32x16_bf16 v[44:59], v[116:119], v[36:39], v[44:59]
  ds_read_b128 v[124:127], v64 offset:24576
  ds_read_b128 v[32:35], v8 offset:24576
  s_bfe_u32 s45, s0, 0x40010
  s_add_u32 m0, s39, 33792
  s_lshl_b32 s45, s45, 7
  buffer_load_dwordx4 v5, s[8:11], s45 offen lds
  s_add_u32 m0, s36, 49152
  s_bfe_u32 s46, s0, 0x40010
  s_lshl_b32 s46, s46, 7
  buffer_load_dwordx4 v6, s[12:15], s46 offen lds
  v_exp_f32 v87, v87
  v_mul_f32 v252, v78, v78
  v_fmac_f32 v252, v79, v79
  v_cvt_pk_bf16_f32 v87, v87, v87
  v_dot2c_f32_bf16 v72, s37, v108
  v_dot2c_f32_bf16 v73, v108, v108
  v_dot2c_f32_bf16 v72, s37, v109
  v_dot2c_f32_bf16 v73, v109, v109
  v_dot2c_f32_bf16 v72, s37, v110
  v_dot2c_f32_bf16 v73, v110, v110
  v_dot2c_f32_bf16 v72, s37, v111
  v_dot2c_f32_bf16 v73, v111, v111
  v_dot2c_f32_bf16 v72, s37, v112
  v_dot2c_f32_bf16 v73, v112, v112
  v_dot2c_f32_bf16 v72, s37, v113
  v_dot2c_f32_bf16 v73, v113, v113
  v_dot2c_f32_bf16 v72, s37, v114
  v_dot2c_f32_bf16 v73, v114, v114
  v_dot2c_f32_bf16 v72, s37, v115
  v_dot2c_f32_bf16 v73, v115, v115
  s_waitcnt lgkmcnt(2)
  v_mfma_f32_32x32x16_bf16 v[44:59], v[120:123], v[28:31], v[44:59]
  ds_read_b128 v[128:131], v65 offset:24576
  ds_read_b128 v[36:39], v9 offset:24576
  v_rcp_f32 v252, v252
  v_lshlrev_b32 v87, 16, v87
  v_mul_f32 v40, v87, v78
  v_mul_f32 v41, v87, v79
  s_waitcnt lgkmcnt(2)
  v_mfma_f32_32x32x16_bf16 v[44:59], v[124:127], v[32:35], v[44:59]
  v_mfma_f32_16x16x32_bf16 v[20:23], v[24:27], v[32:35], v[20:23]
  ds_read_b128 v[132:135], v66 offset:24576
  ds_read_b128 v[28:31], v10 offset:24576
  v_mul_f32 v40, 0x3fb8aa3b, v40
  v_mul_f32 v41, 0x3e22f983, v41
  v_exp_f32 v253, v40
  s_waitcnt lgkmcnt(2)
  v_mfma_f32_32x32x16_bf16 v[44:59], v[128:131], v[36:39], v[44:59]
  ds_read_b128 v[136:139], v67 offset:24576
  ds_read_b128 v[32:35], v11 offset:24576
  s_waitcnt vmcnt(6)
  s_barrier
  s_bfe_u32 s47, s0, 0x40014
  s_add_u32 m0, s39, 57344
  s_lshl_b32 s47, s47, 7
  buffer_load_dwordx4 v4, s[8:11], s47 offen lds
  s_bfe_u32 s40, s0, 0x40014
  s_add_u32 m0, s39, 58368
  s_lshl_b32 s40, s40, 7
  buffer_load_dwordx4 v5, s[8:11], s40 offen lds
  v_fract_f32 v87, v41
  v_cos_f32 v42, v87
  s_waitcnt lgkmcnt(2)
  v_mfma_f32_32x32x16_bf16 v[44:59], v[132:135], v[28:31], v[44:59]
  v_add_u32 v64, 0xffffa000, v64
  v_add_u32 v65, 0xffffa000, v65
  v_add_u32 v66, 0xffffa000, v66
  v_add_u32 v67, 0xffffa000, v67
  ds_read_b128 v[140:143], v64 offset:0
  v_add_u32 v8, 0xffffa000, v8
  v_add_u32 v9, 0xffffa000, v9
  v_add_u32 v10, 0xffffa000, v10
  v_add_u32 v11, 0xffffa000, v11
  ds_read_b128 v[36:39], v8 offset:0
  s_add_u32 m0, s36, 73728
  s_bfe_u32 s41, s0, 0x40014
  s_lshl_b32 s41, s41, 7
  buffer_load_dwordx4 v6, s[12:15], s41 offen lds
  v_sin_f32 v43, v87
  v_mul_f32 v252, s100, v252
  v_add_f32 v252, v252, v252
  v_dot2c_f32_bf16 v72, s37, v124
  v_dot2c_f32_bf16 v73, v124, v124
  v_dot2c_f32_bf16 v72, s37, v125
  v_dot2c_f32_bf16 v73, v125, v125
  v_dot2c_f32_bf16 v72, s37, v126
  v_dot2c_f32_bf16 v73, v126, v126
  v_dot2c_f32_bf16 v72, s37, v127
  v_dot2c_f32_bf16 v73, v127, v127
  v_dot2c_f32_bf16 v72, s37, v128
  v_dot2c_f32_bf16 v73, v128, v128
  v_dot2c_f32_bf16 v72, s37, v129
  v_dot2c_f32_bf16 v73, v129, v129
  v_dot2c_f32_bf16 v72, s37, v130
  v_dot2c_f32_bf16 v73, v130, v130
  v_dot2c_f32_bf16 v72, s37, v131
  v_dot2c_f32_bf16 v73, v131, v131
  s_waitcnt lgkmcnt(2)
  v_mfma_f32_32x32x16_bf16 v[44:59], v[136:139], v[32:35], v[44:59]
  ds_read_b128 v[144:147], v65 offset:0
  ds_read_b128 v[28:31], v9 offset:0
  v_fma_f32 v42, v42, v253, -1.0
  v_mul_f32 v43, v43, v253
  v_mul_f32 v40, v91, v40
  v_mul_f32 v41, v91, v41
  v_mul_f32 v254, v42, v78
  s_waitcnt lgkmcnt(2)
  v_mfma_f32_32x32x16_bf16 v[44:59], v[140:143], v[36:39], v[44:59]
  v_mfma_f32_16x16x32_bf16 v[20:23], v[24:27], v[36:39], v[20:23]
  ds_read_b128 v[148:151], v66 offset:0
  ds_read_b128 v[32:35], v10 offset:0
  v_mul_f32 v255, v43, v78
  v_exp_f32 v40, v40
  v_fract_f32 v41, v41
  v_fmac_f32 v254, v43, v79
  s_waitcnt lgkmcnt(2)
  v_mfma_f32_32x32x16_bf16 v[44:59], v[144:147], v[28:31], v[44:59]
  ds_read_b128 v[152:155], v67 offset:0
  ds_read_b128 v[36:39], v11 offset:0
  s_waitcnt vmcnt(6)
  s_barrier
  s_bfe_u32 s42, s0, 0x40018
  s_add_u32 m0, s39, 106496
  s_lshl_b32 s42, s42, 7
  buffer_load_dwordx4 v4, s[8:11], s42 offen lds
  s_bfe_u32 s43, s0, 0x40018
  s_add_u32 m0, s39, 107520
  s_lshl_b32 s43, s43, 7
  buffer_load_dwordx4 v5, s[8:11], s43 offen lds
  v_fma_f32 v255, -v42, v79, v255
  v_cos_f32 v42, v41
  s_waitcnt lgkmcnt(2)
  v_mfma_f32_32x32x16_bf16 v[44:59], v[148:151], v[32:35], v[44:59]
  v_add_u32 v64, 0xfffee000, v64
  v_add_u32 v65, 0xfffee000, v65
  v_add_u32 v66, 0xfffee000, v66
  v_add_u32 v67, 0xfffee000, v67
  ds_read_b128 v[156:159], v64 offset:0
  v_add_u32 v8, 0xfffee000, v8
  v_add_u32 v9, 0xfffee000, v9
  v_add_u32 v10, 0xfffee000, v10
  v_add_u32 v11, 0xfffee000, v11
  ds_read_b128 v[28:31], v8 offset:0
  s_add_u32 m0, s36, 122880
  s_bfe_u32 s44, s0, 0x40018
  s_lshl_b32 s44, s44, 7
  buffer_load_dwordx4 v6, s[12:15], s44 offen lds
  v_sin_f32 v43, v41
  v_fma_f32 v254, v254, v252, v107
  v_mul_f32 v255, v255, v252
  v_dot2c_f32_bf16 v72, s37, v140
  v_dot2c_f32_bf16 v73, v140, v140
  v_dot2c_f32_bf16 v72, s37, v141
  v_dot2c_f32_bf16 v73, v141, v141
  v_dot2c_f32_bf16 v72, s37, v142
  v_dot2c_f32_bf16 v73, v142, v142
  v_dot2c_f32_bf16 v72, s37, v143
  v_dot2c_f32_bf16 v73, v143, v143
  v_dot2c_f32_bf16 v72, s37, v144
  v_dot2c_f32_bf16 v73, v144, v144
  v_dot2c_f32_bf16 v72, s37, v145
  v_dot2c_f32_bf16 v73, v145, v145
  v_dot2c_f32_bf16 v72, s37, v146
  v_dot2c_f32_bf16 v73, v146, v146
  v_dot2c_f32_bf16 v72, s37, v147
  v_dot2c_f32_bf16 v73, v147, v147
  s_waitcnt lgkmcnt(2)
  v_mfma_f32_32x32x16_bf16 v[44:59], v[152:155], v[36:39], v[44:59]
  ds_read_b128 v[160:163], v65 offset:0
  ds_read_b128 v[32:35], v9 offset:0
  v_mul_f32 v42, v42, v40
  v_mul_f32 v43, v43, v40
  v_mul_f32 v78, v254, v42
  v_mul_f32 v79, v254, v43
  v_fma_f32 v78, -v255, v43, v78
  s_waitcnt lgkmcnt(2)
  v_mfma_f32_32x32x16_bf16 v[44:59], v[156:159], v[28:31], v[44:59]
  v_mfma_f32_16x16x32_bf16 v[20:23], v[24:27], v[28:31], v[20:23]
  ds_read_b128 v[164:167], v66 offset:0
  ds_read_b128 v[36:39], v10 offset:0
  v_mov_b32 v102, -1
  v_mov_b32 v103, -1
  buffer_store_dwordx2 v[102:103], v16, s[28:31], 0 offen sc1
  s_sub_u32 s28, s28, 4096
  s_subb_u32 s29, s29, 0
  v_fmac_f32 v79, v255, v42
  v_lshlrev_b32 v88, 16, v88
  v_lshlrev_b32 v80, 16, v80
  v_lshlrev_b32 v81, 16, v81
  v_mul_f32 v88, 0x3fb8aa3b, v88
  s_waitcnt lgkmcnt(2)
  v_mfma_f32_32x32x16_bf16 v[44:59], v[160:163], v[32:35], v[44:59]
  ds_read_b128 v[168:171], v67 offset:0
  ds_read_b128 v[28:31], v11 offset:0
  buffer_store_dwordx2 v[102:103], v16, s[28:31], 0 offen sc1
  s_sub_u32 s28, s28, 4096
  s_subb_u32 s29, s29, 0
  s_waitcnt vmcnt(8)
  s_barrier
  s_bfe_u32 s45, s0, 0x4001c
  s_add_u32 m0, s39, 131072
  s_lshl_b32 s45, s45, 7
  buffer_load_dwordx4 v4, s[8:11], s45 offen lds
  s_bfe_u32 s46, s0, 0x4001c
  s_add_u32 m0, s39, 132096
  s_lshl_b32 s46, s46, 7
  buffer_load_dwordx4 v5, s[8:11], s46 offen lds
  v_exp_f32 v88, v88
  v_mul_f32 v252, v80, v80
  s_waitcnt lgkmcnt(2)
  v_mfma_f32_32x32x16_bf16 v[44:59], v[164:167], v[36:39], v[44:59]
  ds_read_b128 v[172:175], v64 offset:24576
  ds_read_b128 v[32:35], v8 offset:24576
  buffer_store_dwordx2 v[102:103], v16, s[28:31], 0 offen sc1
  s_sub_u32 s28, s28, 4096
  s_subb_u32 s29, s29, 0
  s_add_u32 m0, s36, 147456
  s_bfe_u32 s47, s0, 0x4001c
  s_lshl_b32 s47, s47, 7
  buffer_load_dwordx4 v6, s[12:15], s47 offen lds
  v_fmac_f32 v252, v81, v81
  v_cvt_pk_bf16_f32 v88, v88, v88
  v_dot2c_f32_bf16 v72, s37, v156
  v_dot2c_f32_bf16 v73, v156, v156
  v_dot2c_f32_bf16 v72, s37, v157
  v_dot2c_f32_bf16 v73, v157, v157
  v_dot2c_f32_bf16 v72, s37, v158
  v_dot2c_f32_bf16 v73, v158, v158
  v_dot2c_f32_bf16 v72, s37, v159
  v_dot2c_f32_bf16 v73, v159, v159
  v_dot2c_f32_bf16 v72, s37, v160
  v_dot2c_f32_bf16 v73, v160, v160
  v_dot2c_f32_bf16 v72, s37, v161
  v_dot2c_f32_bf16 v73, v161, v161
  v_dot2c_f32_bf16 v72, s37, v162
  v_dot2c_f32_bf16 v73, v162, v162
  v_dot2c_f32_bf16 v72, s37, v163
  v_dot2c_f32_bf16 v73, v163, v163
  s_waitcnt lgkmcnt(2)
  v_mfma_f32_32x32x16_bf16 v[44:59], v[168:171], v[28:31], v[44:59]
  ds_read_b128 v[176:179], v65 offset:24576
  ds_read_b128 v[36:39], v9 offset:24576
  buffer_store_dwordx2 v[102:103], v16, s[28:31], 0 offen sc1
  s_sub_u32 s28, s28, 4096
  s_subb_u32 s29, s29, 0
  v_rcp_f32 v252, v252
  v_lshlrev_b32 v88, 16, v88
  v_mul_f32 v40, v88, v80
  v_mul_f32 v41, v88, v81
  v_mul_f32 v40, 0x3fb8aa3b, v40
  s_waitcnt lgkmcnt(2)
  v_mfma_f32_32x32x16_bf16 v[44:59], v[172:175], v[32:35], v[44:59]
  v_mfma_f32_16x16x32_bf16 v[20:23], v[24:27], v[32:35], v[20:23]
  ds_read_b128 v[180:183], v66 offset:24576
  ds_read_b128 v[28:31], v10 offset:24576
  buffer_store_dwordx2 v[102:103], v16, s[28:31], 0 offen sc1
  v_mul_f32 v41, 0x3e22f983, v41
  v_exp_f32 v253, v40
  v_fract_f32 v88, v41
  s_waitcnt lgkmcnt(2)
  v_mfma_f32_32x32x16_bf16 v[44:59], v[176:179], v[36:39], v[44:59]
  ds_read_b128 v[184:187], v67 offset:24576
  ds_read_b128 v[32:35], v11 offset:24576
  s_waitcnt vmcnt(11)
  s_barrier
  s_and_b32 s40, s1, 15
  s_add_u32 m0, s39, 81920
  s_lshl_b32 s40, s40, 7
  buffer_load_dwordx4 v4, s[8:11], s40 offen lds
  s_and_b32 s41, s1, 15
  s_add_u32 m0, s39, 82944
  s_lshl_b32 s41, s41, 7
  buffer_load_dwordx4 v5, s[8:11], s41 offen lds
  v_cos_f32 v42, v88
  v_sin_f32 v43, v88
  v_mul_f32 v252, s100, v252
  s_waitcnt lgkmcnt(2)
  v_mfma_f32_32x32x16_bf16 v[44:59], v[180:183], v[28:31], v[44:59]
  ds_read_b128 v[188:191], v64 offset:49152
  ds_read_b128 v[36:39], v8 offset:49152
  s_add_u32 m0, s36, 98304
  s_and_b32 s42, s1, 15
  s_lshl_b32 s42, s42, 7
  buffer_load_dwordx4 v6, s[12:15], s42 offen lds
  s_add_u32 m0, s36, 0
  s_bfe_u32 s43, s0, 0x40000
  s_lshl_b32 s43, s43, 7
  s_add_u32 s43, s43, 36864
  buffer_load_dwordx4 v6, s[12:15], s43 offen lds
  v_add_f32 v252, v252, v252
  v_fma_f32 v42, v42, v253, -1.0
  v_mul_f32 v43, v43, v253
  v_dot2c_f32_bf16 v72, s37, v172
  v_dot2c_f32_bf16 v73, v172, v172
  v_dot2c_f32_bf16 v72, s37, v173
  v_dot2c_f32_bf16 v73, v173, v173
  v_dot2c_f32_bf16 v72, s37, v174
  v_dot2c_f32_bf16 v73, v174, v174
  v_dot2c_f32_bf16 v72, s37, v175
  v_dot2c_f32_bf16 v73, v175, v175
  v_dot2c_f32_bf16 v72, s37, v176
  v_dot2c_f32_bf16 v73, v176, v176
  v_dot2c_f32_bf16 v72, s37, v177
  v_dot2c_f32_bf16 v73, v177, v177
  v_dot2c_f32_bf16 v72, s37, v178
  v_dot2c_f32_bf16 v73, v178, v178
  v_dot2c_f32_bf16 v72, s37, v179
  v_dot2c_f32_bf16 v73, v179, v179
  s_waitcnt lgkmcnt(2)
  v_mfma_f32_32x32x16_bf16 v[44:59], v[184:187], v[32:35], v[44:59]
  ds_read_b128 v[192:195], v65 offset:49152
  ds_read_b128 v[28:31], v9 offset:49152
  s_add_u32 m0, s36, 8192
  s_bfe_u32 s44, s0, 0x40004
  s_lshl_b32 s44, s44, 7
  s_add_u32 s44, s44, 36864
  buffer_load_dwordx4 v6, s[12:15], s44 offen lds
  s_add_u32 m0, s36, 16384
  s_bfe_u32 s45, s0, 0x40008
  s_lshl_b32 s45, s45, 7
  s_add_u32 s45, s45, 36864
  buffer_load_dwordx4 v6, s[12:15], s45 offen lds
  v_mul_f32 v40, v91, v40
  v_mul_f32 v41, v91, v41
  v_mul_f32 v254, v42, v80
  s_waitcnt lgkmcnt(2)
  v_mfma_f32_32x32x16_bf16 v[44:59], v[188:191], v[36:39], v[44:59]
  v_mfma_f32_16x16x32_bf16 v[20:23], v[24:27], v[36:39], v[20:23]
  ds_read_b128 v[196:199], v66 offset:49152
  ds_read_b128 v[32:35], v10 offset:49152
  s_add_u32 m0, s36, 24576
  s_bfe_u32 s46, s0, 0x4000c
  s_lshl_b32 s46, s46, 7
  s_add_u32 s46, s46, 36864
  buffer_load_dwordx4 v6, s[12:15], s46 offen lds
  v_mul_f32 v255, v43, v80
  v_exp_f32 v40, v40
  v_fract_f32 v41, v41
  s_waitcnt lgkmcnt(2)
  v_mfma_f32_32x32x16_bf16 v[44:59], v[192:195], v[28:31], v[44:59]
  ds_read_b128 v[200:203], v67 offset:49152
  ds_read_b128 v[36:39], v11 offset:49152
  s_waitcnt vmcnt(15)
  s_barrier
  s_add_u32 m0, s36, 32768
  s_bfe_u32 s47, s0, 0x40010
  s_lshl_b32 s47, s47, 7
  s_add_u32 s47, s47, 36864
  buffer_load_dwordx4 v6, s[12:15], s47 offen lds
  s_add_u32 m0, s36, 40960
  s_bfe_u32 s40, s0, 0x40014
  s_lshl_b32 s40, s40, 7
  s_add_u32 s40, s40, 36864
  buffer_load_dwordx4 v6, s[12:15], s40 offen lds
  v_fmac_f32 v254, v43, v81
  v_fma_f32 v255, -v42, v81, v255
  s_waitcnt lgkmcnt(2)
  v_mfma_f32_32x32x16_bf16 v[44:59], v[196:199], v[32:35], v[44:59]
  v_add_u32 v64, 0x18000, v64
  v_add_u32 v65, 0x18000, v65
  v_add_u32 v66, 0x18000, v66
  v_add_u32 v67, 0x18000, v67
  ds_read_b128 v[204:207], v64 offset:0
  v_add_u32 v8, 0x18000, v8
  v_add_u32 v9, 0x18000, v9
  v_add_u32 v10, 0x18000, v10
  v_add_u32 v11, 0x18000, v11
  ds_read_b128 v[28:31], v8 offset:0
  s_add_u32 m0, s36, 49152
  s_bfe_u32 s41, s0, 0x40018
  s_lshl_b32 s41, s41, 7
  s_add_u32 s41, s41, 36864
  buffer_load_dwordx4 v6, s[12:15], s41 offen lds
  v_cos_f32 v42, v41
  v_sin_f32 v43, v41
  v_fma_f32 v254, v254, v252, v107
  v_dot2c_f32_bf16 v72, s37, v188
  v_dot2c_f32_bf16 v73, v188, v188
  v_dot2c_f32_bf16 v72, s37, v189
  v_dot2c_f32_bf16 v73, v189, v189
  v_dot2c_f32_bf16 v72, s37, v190
  v_dot2c_f32_bf16 v73, v190, v190
  v_dot2c_f32_bf16 v72, s37, v191
  v_dot2c_f32_bf16 v73, v191, v191
  v_dot2c_f32_bf16 v72, s37, v192
  v_dot2c_f32_bf16 v73, v192, v192
  v_dot2c_f32_bf16 v72, s37, v193
  v_dot2c_f32_bf16 v73, v193, v193
  v_dot2c_f32_bf16 v72, s37, v194
  v_dot2c_f32_bf16 v73, v194, v194
  v_dot2c_f32_bf16 v72, s37, v195
  v_dot2c_f32_bf16 v73, v195, v195
  s_waitcnt lgkmcnt(2)
  v_mfma_f32_32x32x16_bf16 v[44:59], v[200:203], v[36:39], v[44:59]
  ds_read_b128 v[208:211], v65 offset:0
  ds_read_b128 v[32:35], v9 offset:0
  v_mul_f32 v255, v255, v252
  v_mul_f32 v42, v42, v40
  v_mul_f32 v43, v43, v40
  v_mul_f32 v80, v254, v42
  v_mul_f32 v81, v254, v43
  s_waitcnt lgkmcnt(2)
  v_mfma_f32_32x32x16_bf16 v[44:59], v[204:207], v[28:31], v[44:59]
  v_mfma_f32_16x16x32_bf16 v[20:23], v[24:27], v[28:31], v[20:23]
  ds_read_b128 v[212:215], v66 offset:0
  ds_read_b128 v[36:39], v10 offset:0
  v_fma_f32 v80, -v255, v43, v80
  v_fmac_f32 v81, v255, v42
  v_lshlrev_b32 v89, 16, v89
  v_lshlrev_b32 v82, 16, v82
  s_waitcnt lgkmcnt(2)
  v_mfma_f32_32x32x16_bf16 v[44:59], v[208:211], v[32:35], v[44:59]
  ds_read_b128 v[216:219], v67 offset:0
  ds_read_b128 v[28:31], v11 offset:0
  s_waitcnt vmcnt(12)
  s_barrier
  s_add_u32 m0, s36, 57344
  s_bfe_u32 s42, s0, 0x4001c
  s_lshl_b32 s42, s42, 7
  s_add_u32 s42, s42, 36864
  buffer_load_dwordx4 v6, s[12:15], s42 offen lds
  s_add_u32 m0, s36, 65536
  s_and_b32 s43, s1, 15
  s_lshl_b32 s43, s43, 7
  s_add_u32 s43, s43, 36864
  buffer_load_dwordx4 v6, s[12:15], s43 offen lds
  v_lshlrev_b32 v83, 16, v83
  v_mul_f32 v89, 0x3fb8aa3b, v89
  v_exp_f32 v89, v89
  s_waitcnt lgkmcnt(2)
  v_mfma_f32_32x32x16_bf16 v[44:59], v[212:215], v[36:39], v[44:59]
  ds_read_b128 v[220:223], v64 offset:24576
  ds_read_b128 v[32:35], v8 offset:24576
  s_add_u32 m0, s36, 73728
  s_bfe_u32 s44, s0, 0x40000
  s_lshl_b32 s44, s44, 7
  s_add_u32 s44, s44, 73728
  buffer_load_dwordx4 v6, s[12:15], s44 offen lds
  v_mul_f32 v252, v82, v82
  v_fmac_f32 v252, v83, v83
  v_cvt_pk_bf16_f32 v89, v89, v89
  v_dot2c_f32_bf16 v72, s37, v204
  v_dot2c_f32_bf16 v73, v204, v204
  v_dot2c_f32_bf16 v72, s37, v205
  v_dot2c_f32_bf16 v73, v205, v205
  v_dot2c_f32_bf16 v72, s37, v206
  v_dot2c_f32_bf16 v73, v206, v206
  v_dot2c_f32_bf16 v72, s37, v207
  v_dot2c_f32_bf16 v73, v207, v207
  v_dot2c_f32_bf16 v72, s37, v208
  v_dot2c_f32_bf16 v73, v208, v208
  v_dot2c_f32_bf16 v72, s37, v209
  v_dot2c_f32_bf16 v73, v209, v209
  v_dot2c_f32_bf16 v72, s37, v210
  v_dot2c_f32_bf16 v73, v210, v210
  v_dot2c_f32_bf16 v72, s37, v211
  v_dot2c_f32_bf16 v73, v211, v211
  s_waitcnt lgkmcnt(2)
  v_mfma_f32_32x32x16_bf16 v[44:59], v[216:219], v[28:31], v[44:59]
  ds_read_b128 v[224:227], v65 offset:24576
  ds_read_b128 v[36:39], v9 offset:24576
  v_rcp_f32 v252, v252
  v_lshlrev_b32 v89, 16, v89
  v_mul_f32 v40, v89, v82
  v_mul_f32 v41, v89, v83
  s_waitcnt lgkmcnt(2)
  v_mfma_f32_32x32x16_bf16 v[44:59], v[220:223], v[32:35], v[44:59]
  v_mfma_f32_16x16x32_bf16 v[20:23], v[24:27], v[32:35], v[20:23]
  ds_read_b128 v[228:231], v66 offset:24576
  ds_read_b128 v[28:31], v10 offset:24576
  v_mul_f32 v40, 0x3fb8aa3b, v40
  v_mul_f32 v41, 0x3e22f983, v41
  v_exp_f32 v253, v40
  v_fract_f32 v89, v41
  s_waitcnt lgkmcnt(2)
  v_mfma_f32_32x32x16_bf16 v[44:59], v[224:227], v[36:39], v[44:59]
  ds_read_b128 v[232:235], v67 offset:24576
  ds_read_b128 v[32:35], v11 offset:24576
  s_waitcnt vmcnt(10)
  s_barrier
  s_mov_b64 exec, 1
  buffer_atomic_or v63, v62, s[96:99], 0 offen sc1
  s_mov_b64 exec, -1
  v_cos_f32 v42, v89
  v_sin_f32 v43, v89
  v_mul_f32 v252, s100, v252
  s_waitcnt lgkmcnt(2)
  v_mfma_f32_32x32x16_bf16 v[44:59], v[228:231], v[28:31], v[44:59]
  v_add_u32 v64, 0xffffa000, v64
  v_add_u32 v65, 0xffffa000, v65
  v_add_u32 v66, 0xffffa000, v66
  v_add_u32 v67, 0xffffa000, v67
  ds_read_b128 v[236:239], v64 offset:0
  v_add_u32 v8, 0xffffa000, v8
  v_add_u32 v9, 0xffffa000, v9
  v_add_u32 v10, 0xffffa000, v10
  v_add_u32 v11, 0xffffa000, v11
  ds_read_b128 v[36:39], v8 offset:0
  v_add_f32 v252, v252, v252
  v_fma_f32 v42, v42, v253, -1.0
  v_mul_f32 v43, v43, v253
  v_mul_f32 v40, v91, v40
  v_mul_f32 v41, v91, v41
  v_dot2c_f32_bf16 v72, s37, v220
  v_dot2c_f32_bf16 v73, v220, v220
  v_dot2c_f32_bf16 v72, s37, v221
  v_dot2c_f32_bf16 v73, v221, v221
  v_dot2c_f32_bf16 v72, s37, v222
  v_dot2c_f32_bf16 v73, v222, v222
  v_dot2c_f32_bf16 v72, s37, v223
  v_dot2c_f32_bf16 v73, v223, v223
  v_dot2c_f32_bf16 v72, s37, v224
  v_dot2c_f32_bf16 v73, v224, v224
  v_dot2c_f32_bf16 v72, s37, v225
  v_dot2c_f32_bf16 v73, v225, v225
  v_dot2c_f32_bf16 v72, s37, v226
  v_dot2c_f32_bf16 v73, v226, v226
  v_dot2c_f32_bf16 v72, s37, v227
  v_dot2c_f32_bf16 v73, v227, v227
  s_waitcnt lgkmcnt(2)
  v_mfma_f32_32x32x16_bf16 v[44:59], v[232:235], v[32:35], v[44:59]
  ds_read_b128 v[240:243], v65 offset:0
  ds_read_b128 v[28:31], v9 offset:0
  v_mul_f32 v254, v42, v82
  v_mul_f32 v255, v43, v82
  v_exp_f32 v40, v40
  v_fract_f32 v41, v41
  s_waitcnt lgkmcnt(2)
  v_mfma_f32_32x32x16_bf16 v[44:59], v[236:239], v[36:39], v[44:59]
  v_mfma_f32_16x16x32_bf16 v[20:23], v[24:27], v[36:39], v[20:23]
  ds_read_b128 v[244:247], v66 offset:0
  ds_read_b128 v[32:35], v10 offset:0
  v_fmac_f32 v254, v43, v83
  v_fma_f32 v255, -v42, v83, v255
  v_cos_f32 v42, v41
  s_waitcnt lgkmcnt(2)
  v_mfma_f32_32x32x16_bf16 v[44:59], v[240:243], v[28:31], v[44:59]
  ds_read_b128 v[248:251], v67 offset:0
  ds_read_b128 v[36:39], v11 offset:0
  v_dot2c_f32_bf16 v72, s37, v236
  v_dot2c_f32_bf16 v73, v236, v236
  v_dot2c_f32_bf16 v72, s37, v237
  v_dot2c_f32_bf16 v73, v237, v237
  v_dot2c_f32_bf16 v72, s37, v238
  v_dot2c_f32_bf16 v73, v238, v238
  v_dot2c_f32_bf16 v72, s37, v239
  v_dot2c_f32_bf16 v73, v239, v239
  v_dot2c_f32_bf16 v72, s37, v240
  v_dot2c_f32_bf16 v73, v240, v240
  v_dot2c_f32_bf16 v72, s37, v241
  v_dot2c_f32_bf16 v73, v241, v241
  v_dot2c_f32_bf16 v72, s37, v242
  v_dot2c_f32_bf16 v73, v242, v242
  v_dot2c_f32_bf16 v72, s37, v243
  v_dot2c_f32_bf16 v73, v243, v243
  ds_write_b32 v13, v20
  s_nop 1
  ds_write_b64 v70, v[72:73]
  s_waitcnt lgkmcnt(0)
  s_waitcnt vmcnt(10)
  s_barrier
  s_lshl_b32 s41, s6, 3
  s_add_u32 s41, s41, 128
  s_lshl_b32 s40, 1, s7
  v_mov_b32 v62, s40
  s_cmp_eq_u32 s3, 0
  s_cselect_b32 s40, s41, 0x1000
  s_mov_b64 exec, 1
  buffer_atomic_or v62, off, s[96:99], s40 sc1
  s_mov_b64 exec, -1
  ds_read_b64 v[100:101], v7
  ds_read_b128 v[92:95], v2
  ds_read_b128 v[96:99], v2 offset:16
  v_mfma_f32_32x32x16_bf16 v[44:59], v[244:247], v[32:35], v[44:59]
  v_add_u32 v8, 0xfffe8000, v8
  v_add_u32 v9, 0xfffe8000, v9
  v_add_u32 v10, 0xfffe8000, v10
  v_add_u32 v11, 0xfffe8000, v11
  ds_read_b128 v[28:31], v8 offset:0
  s_waitcnt lgkmcnt(2)
  v_add_f32 v92, v92, v94
  v_add_f32 v93, v93, v95
  s_waitcnt lgkmcnt(1)
  v_add_f32 v96, v96, v98
  v_add_f32 v97, v97, v99
  v_add_f32 v92, v92, v96
  v_add_f32 v93, v93, v97
  v_mul_f32 v92, 0x3ae38e39, v92
  v_mul_f32 v93, 0x3ae38e39, v93
  v_mfma_f32_32x32x16_bf16 v[44:59], v[248:251], v[36:39], v[44:59]
  ds_read_b128 v[32:35], v9 offset:0
  v_cvt_pk_bf16_f32 v104, -v92, -v92
  v_fma_f32 v93, -v92, v92, v93
  v_max_f32 v93, 0, v93
  v_cvt_pk_bf16_f32 v94, v93, v93
  v_lshlrev_b32 v94, 16, v94
  v_add_f32 v94, 0x3727c5ac, v94
  v_cvt_pk_bf16_f32 v94, v94, v94
  v_lshlrev_b32 v94, 16, v94
  s_waitcnt lgkmcnt(1)
  v_mfma_f32_32x32x16_bf16 v[60:75], v[108:111], v[28:31], 0
  v_mfma_f32_16x16x32_bf16 v[20:23], v[24:27], v[28:31], 0
  ds_read_b128 v[36:39], v10 offset:0
  v_sqrt_f32 v94, v94
  s_nop 0
  v_cvt_pk_bf16_f32 v105, v94, 0
  v_lshlrev_b32 v94, 16, v105
  v_rcp_f32 v96, v94
  v_mov_b32 v12, v104
  s_waitcnt lgkmcnt(1)
  v_mfma_f32_32x32x16_bf16 v[60:75], v[112:115], v[32:35], v[60:75]
  ds_read_b128 v[28:31], v11 offset:0
  s_waitcnt vmcnt(9)
  s_barrier
  ds_write_b32 v1, v96
  ds_read_b128 v[92:95], v14
  ds_read_b128 v[96:99], v14 offset:16
  s_waitcnt lgkmcnt(4)
  v_mfma_f32_32x32x16_bf16 v[60:75], v[116:119], v[36:39], v[60:75]
  ds_read_b128 v[32:35], v8 offset:8192
  s_add_u32 m0, s36, 81920
  s_bfe_u32 s45, s0, 0x40004
  s_lshl_b32 s45, s45, 7
  s_add_u32 s45, s45, 73728
  buffer_load_dwordx4 v6, s[12:15], s45 offen lds
  s_add_u32 m0, s36, 90112
  s_bfe_u32 s46, s0, 0x40008
  s_lshl_b32 s46, s46, 7
  s_add_u32 s46, s46, 73728
  buffer_load_dwordx4 v6, s[12:15], s46 offen lds
  v_add_f32 v100, v100, v101
  v_cvt_pk_bf16_f32 v101, v100, v100
  v_lshlrev_b32 v101, 16, v101
  v_sub_f32 v102, v100, v101
  v_cvt_pk_bf16_f32 v100, v101, v102
  s_waitcnt lgkmcnt(4)
  v_mfma_f32_32x32x16_bf16 v[60:75], v[120:123], v[28:31], v[60:75]
  ds_read_b128 v[36:39], v9 offset:8192
  s_add_u32 m0, s36, 98304
  s_bfe_u32 s47, s0, 0x4000c
  s_lshl_b32 s47, s47, 7
  s_add_u32 s47, s47, 73728
  buffer_load_dwordx4 v6, s[12:15], s47 offen lds
  v_mov_b32 v101, 0
  s_nop 1
  v_mfma_f32_32x32x8_bf16 v[44:59], v[12:13], v[100:101], v[44:59]
  ds_read_b64 v[102:103], v15 offset:16384
  v_sin_f32 v43, v41
  s_waitcnt lgkmcnt(2)
  v_mfma_f32_32x32x16_bf16 v[60:75], v[124:127], v[32:35], v[60:75]
  v_mfma_f32_16x16x32_bf16 v[20:23], v[24:27], v[32:35], v[20:23]
  ds_read_b128 v[28:31], v10 offset:8192
  s_and_b32 s40, s6, 7
  s_mul_i32 s40, s40, 73728
  buffer_load_dword v3, v6, s[16:19], s40 offen
  v_fma_f32 v254, v254, v252, v107
  s_nop 1
  v_permlane16_swap_b32 v44, v52
  v_permlane16_swap_b32 v45, v53
  v_permlane16_swap_b32 v46, v54
  v_permlane16_swap_b32 v47, v55
  v_permlane16_swap_b32 v48, v56
  v_permlane16_swap_b32 v49, v57
  s_waitcnt lgkmcnt(2)
  v_mfma_f32_32x32x16_bf16 v[60:75], v[128:131], v[36:39], v[60:75]
  ds_read_b128 v[32:35], v11 offset:8192
  v_mul_f32 v255, v255, v252
  v_permlane16_swap_b32 v50, v58
  v_permlane16_swap_b32 v51, v59
  v_mul_f32 v44, v92, v44
  v_mul_f32 v52, v92, v52
  v_mul_f32 v45, v93, v45
  v_mul_f32 v53, v93, v53
  v_mul_f32 v46, v94, v46
  s_waitcnt lgkmcnt(1)
  v_mfma_f32_32x32x16_bf16 v[60:75], v[132:135], v[28:31], v[60:75]
  ds_read_b128 v[36:39], v8 offset:16384
  v_mul_f32 v42, v42, v40
  v_mul_f32 v54, v94, v54
  v_mul_f32 v47, v95, v47
  v_mul_f32 v55, v95, v55
  v_mul_f32 v48, v96, v48
  v_mul_f32 v56, v96, v56
  v_mul_f32 v49, v97, v49
  s_waitcnt lgkmcnt(1)
  v_mfma_f32_32x32x16_bf16 v[60:75], v[136:139], v[32:35], v[60:75]
  ds_read_b128 v[28:31], v9 offset:16384
  v_mul_f32 v43, v43, v40
  v_mul_f32 v57, v97, v57
  v_mul_f32 v50, v98, v50
  v_mul_f32 v58, v98, v58
  v_mul_f32 v51, v99, v51
  v_mul_f32 v59, v99, v59
  ds_read_b64 v[96:97], v15 offset:17664
  ds_read_b64 v[98:99], v15 offset:17920
  s_waitcnt lgkmcnt(3)
  v_mfma_f32_32x32x16_bf16 v[60:75], v[140:143], v[36:39], v[60:75]
  v_mfma_f32_16x16x32_bf16 v[20:23], v[24:27], v[36:39], v[20:23]
  ds_read_b128 v[32:35], v10 offset:16384
  v_mul_f32 v82, v254, v42
  ds_read_b64 v[100:101], v16 offset:16896
  v_fma_f32 v94, v102, v44, v45
  v_fma_f32 v95, v102, v52, v53
  v_fma_f32 v94, -v103, v52, v94
  v_fmac_f32 v95, v103, v44
  v_fma_f32 v92, v102, v94, v46
  s_waitcnt lgkmcnt(4)
  v_mfma_f32_32x32x16_bf16 v[60:75], v[144:147], v[28:31], v[60:75]
  ds_read_b128 v[36:39], v11 offset:16384
  s_waitcnt vmcnt(11)
  s_barrier
  v_mul_f32 v83, v254, v43
  v_fma_f32 v93, v102, v95, v54
  v_fma_f32 v92, -v103, v95, v92
  s_waitcnt lgkmcnt(2)
  v_mfma_f32_32x32x16_bf16 v[60:75], v[148:151], v[32:35], v[60:75]
  ds_read_b128 v[28:31], v8 offset:24576
  s_and_b32 s42, s6, 7
  s_mul_i32 s42, s42, 73728
  buffer_load_dword v3, v6, s[20:23], s42 offen
  v_fma_f32 v82, -v255, v43, v82
  v_fmac_f32 v93, v103, v94
  v_fma_f32 v94, v102, v92, v47
  v_fma_f32 v95, v102, v93, v55
  v_fma_f32 v94, -v103, v93, v94
  v_fmac_f32 v95, v103, v92
  v_fma_f32 v92, v102, v94, v48
  v_fma_f32 v93, v102, v95, v56
  s_waitcnt lgkmcnt(1)
  v_mfma_f32_32x32x16_bf16 v[60:75], v[152:155], v[36:39], v[60:75]
  ds_read_b128 v[32:35], v9 offset:24576
  v_fmac_f32 v83, v255, v42
  v_fma_f32 v92, -v103, v95, v92
  v_fmac_f32 v93, v103, v94
  v_fma_f32 v94, v102, v92, v49
  v_fma_f32 v95, v102, v93, v57
  v_fma_f32 v94, -v103, v93, v94
  v_fmac_f32 v95, v103, v92
  s_waitcnt lgkmcnt(1)
  v_mfma_f32_32x32x16_bf16 v[60:75], v[156:159], v[28:31], v[60:75]
  v_mfma_f32_16x16x32_bf16 v[20:23], v[24:27], v[28:31], v[20:23]
  ds_read_b128 v[36:39], v10 offset:24576
  v_lshlrev_b32 v90, 16, v90
  v_fma_f32 v92, v102, v94, v50
  v_fma_f32 v93, v102, v95, v58
  v_fma_f32 v92, -v103, v95, v92
  v_fmac_f32 v93, v103, v94
  v_fma_f32 v94, v102, v92, v51
  v_fma_f32 v95, v102, v93, v59
  v_fma_f32 v94, -v103, v93, v94
  s_waitcnt lgkmcnt(1)
  v_mfma_f32_32x32x16_bf16 v[60:75], v[160:163], v[32:35], v[60:75]
  ds_read_b128 v[28:31], v11 offset:24576
  v_lshlrev_b32 v84, 16, v84
  v_fmac_f32 v95, v103, v92
  v_mov_b32 v92, v94
  v_mov_b32 v93, v95
  s_nop 0
  v_permlane32_swap_b32 v94, v92
  v_permlane32_swap_b32 v95, v93
  v_fmac_f32 v92, v96, v94
  s_waitcnt lgkmcnt(1)
  v_mfma_f32_32x32x16_bf16 v[60:75], v[164:167], v[36:39], v[60:75]
  ds_read_b128 v[32:35], v8 offset:32768
  v_lshlrev_b32 v85, 16, v85
  v_fmac_f32 v93, v96, v95
  v_fma_f32 v92, -v97, v95, v92
  v_fmac_f32 v93, v97, v94
  v_cndmask_b32 v104, 0, v94, s[90:91]
  v_cndmask_b32 v105, 0, v95, s[90:91]
  v_mov_b32 v94, v92
  v_mov_b32 v95, v93
  s_waitcnt lgkmcnt(1)
  v_mfma_f32_32x32x16_bf16 v[60:75], v[168:171], v[28:31], v[60:75]
  ds_read_b128 v[36:39], v9 offset:32768
  v_mul_f32 v90, 0x3fb8aa3b, v90
  v_permlane16_swap_b32 v92, v94
  v_permlane16_swap_b32 v93, v95
  v_fmac_f32 v94, v98, v92
  v_fmac_f32 v95, v98, v93
  v_fma_f32 v94, -v99, v93, v94
  v_fmac_f32 v95, v99, v92
  s_waitcnt lgkmcnt(1)
  v_mfma_f32_32x32x16_bf16 v[60:75], v[172:175], v[32:35], v[60:75]
  v_mfma_f32_16x16x32_bf16 v[20:23], v[24:27], v[32:35], v[20:23]
  ds_read_b128 v[28:31], v10 offset:32768
  s_and_b32 s44, s6, 7
  s_mul_i32 s44, s44, 73728
  s_add_u32 s44, s44, 128
  buffer_load_dword v3, v6, s[16:19], s44 offen
  s_mov_b64 exec, 0xffff
  ds_write_b64 v17, v[94:95] offset:22272
  s_mov_b64 exec, -1
  v_fmac_f32 v104, v100, v92
  v_fmac_f32 v105, v100, v93
  v_fma_f32 v104, -v101, v93, v104
  v_fmac_f32 v105, v101, v92
  ds_read_b64 v[102:103], v15 offset:19712
  ds_read_b64 v[92:93], v16 offset:17408
  s_waitcnt lgkmcnt(4)
  v_mfma_f32_32x32x16_bf16 v[60:75], v[176:179], v[36:39], v[60:75]
  ds_read_b128 v[32:35], v11 offset:32768
  s_waitcnt lgkmcnt(3)
  s_waitcnt vmcnt(11)
  s_barrier
  ds_read_b64 v[96:97], v17 offset:21504
  ds_read_b64 v[98:99], v17 offset:21760
  ds_read_b64 v[100:101], v17 offset:22016
  v_mfma_f32_32x32x16_bf16 v[60:75], v[180:183], v[28:31], v[60:75]
  ds_read_b128 v[36:39], v8 offset:40960
  s_waitcnt lgkmcnt(2)
  v_fmac_f32 v98, v102, v96
  v_fmac_f32 v99, v102, v97
  v_fma_f32 v98, -v103, v97, v98
  v_fmac_f32 v99, v103, v96
  s_waitcnt lgkmcnt(1)
  v_fmac_f32 v100, v102, v98
  v_fmac_f32 v101, v102, v99
  v_fma_f32 v100, -v103, v99, v100
  v_fmac_f32 v101, v103, v98
  v_mfma_f32_32x32x16_bf16 v[60:75], v[184:187], v[32:35], v[60:75]
  ds_read_b128 v[28:31], v9 offset:40960
  v_fmac_f32 v94, v102, v100
  v_fmac_f32 v95, v102, v101
  v_fma_f32 v94, -v103, v101, v94
  v_fmac_f32 v95, v103, v100
  v_min_u32 v94, -2, v94
  buffer_store_dwordx2 v[94:95], v16, s[28:31], 0 offen sc1
  s_add_u32 s28, s28, 4096
  s_addc_u32 s29, s29, 0
  v_fmac_f32 v104, v92, v100
  s_waitcnt lgkmcnt(1)
  v_mfma_f32_32x32x16_bf16 v[60:75], v[188:191], v[36:39], v[60:75]
  v_mfma_f32_16x16x32_bf16 v[20:23], v[24:27], v[36:39], v[20:23]
  ds_read_b128 v[32:35], v10 offset:40960
  v_fmac_f32 v105, v92, v101
  v_fma_f32 v104, -v93, v101, v104
  v_fmac_f32 v105, v93, v100
  v_exp_f32 v90, v90
  v_mul_f32 v252, v84, v84
  v_fmac_f32 v252, v85, v85
  s_waitcnt lgkmcnt(1)
  v_mfma_f32_32x32x16_bf16 v[60:75], v[192:195], v[28:31], v[60:75]
  ds_read_b128 v[36:39], v11 offset:40960
  v_cvt_pk_bf16_f32 v90, v90, v90
  v_rcp_f32 v252, v252
  v_lshlrev_b32 v90, 16, v90
  v_mul_f32 v40, v90, v84
  v_mul_f32 v41, v90, v85
  v_mul_f32 v40, 0x3fb8aa3b, v40
  v_mul_f32 v41, 0x3e22f983, v41
  s_waitcnt lgkmcnt(1)
  v_mfma_f32_32x32x16_bf16 v[60:75], v[196:199], v[32:35], v[60:75]
  ds_read_b128 v[28:31], v8 offset:49152
  s_and_b32 s46, s6, 7
  s_mul_i32 s46, s46, 73728
  s_add_u32 s46, s46, 128
  buffer_load_dword v3, v6, s[20:23], s46 offen
  v_exp_f32 v253, v40
  v_fract_f32 v90, v41
  v_cos_f32 v42, v90
  v_sin_f32 v43, v90
  s_waitcnt lgkmcnt(1)
  v_mfma_f32_32x32x16_bf16 v[60:75], v[200:203], v[36:39], v[60:75]
  ds_read_b128 v[32:35], v9 offset:49152
  v_mul_f32 v252, s100, v252
  v_add_f32 v252, v252, v252
  v_fma_f32 v42, v42, v253, -1.0
  v_mul_f32 v43, v43, v253
  v_mul_f32 v40, v91, v40
  v_mul_f32 v41, v91, v41
  v_mul_f32 v254, v42, v84
  v_mul_f32 v255, v43, v84
  s_waitcnt lgkmcnt(1)
  v_mfma_f32_32x32x16_bf16 v[60:75], v[204:207], v[28:31], v[60:75]
  v_mfma_f32_16x16x32_bf16 v[20:23], v[24:27], v[28:31], v[20:23]
  ds_read_b128 v[36:39], v10 offset:49152
  v_exp_f32 v40, v40
  v_fract_f32 v41, v41
  v_fmac_f32 v254, v43, v85
  v_fma_f32 v255, -v42, v85, v255
  v_cos_f32 v42, v41
  s_waitcnt lgkmcnt(1)
  v_mfma_f32_32x32x16_bf16 v[60:75], v[208:211], v[32:35], v[60:75]
  ds_read_b128 v[28:31], v11 offset:49152
  s_waitcnt vmcnt(11)
  s_barrier
  v_sin_f32 v43, v41
  v_fma_f32 v254, v254, v252, v107
  s_waitcnt lgkmcnt(1)
  v_mfma_f32_32x32x16_bf16 v[60:75], v[212:215], v[36:39], v[60:75]
  ds_read_b128 v[32:35], v8 offset:57344
  v_mul_f32 v255, v255, v252
  v_mul_f32 v42, v42, v40
  v_mul_f32 v43, v43, v40
  v_mul_f32 v84, v254, v42
  v_mul_f32 v85, v254, v43
  v_fma_f32 v84, -v255, v43, v84
  v_fmac_f32 v85, v255, v42
  ds_write_b64 v106, v[78:79] offset:12288
  s_waitcnt lgkmcnt(2)
  v_mfma_f32_32x32x16_bf16 v[60:75], v[216:219], v[28:31], v[60:75]
  ds_read_b128 v[36:39], v9 offset:57344
  ds_write_b64 v106, v[80:81] offset:8192
  ds_write_b64 v106, v[82:83] offset:4096
  ds_write_b64 v106, v[84:85] offset:0
  ds_read_b64 v[0:1], v15 offset:18432
  ds_read_b64 v[40:41], v16 offset:18432
  ds_read_b64 v[42:43], v17 offset:19456
  s_waitcnt lgkmcnt(8)
  v_mfma_f32_32x32x16_bf16 v[60:75], v[220:223], v[32:35], v[60:75]
  v_mfma_f32_16x16x32_bf16 v[20:23], v[24:27], v[32:35], v[20:23]
  ds_read_b128 v[28:31], v10 offset:57344
  s_add_u32 m0, s36, 0
  s_bfe_u32 s40, s0, 0x40010
  s_lshl_b32 s40, s40, 7
  s_add_u32 s40, s40, 73728
  buffer_load_dwordx4 v6, s[12:15], s40 offen lds
  s_add_u32 m0, s36, 8192
  s_bfe_u32 s41, s0, 0x40014
  s_lshl_b32 s41, s41, 7
  s_add_u32 s41, s41, 73728
  buffer_load_dwordx4 v6, s[12:15], s41 offen lds
  s_waitcnt lgkmcnt(1)
  v_mul_f32 v4, v40, v42
  v_mul_f32 v5, v40, v43
  v_fma_f32 v4, -v41, v43, v4
  v_fmac_f32 v5, v41, v42
  buffer_load_dword v40, off, s[96:99], s101 sc1
  v_mul_f32 v2, v1, v44
  v_mfma_f32_32x32x16_bf16 v[60:75], v[224:227], v[36:39], v[60:75]
  ds_read_b128 v[32:35], v11 offset:57344
  v_mul_f32 v44, v0, v44
  v_fma_f32 v44, -v1, v52, v44
  v_fma_f32 v52, v0, v52, v2
  v_mul_f32 v2, v1, v45
  v_mul_f32 v45, v0, v45
  v_fma_f32 v45, -v1, v53, v45
  v_fma_f32 v53, v0, v53, v2
  v_mul_f32 v2, v1, v46
  s_waitcnt lgkmcnt(1)
  v_mfma_f32_32x32x16_bf16 v[60:75], v[228:231], v[28:31], v[60:75]
  v_add_u32 v8, 0x10000, v8
  v_add_u32 v9, 0x10000, v9
  v_add_u32 v10, 0x10000, v10
  v_add_u32 v11, 0x10000, v11
  ds_read_b128 v[36:39], v8 offset:0
  v_mul_f32 v46, v0, v46
  v_fma_f32 v46, -v1, v54, v46
  v_fma_f32 v54, v0, v54, v2
  v_mul_f32 v2, v1, v47
  v_mul_f32 v47, v0, v47
  v_fma_f32 v47, -v1, v55, v47
  v_fma_f32 v55, v0, v55, v2
  s_waitcnt lgkmcnt(1)
  v_mfma_f32_32x32x16_bf16 v[60:75], v[232:235], v[32:35], v[60:75]
  ds_read_b128 v[28:31], v9 offset:0
  v_mul_f32 v2, v1, v48
  v_mul_f32 v48, v0, v48
  v_fma_f32 v48, -v1, v56, v48
  v_fma_f32 v56, v0, v56, v2
  v_mul_f32 v2, v1, v49
  v_mul_f32 v49, v0, v49
  v_fma_f32 v49, -v1, v57, v49
  v_fma_f32 v57, v0, v57, v2
  s_waitcnt lgkmcnt(1)
  v_mfma_f32_32x32x16_bf16 v[60:75], v[236:239], v[36:39], v[60:75]
  v_mfma_f32_16x16x32_bf16 v[20:23], v[24:27], v[36:39], v[20:23]
  ds_read_b128 v[32:35], v10 offset:0
  v_mul_f32 v2, v1, v50
  v_mul_f32 v50, v0, v50
  v_fma_f32 v50, -v1, v58, v50
  v_fma_f32 v58, v0, v58, v2
  v_mul_f32 v2, v1, v51
  v_mul_f32 v51, v0, v51
  v_fma_f32 v51, -v1, v59, v51
  s_waitcnt lgkmcnt(1)
  v_mfma_f32_32x32x16_bf16 v[60:75], v[240:243], v[28:31], v[60:75]
  ds_read_b128 v[36:39], v11 offset:0
  ds_write_b32 v13, v20
  s_waitcnt lgkmcnt(0)
  s_waitcnt vmcnt(9)
  s_barrier
  v_fma_f32 v59, v0, v59, v2
  ds_read_b64 v[100:101], v7
  ds_read_b128 v[92:95], v14
  v_mfma_f32_32x32x16_bf16 v[60:75], v[244:247], v[32:35], v[60:75]
  ds_read_b128 v[28:31], v8 offset:8192
  s_add_u32 m0, s36, 16384
  s_bfe_u32 s42, s0, 0x40018
  s_lshl_b32 s42, s42, 7
  s_add_u32 s42, s42, 73728
  buffer_load_dwordx4 v6, s[12:15], s42 offen lds
  s_add_u32 m0, s36, 24576
  s_bfe_u32 s43, s0, 0x4001c
  s_lshl_b32 s43, s43, 7
  s_add_u32 s43, s43, 73728
  buffer_load_dwordx4 v6, s[12:15], s43 offen lds
  v_mul_f32 v2, v1, v104
  ds_read_b128 v[96:99], v14 offset:16
  v_mul_f32 v104, v0, v104
  v_fma_f32 v104, -v1, v105, v104
  v_fma_f32 v105, v0, v105, v2
  ds_read_b64 v[0:1], v15 offset:16640
  v_mfma_f32_32x32x16_bf16 v[60:75], v[248:251], v[36:39], v[60:75]
  ds_read_b128 v[32:35], v9 offset:8192
  s_add_u32 m0, s36, 32768
  s_and_b32 s44, s1, 15
  s_lshl_b32 s44, s44, 7
  s_add_u32 s44, s44, 73728
  buffer_load_dwordx4 v6, s[12:15], s44 offen lds
  s_add_u32 m0, s36, 40960
  s_bfe_u32 s45, s0, 0x40000
  s_lshl_b32 s45, s45, 7
  s_add_u32 s45, s45, 110592
  buffer_load_dwordx4 v6, s[12:15], s45 offen lds
  s_waitcnt lgkmcnt(5)
  v_add_f32 v100, v100, v101
  v_cvt_pk_bf16_f32 v101, v100, v100
  v_lshlrev_b32 v101, 16, v101
  v_sub_f32 v102, v100, v101
  v_cvt_pk_bf16_f32 v100, v101, v102
  s_waitcnt lgkmcnt(3)
  v_mfma_f32_32x32x16_bf16 v[76:91], v[108:111], v[28:31], 0
  v_mfma_f32_16x16x32_bf16 v[20:23], v[24:27], v[28:31], 0
  ds_read_b128 v[36:39], v10 offset:8192
  s_add_u32 m0, s36, 49152
  s_bfe_u32 s46, s0, 0x40004
  s_lshl_b32 s46, s46, 7
  s_add_u32 s46, s46, 110592
  buffer_load_dwordx4 v6, s[12:15], s46 offen lds
  v_mov_b32 v101, 0
  s_nop 1
  v_mfma_f32_32x32x8_bf16 v[60:75], v[12:13], v[100:101], v[60:75]
  ds_read_b64 v[102:103], v15 offset:12288
  s_waitcnt lgkmcnt(2)
  v_mfma_f32_32x32x16_bf16 v[76:91], v[112:115], v[32:35], v[76:91]
  ds_read_b128 v[28:31], v11 offset:8192
  s_add_u32 m0, s36, 57344
  s_bfe_u32 s47, s0, 0x40008
  s_lshl_b32 s47, s47, 7
  s_add_u32 s47, s47, 110592
  buffer_load_dwordx4 v6, s[12:15], s47 offen lds
  s_nop 2
  v_permlane16_swap_b32 v60, v68
  v_permlane16_swap_b32 v61, v69
  v_permlane16_swap_b32 v62, v70
  v_permlane16_swap_b32 v63, v71
  v_permlane16_swap_b32 v64, v72
  v_permlane16_swap_b32 v65, v73
  s_waitcnt lgkmcnt(2)
  v_mfma_f32_32x32x16_bf16 v[76:91], v[116:119], v[36:39], v[76:91]
  ds_read_b128 v[32:35], v8 offset:16384
  v_permlane16_swap_b32 v66, v74
  v_permlane16_swap_b32 v67, v75
  v_mul_f32 v60, v92, v60
  v_mul_f32 v68, v92, v68
  v_mul_f32 v61, v93, v61
  v_mul_f32 v69, v93, v69
  v_mul_f32 v62, v94, v62
  v_mul_f32 v70, v94, v70
  s_waitcnt lgkmcnt(1)
  v_mfma_f32_32x32x16_bf16 v[76:91], v[120:123], v[28:31], v[76:91]
  ds_read_b128 v[36:39], v9 offset:16384
  v_mul_f32 v63, v95, v63
  v_mul_f32 v71, v95, v71
  v_mul_f32 v64, v96, v64
  v_mul_f32 v72, v96, v72
  v_mul_f32 v65, v97, v65
  v_mul_f32 v73, v97, v73
  v_mul_f32 v66, v98, v66
  s_waitcnt lgkmcnt(1)
  v_mfma_f32_32x32x16_bf16 v[76:91], v[124:127], v[32:35], v[76:91]
  v_mfma_f32_16x16x32_bf16 v[20:23], v[24:27], v[32:35], v[20:23]
  ds_read_b128 v[28:31], v10 offset:16384
  v_mul_f32 v74, v98, v74
  v_mul_f32 v67, v99, v67
  v_mul_f32 v75, v99, v75
  ds_read_b64 v[96:97], v15 offset:13568
  ds_read_b64 v[98:99], v15 offset:13824
  ds_read_b64 v[100:101], v16 offset:12800
  v_fma_f32 v94, v102, v60, v61
  v_fma_f32 v95, v102, v68, v69
  s_waitcnt lgkmcnt(4)
  v_mfma_f32_32x32x16_bf16 v[76:91], v[128:131], v[36:39], v[76:91]
  ds_read_b128 v[32:35], v11 offset:16384
  s_waitcnt vmcnt(6)
  v_and_b32 v40, s87, v40
  v_fma_f32 v94, -v103, v68, v94
  v_fmac_f32 v95, v103, v60
  v_fma_f32 v92, v102, v94, v62
  v_fma_f32 v93, v102, v95, v70
  v_fma_f32 v92, -v103, v95, v92
  v_fmac_f32 v93, v103, v94
  s_waitcnt lgkmcnt(4)
  v_mfma_f32_32x32x16_bf16 v[76:91], v[132:135], v[28:31], v[76:91]
  ds_read_b128 v[36:39], v8 offset:24576
  v_cmp_ne_u32 vcc, s87, v40
  v_fma_f32 v94, v102, v92, v63
  v_fma_f32 v95, v102, v93, v71
  v_fma_f32 v94, -v103, v93, v94
  v_fmac_f32 v95, v103, v92
  v_fma_f32 v92, v102, v94, v64
  v_fma_f32 v93, v102, v95, v72
  v_fma_f32 v92, -v103, v95, v92
  s_waitcnt lgkmcnt(1)
  v_mfma_f32_32x32x16_bf16 v[76:91], v[136:139], v[32:35], v[76:91]
  ds_read_b128 v[28:31], v9 offset:24576
  s_nop 1
  s_cbranch_vccnz SPIN_c
BACK_c:
  v_fmac_f32 v93, v103, v94
  v_fma_f32 v94, v102, v92, v65
  v_fma_f32 v95, v102, v93, v73
  v_fma_f32 v94, -v103, v93, v94
  v_fmac_f32 v95, v103, v92
  v_fma_f32 v92, v102, v94, v66
  s_waitcnt lgkmcnt(1)
  v_mfma_f32_32x32x16_bf16 v[76:91], v[140:143], v[36:39], v[76:91]
  v_mfma_f32_16x16x32_bf16 v[20:23], v[24:27], v[36:39], v[20:23]
  ds_read_b128 v[32:35], v10 offset:24576
  buffer_load_dwordx2 v[254:255], v16, s[32:35], 0 offen offset:3072 sc1
  buffer_load_dwordx2 v[252:253], v16, s[32:35], 0 offen offset:2048 sc1
  buffer_load_dwordx2 v[42:43], v16, s[32:35], 0 offen offset:1024 sc1
  buffer_load_dwordx2 v[40:41], v16, s[32:35], 0 offen offset:0 sc1
  v_fma_f32 v93, v102, v95, v74
  v_fma_f32 v92, -v103, v95, v92
  v_fmac_f32 v93, v103, v94
  v_fma_f32 v94, v102, v92, v67
  v_fma_f32 v95, v102, v93, v75
  v_fma_f32 v94, -v103, v93, v94
  v_fmac_f32 v95, v103, v92
  s_waitcnt lgkmcnt(1)
  v_mfma_f32_32x32x16_bf16 v[76:91], v[144:147], v[28:31], v[76:91]
  ds_read_b128 v[36:39], v11 offset:24576
  s_barrier
  v_mov_b32 v92, v94
  v_mov_b32 v93, v95
  s_nop 0
  v_permlane32_swap_b32 v94, v92
  s_waitcnt lgkmcnt(1)
  v_mfma_f32_32x32x16_bf16 v[76:91], v[148:151], v[32:35], v[76:91]
  ds_read_b128 v[28:31], v8 offset:32768
  v_permlane32_swap_b32 v95, v93
  v_fmac_f32 v92, v96, v94
  v_fmac_f32 v93, v96, v95
  v_fma_f32 v92, -v97, v95, v92
  v_fmac_f32 v93, v97, v94
  v_cndmask_b32 v106, 0, v94, s[90:91]
  v_cndmask_b32 v107, 0, v95, s[90:91]
  s_waitcnt lgkmcnt(1)
  v_mfma_f32_32x32x16_bf16 v[76:91], v[152:155], v[36:39], v[76:91]
  ds_read_b128 v[32:35], v9 offset:32768
  v_mov_b32 v94, v92
  v_mov_b32 v95, v93
  s_nop 0
  v_permlane16_swap_b32 v92, v94
  v_permlane16_swap_b32 v93, v95
  v_fmac_f32 v94, v98, v92
  v_fmac_f32 v95, v98, v93
  v_fma_f32 v94, -v99, v93, v94
  v_fmac_f32 v95, v99, v92
  s_waitcnt lgkmcnt(1)
  v_mfma_f32_32x32x16_bf16 v[76:91], v[156:159], v[28:31], v[76:91]
  v_mfma_f32_16x16x32_bf16 v[20:23], v[24:27], v[28:31], v[20:23]
  ds_read_b128 v[36:39], v10 offset:32768
  s_and_b32 s40, s6, 7
  s_mul_i32 s40, s40, 73728
  s_lshl_b32 s41, s82, 8
  s_sub_u32 s40, s40, s41
  s_add_u32 s40, s40, 1024
  buffer_load_dword v3, v6, s[16:19], s40 offen
  s_mov_b64 exec, 0xffff
  ds_write_b64 v17, v[94:95] offset:22272
  s_mov_b64 exec, -1
  v_fmac_f32 v106, v100, v92
  v_fmac_f32 v107, v100, v93
  v_fma_f32 v106, -v101, v93, v106
  v_fmac_f32 v107, v101, v92
  ds_read_b64 v[102:103], v15 offset:15616
  ds_read_b64 v[92:93], v16 offset:13312
  s_waitcnt lgkmcnt(4)
  v_mfma_f32_32x32x16_bf16 v[76:91], v[160:163], v[32:35], v[76:91]
  ds_read_b128 v[28:31], v11 offset:32768
  s_waitcnt lgkmcnt(4)
  v_mfma_f32_32x32x16_bf16 v[76:91], v[164:167], v[36:39], v[76:91]
  v_add_u32 v8, 0xffff0000, v8
  v_add_u32 v9, 0xffff0000, v9
  v_add_u32 v10, 0xffff0000, v10
  v_add_u32 v11, 0xffff0000, v11
  ds_read_b128 v[32:35], v8 offset:0
  s_add_u32 m0, s36, 65536
  s_bfe_u32 s42, s0, 0x4000c
  s_lshl_b32 s42, s42, 7
  s_add_u32 s42, s42, 110592
  buffer_load_dwordx4 v6, s[12:15], s42 offen lds
  s_waitcnt lgkmcnt(1)
  v_mfma_f32_32x32x16_bf16 v[76:91], v[168:171], v[28:31], v[76:91]
  ds_read_b128 v[36:39], v9 offset:0
  s_add_u32 m0, s36, 73728
  s_bfe_u32 s43, s0, 0x40010
  s_lshl_b32 s43, s43, 7
  s_add_u32 s43, s43, 110592
  buffer_load_dwordx4 v6, s[12:15], s43 offen lds
  s_waitcnt lgkmcnt(1)
  v_mfma_f32_32x32x16_bf16 v[76:91], v[172:175], v[32:35], v[76:91]
  v_mfma_f32_16x16x32_bf16 v[20:23], v[24:27], v[32:35], v[20:23]
  ds_read_b128 v[28:31], v10 offset:0
  s_add_u32 m0, s36, 81920
  s_bfe_u32 s44, s0, 0x40014
  s_lshl_b32 s44, s44, 7
  s_add_u32 s44, s44, 110592
  buffer_load_dwordx4 v6, s[12:15], s44 offen lds
  s_waitcnt vmcnt(4)
  v_max3_u32 v2, v40, v42, v252
  v_max_u32 v2, v2, v254
  v_cmp_eq_u32 vcc, -1, v2
  s_nop 1
  s_cbranch_vccnz SPIN_p0
BACK_p0:
  s_add_u32 s32, s32, 4096
  s_addc_u32 s33, s33, 0
  v_fmac_f32 v252, v0, v254
  v_fmac_f32 v253, v0, v255
  v_fma_f32 v252, -v1, v255, v252
  v_fmac_f32 v253, v1, v254
  s_waitcnt lgkmcnt(1)
  v_mfma_f32_32x32x16_bf16 v[76:91], v[176:179], v[36:39], v[76:91]
  ds_read_b128 v[32:35], v11 offset:0
  s_barrier
  ds_read_b64 v[254:255], v16 offset:17408
  ds_read_b64 v[96:97], v17 offset:21504
  ds_read_b64 v[98:99], v17 offset:21760
  s_waitcnt lgkmcnt(4)
  v_mfma_f32_32x32x16_bf16 v[76:91], v[180:183], v[28:31], v[76:91]
  ds_read_b128 v[36:39], v8 offset:8192
  s_and_b32 s45, s6, 7
  s_mul_i32 s45, s45, 73728
  s_lshl_b32 s46, s82, 8
  s_sub_u32 s45, s45, s46
  s_add_u32 s45, s45, 1024
  buffer_load_dword v3, v6, s[20:23], s45 offen
  s_add_u32 m0, s36, 90112
  s_bfe_u32 s47, s0, 0x40018
  s_lshl_b32 s47, s47, 7
  s_add_u32 s47, s47, 110592
  buffer_load_dwordx4 v6, s[12:15], s47 offen lds
  v_fmac_f32 v42, v0, v252
  ds_read_b64 v[100:101], v17 offset:22016
  v_fmac_f32 v43, v0, v253
  v_fma_f32 v42, -v1, v253, v42
  v_fmac_f32 v43, v1, v252
  s_waitcnt lgkmcnt(5)
  v_mfma_f32_32x32x16_bf16 v[76:91], v[184:187], v[32:35], v[76:91]
  ds_read_b128 v[28:31], v9 offset:8192
  s_add_u32 m0, s36, 98304
  s_bfe_u32 s40, s0, 0x4001c
  s_lshl_b32 s40, s40, 7
  s_add_u32 s40, s40, 110592
  buffer_load_dwordx4 v6, s[12:15], s40 offen lds
  v_fmac_f32 v40, v0, v42
  s_waitcnt lgkmcnt(3)
  v_fmac_f32 v98, v102, v96
  v_fmac_f32 v99, v102, v97
  v_fma_f32 v98, -v103, v97, v98
  v_fmac_f32 v99, v103, v96
  s_waitcnt lgkmcnt(2)
  v_mfma_f32_32x32x16_bf16 v[76:91], v[188:191], v[36:39], v[76:91]
  v_mfma_f32_16x16x32_bf16 v[20:23], v[24:27], v[36:39], v[20:23]
  ds_read_b128 v[32:35], v10 offset:8192
  v_fmac_f32 v41, v0, v43
  s_waitcnt lgkmcnt(2)
  v_fmac_f32 v100, v102, v98
  v_fmac_f32 v101, v102, v99
  v_fma_f32 v100, -v103, v99, v100
  v_fmac_f32 v101, v103, v98
  v_fmac_f32 v94, v102, v100
  v_fmac_f32 v95, v102, v101
  v_fma_f32 v94, -v103, v101, v94
  s_waitcnt lgkmcnt(1)
  v_mfma_f32_32x32x16_bf16 v[76:91], v[192:195], v[28:31], v[76:91]
  ds_read_b128 v[36:39], v11 offset:8192
  v_fma_f32 v40, -v1, v43, v40
  v_fmac_f32 v95, v103, v100
  v_min_u32 v94, -2, v94
  buffer_store_dwordx2 v[94:95], v16, s[28:31], 0 offen sc1
  s_add_u32 s28, s28, 4096
  s_addc_u32 s29, s29, 0
  v_fmac_f32 v106, v92, v100
  v_fmac_f32 v107, v92, v101
  s_waitcnt lgkmcnt(1)
  v_mfma_f32_32x32x16_bf16 v[76:91], v[196:199], v[32:35], v[76:91]
  ds_read_b128 v[28:31], v8 offset:16384
  v_fmac_f32 v41, v1, v42
  v_fma_f32 v106, -v93, v101, v106
  v_fmac_f32 v107, v93, v100
  ds_read_b64 v[0:1], v15 offset:16384
  v_mul_f32 v42, v4, v40
  v_mul_f32 v43, v4, v41
  v_fma_f32 v42, -v5, v41, v42
  v_fmac_f32 v43, v5, v40
  s_waitcnt lgkmcnt(2)
  v_mfma_f32_32x32x16_bf16 v[76:91], v[200:203], v[36:39], v[76:91]
  ds_read_b128 v[32:35], v9 offset:16384
  v_permlane32_swap_b32 v42, v43
  v_add_f32 v42, v42, v43
  v_mov_b32 v43, v42
  s_nop 1
  v_permlane16_swap_b32 v42, v43
  v_add_f32 v42, v42, v43
  v_mov_b32 v43, v42
  s_nop 1
  v_permlane32_swap_b32 v42, v43
  s_waitcnt lgkmcnt(2)
  v_mfma_f32_32x32x16_bf16 v[76:91], v[204:207], v[28:31], v[76:91]
  v_mfma_f32_16x16x32_bf16 v[20:23], v[24:27], v[28:31], v[20:23]
  ds_read_b128 v[36:39], v10 offset:16384
  s_and_b32 s41, s6, 7
  s_sub_u32 s41, s41, s3
  s_mul_i32 s41, s41, 9216
  s_lshl_b32 s42, s82, 8
  s_sub_u32 s42, 590848, s42
  s_cmp_lt_u32 s3, 2
  s_cselect_b32 s42, 589824, s42
  s_add_u32 s41, s41, s42
  s_and_b32 s42, s3, 1
  s_lshl_b32 s42, s42, 7
  s_add_u32 s41, s41, s42
  s_cmp_lt_u32 s3, 3
  s_cselect_b32 s41, s41, 0x1000000
  buffer_load_dword v3, v6, s[16:19], s41 offen
  s_waitcnt lgkmcnt(2)
  v_xor_b32 v2, 0x80000000, v1
  v_fmac_f32 v104, v254, v42
  v_fmac_f32 v105, v254, v43
  v_fma_f32 v104, -v255, v43, v104
  v_fmac_f32 v105, v255, v42
  v_fmac_f32 v44, v0, v104
  v_fmac_f32 v52, v0, v105
  v_fmac_f32 v44, v2, v105
  s_waitcnt lgkmcnt(1)
  v_mfma_f32_32x32x16_bf16 v[76:91], v[208:211], v[32:35], v[76:91]
  ds_read_b128 v[28:31], v11 offset:16384
  s_barrier
  v_fmac_f32 v52, v1, v104
  v_fmac_f32 v45, v0, v44
  v_fmac_f32 v53, v0, v52
  s_waitcnt lgkmcnt(1)
  v_mfma_f32_32x32x16_bf16 v[76:91], v[212:215], v[36:39], v[76:91]
  ds_read_b128 v[32:35], v8 offset:24576
  v_fmac_f32 v45, v2, v52
  v_fmac_f32 v53, v1, v44
  v_cvt_pk_bf16_f32 v40, v44, v45
  v_cvt_pk_bf16_f32 v252, -v52, -v53
  v_fmac_f32 v46, v0, v45
  v_fmac_f32 v54, v0, v53
  v_fmac_f32 v46, v2, v53
  s_waitcnt lgkmcnt(1)
  v_mfma_f32_32x32x16_bf16 v[76:91], v[216:219], v[28:31], v[76:91]
  ds_read_b128 v[36:39], v9 offset:24576
  v_fmac_f32 v54, v1, v45
  v_fmac_f32 v47, v0, v46
  v_fmac_f32 v55, v0, v54
  v_fmac_f32 v47, v2, v54
  v_fmac_f32 v55, v1, v46
  v_cvt_pk_bf16_f32 v41, v46, v47
  v_cvt_pk_bf16_f32 v253, -v54, -v55
  v_fmac_f32 v48, v0, v47
  s_waitcnt lgkmcnt(1)
  v_mfma_f32_32x32x16_bf16 v[76:91], v[220:223], v[32:35], v[76:91]
  v_mfma_f32_16x16x32_bf16 v[20:23], v[24:27], v[32:35], v[20:23]
  ds_read_b128 v[28:31], v10 offset:24576
  v_fmac_f32 v56, v0, v55
  v_fmac_f32 v48, v2, v55
  v_fmac_f32 v56, v1, v47
  v_fmac_f32 v49, v0, v48
  v_fmac_f32 v57, v0, v56
  v_fmac_f32 v49, v2, v56
  v_fmac_f32 v57, v1, v48
  s_waitcnt lgkmcnt(1)
  v_mfma_f32_32x32x16_bf16 v[76:91], v[224:227], v[36:39], v[76:91]
  ds_read_b128 v[32:35], v11 offset:24576
  v_cvt_pk_bf16_f32 v42, v48, v49
  v_cvt_pk_bf16_f32 v254, -v56, -v57
  v_fmac_f32 v50, v0, v49
  v_fmac_f32 v58, v0, v57
  v_fmac_f32 v50, v2, v57
  v_fmac_f32 v58, v1, v49
  v_fmac_f32 v51, v0, v50
  v_fmac_f32 v59, v0, v58
  s_waitcnt lgkmcnt(1)
  v_mfma_f32_32x32x16_bf16 v[76:91], v[228:231], v[28:31], v[76:91]
  ds_read_b128 v[36:39], v8 offset:32768
  s_and_b32 s43, s6, 7
  s_sub_u32 s43, s43, s3
  s_mul_i32 s43, s43, 9216
  s_lshl_b32 s44, s82, 8
  s_sub_u32 s44, 590848, s44
  s_cmp_lt_u32 s3, 2
  s_cselect_b32 s44, 589824, s44
  s_add_u32 s43, s43, s44
  s_and_b32 s44, s3, 1
  s_lshl_b32 s44, s44, 7
  s_add_u32 s43, s43, s44
  s_cmp_lt_u32 s3, 3
  s_cselect_b32 s43, s43, 0x1000000
  buffer_load_dword v3, v6, s[20:23], s43 offen
  v_fmac_f32 v51, v2, v58
  v_fmac_f32 v59, v1, v50
  v_cvt_pk_bf16_f32 v43, v50, v51
  v_cvt_pk_bf16_f32 v255, -v58, -v59
  ds_write_b128 v18, v[40:43] offset:0
  ds_write_b128 v18, v[252:255] offset:1024
  ds_read_b64 v[0:1], v15 offset:14336
  s_waitcnt lgkmcnt(4)
  v_mfma_f32_32x32x16_bf16 v[76:91], v[232:235], v[32:35], v[76:91]
  ds_read_b128 v[28:31], v9 offset:32768
  ds_read_b64 v[40:41], v16 offset:14336
  ds_read_b64 v[42:43], v17 offset:15360
  s_waitcnt lgkmcnt(6)
  v_mfma_f32_32x32x16_bf16 v[76:91], v[236:239], v[36:39], v[76:91]
  v_mfma_f32_16x16x32_bf16 v[20:23], v[24:27], v[36:39], v[20:23]
  ds_read_b128 v[32:35], v10 offset:32768
  s_waitcnt lgkmcnt(1)
  v_mul_f32 v4, v40, v42
  v_mul_f32 v5, v40, v43
  v_fma_f32 v4, -v41, v43, v4
  v_fmac_f32 v5, v41, v42
  v_mfma_f32_32x32x16_bf16 v[76:91], v[240:243], v[28:31], v[76:91]
  ds_read_b128 v[36:39], v11 offset:32768
  ds_write_b32 v13, v20
  s_waitcnt lgkmcnt(0)
  s_barrier
  ds_read_b64 v[100:101], v7
  ds_read_b128 v[92:95], v14
  ds_read_b128 v[96:99], v14 offset:16
  v_mfma_f32_32x32x16_bf16 v[76:91], v[244:247], v[32:35], v[76:91]
  ds_read_b128 v[28:31], v8 offset:40960
  s_add_u32 m0, s36, 0
  s_and_b32 s45, s1, 15
  s_lshl_b32 s45, s45, 7
  s_add_u32 s45, s45, 110592
  buffer_load_dwordx4 v6, s[12:15], s45 offen lds
  s_add_u32 m0, s36, 8192
  s_bfe_u32 s46, s0, 0x40000
  s_lshl_b32 s46, s46, 7
  s_add_u32 s46, s46, s83
  buffer_load_dwordx4 v6, s[12:15], s46 offen lds
  s_waitcnt lgkmcnt(3)
  v_add_f32 v100, v100, v101
  v_cvt_pk_bf16_f32 v101, v100, v100
  v_lshlrev_b32 v101, 16, v101
  v_sub_f32 v102, v100, v101
  v_cvt_pk_bf16_f32 v100, v101, v102
  v_mov_b32 v101, 0
  v_mfma_f32_32x32x16_bf16 v[76:91], v[248:251], v[36:39], v[76:91]
  ds_read_b128 v[32:35], v9 offset:40960
  s_add_u32 m0, s36, 16384
  s_bfe_u32 s47, s0, 0x40004
  s_lshl_b32 s47, s47, 7
  s_add_u32 s47, s47, s83
  buffer_load_dwordx4 v6, s[12:15], s47 offen lds
  v_mfma_f32_32x32x8_bf16 v[76:91], v[12:13], v[100:101], v[76:91]
  ds_read_b64 v[102:103], v15 offset:8192
  s_waitcnt lgkmcnt(2)
  v_mfma_f32_32x32x16_bf16 v[44:59], v[108:111], v[28:31], 0
  v_mfma_f32_16x16x32_bf16 v[20:23], v[24:27], v[28:31], 0
  ds_read_b128 v[36:39], v10 offset:40960
  s_add_u32 m0, s36, 24576
  s_bfe_u32 s40, s0, 0x40008
  s_lshl_b32 s40, s40, 7
  s_add_u32 s40, s40, s83
  buffer_load_dwordx4 v6, s[12:15], s40 offen lds
  s_nop 1
  v_permlane16_swap_b32 v76, v84
  v_permlane16_swap_b32 v77, v85
  v_permlane16_swap_b32 v78, v86
  v_permlane16_swap_b32 v79, v87
  v_permlane16_swap_b32 v80, v88
  v_permlane16_swap_b32 v81, v89
  v_permlane16_swap_b32 v82, v90
  v_permlane16_swap_b32 v83, v91
  v_mul_f32 v76, v92, v76
  s_waitcnt lgkmcnt(2)
  v_mfma_f32_32x32x16_bf16 v[44:59], v[112:115], v[32:35], v[44:59]
  ds_read_b128 v[28:31], v11 offset:40960
  v_mul_f32 v84, v92, v84
  v_mul_f32 v77, v93, v77
  v_mul_f32 v85, v93, v85
  v_mul_f32 v78, v94, v78
  v_mul_f32 v86, v94, v86
  v_mul_f32 v79, v95, v79
  v_mul_f32 v87, v95, v87
  s_waitcnt lgkmcnt(1)
  v_mfma_f32_32x32x16_bf16 v[44:59], v[116:119], v[36:39], v[44:59]
  ds_read_b128 v[32:35], v8 offset:49152
  v_mul_f32 v80, v96, v80
  v_mul_f32 v88, v96, v88
  v_mul_f32 v81, v97, v81
  v_mul_f32 v89, v97, v89
  v_mul_f32 v82, v98, v82
  v_mul_f32 v90, v98, v90
  v_mul_f32 v83, v99, v83
  v_mul_f32 v91, v99, v91
  s_waitcnt lgkmcnt(1)
  v_mfma_f32_32x32x16_bf16 v[44:59], v[120:123], v[28:31], v[44:59]
  ds_read_b128 v[36:39], v9 offset:49152
  ds_read_b64 v[96:97], v15 offset:9472
  ds_read_b64 v[98:99], v15 offset:9728
  ds_read_b64 v[100:101], v16 offset:8704
  v_fma_f32 v94, v102, v76, v77
  v_fma_f32 v95, v102, v84, v85
  v_fma_f32 v94, -v103, v84, v94
  v_fmac_f32 v95, v103, v76
  s_waitcnt lgkmcnt(4)
  v_mfma_f32_32x32x16_bf16 v[44:59], v[124:127], v[32:35], v[44:59]
  v_mfma_f32_16x16x32_bf16 v[20:23], v[24:27], v[32:35], v[20:23]
  ds_read_b128 v[28:31], v10 offset:49152
  v_fma_f32 v92, v102, v94, v78
  v_fma_f32 v93, v102, v95, v86
  v_fma_f32 v92, -v103, v95, v92
  v_fmac_f32 v93, v103, v94
  v_fma_f32 v94, v102, v92, v79
  v_fma_f32 v95, v102, v93, v87
  v_fma_f32 v94, -v103, v93, v94
  v_fmac_f32 v95, v103, v92
  s_waitcnt lgkmcnt(4)
  v_mfma_f32_32x32x16_bf16 v[44:59], v[128:131], v[36:39], v[44:59]
  ds_read_b128 v[32:35], v11 offset:49152
  v_fma_f32 v92, v102, v94, v80
  v_fma_f32 v93, v102, v95, v88
  v_fma_f32 v92, -v103, v95, v92
  v_fmac_f32 v93, v103, v94
  v_fma_f32 v94, v102, v92, v81
  v_fma_f32 v95, v102, v93, v89
  v_fma_f32 v94, -v103, v93, v94
  s_waitcnt lgkmcnt(1)
  v_mfma_f32_32x32x16_bf16 v[44:59], v[132:135], v[28:31], v[44:59]
  ds_read_b128 v[36:39], v8 offset:57344
  v_fmac_f32 v95, v103, v92
  v_fma_f32 v92, v102, v94, v82
  v_fma_f32 v93, v102, v95, v90
  v_fma_f32 v92, -v103, v95, v92
  v_fmac_f32 v93, v103, v94
  v_fma_f32 v94, v102, v92, v83
  v_fma_f32 v95, v102, v93, v91
  v_fma_f32 v94, -v103, v93, v94
  s_waitcnt lgkmcnt(1)
  v_mfma_f32_32x32x16_bf16 v[44:59], v[136:139], v[32:35], v[44:59]
  ds_read_b128 v[28:31], v9 offset:57344
  buffer_load_dwordx2 v[254:255], v16, s[32:35], 0 offen offset:3072 sc1
  buffer_load_dwordx2 v[252:253], v16, s[32:35], 0 offen offset:2048 sc1
  buffer_load_dwordx2 v[42:43], v16, s[32:35], 0 offen offset:1024 sc1
  buffer_load_dwordx2 v[40:41], v16, s[32:35], 0 offen offset:0 sc1
  v_fmac_f32 v95, v103, v92
  v_mov_b32 v92, v94
  v_mov_b32 v93, v95
  s_nop 0
  v_permlane32_swap_b32 v94, v92
  v_permlane32_swap_b32 v95, v93
  v_fmac_f32 v92, v96, v94
  s_waitcnt lgkmcnt(1)
  v_mfma_f32_32x32x16_bf16 v[44:59], v[140:143], v[36:39], v[44:59]
  v_mfma_f32_16x16x32_bf16 v[20:23], v[24:27], v[36:39], v[20:23]
  ds_read_b128 v[32:35], v10 offset:57344
  v_mul_f32 v2, v1, v60
  v_fmac_f32 v93, v96, v95
  v_fma_f32 v92, -v97, v95, v92
  v_fmac_f32 v93, v97, v94
  v_cndmask_b32 v104, 0, v94, s[90:91]
  v_cndmask_b32 v105, 0, v95, s[90:91]
  v_mov_b32 v94, v92
  v_mov_b32 v95, v93
  s_waitcnt lgkmcnt(1)
  v_mfma_f32_32x32x16_bf16 v[44:59], v[144:147], v[28:31], v[44:59]
  ds_read_b128 v[36:39], v11 offset:57344
  s_waitcnt vmcnt(15)
  s_barrier
  v_mul_f32 v60, v0, v60
  v_permlane16_swap_b32 v92, v94
  v_permlane16_swap_b32 v93, v95
  s_waitcnt lgkmcnt(1)
  v_mfma_f32_32x32x16_bf16 v[44:59], v[148:151], v[32:35], v[44:59]
  v_add_u32 v8, 0x10000, v8
  v_add_u32 v9, 0x10000, v9
  v_add_u32 v10, 0x10000, v10
  v_add_u32 v11, 0x10000, v11
  ds_read_b128 v[28:31], v8 offset:0
  v_fma_f32 v60, -v1, v68, v60
  v_fmac_f32 v94, v98, v92
  v_fmac_f32 v95, v98, v93
  v_fma_f32 v94, -v99, v93, v94
  v_fmac_f32 v95, v99, v92
  s_mov_b64 exec, 0xffff
  ds_write_b64 v17, v[94:95] offset:22272
  s_mov_b64 exec, -1
  v_fmac_f32 v104, v100, v92
  s_waitcnt lgkmcnt(2)
  v_mfma_f32_32x32x16_bf16 v[44:59], v[152:155], v[36:39], v[44:59]
  ds_read_b128 v[32:35], v9 offset:0
  v_fma_f32 v68, v0, v68, v2
  v_fmac_f32 v105, v100, v93
  v_fma_f32 v104, -v101, v93, v104
  v_fmac_f32 v105, v101, v92
  ds_read_b64 v[102:103], v15 offset:11520
  ds_read_b64 v[92:93], v16 offset:9216
  v_mul_f32 v2, v1, v61
  v_mul_f32 v61, v0, v61
  s_waitcnt lgkmcnt(4)
  v_mfma_f32_32x32x16_bf16 v[44:59], v[156:159], v[28:31], v[44:59]
  v_mfma_f32_16x16x32_bf16 v[20:23], v[24:27], v[28:31], v[20:23]
  ds_read_b128 v[36:39], v10 offset:0
  s_add_u32 m0, s36, 32768
  s_bfe_u32 s41, s0, 0x4000c
  s_lshl_b32 s41, s41, 7
  s_add_u32 s41, s41, s83
  buffer_load_dwordx4 v6, s[12:15], s41 offen lds
  v_fma_f32 v61, -v1, v69, v61
  v_fma_f32 v69, v0, v69, v2
  v_mul_f32 v2, v1, v62
  v_mul_f32 v62, v0, v62
  v_fma_f32 v62, -v1, v70, v62
  s_waitcnt lgkmcnt(3)
  v_mfma_f32_32x32x16_bf16 v[44:59], v[160:163], v[32:35], v[44:59]
  ds_read_b128 v[28:31], v11 offset:0
  s_add_u32 m0, s36, 40960
  s_bfe_u32 s42, s0, 0x40010
  s_lshl_b32 s42, s42, 7
  s_add_u32 s42, s42, s83
  buffer_load_dwordx4 v6, s[12:15], s42 offen lds
  v_fma_f32 v70, v0, v70, v2
  v_mul_f32 v2, v1, v63
  v_mul_f32 v63, v0, v63
  v_fma_f32 v63, -v1, v71, v63
  v_fma_f32 v71, v0, v71, v2
  s_waitcnt lgkmcnt(1)
  v_mfma_f32_32x32x16_bf16 v[44:59], v[164:167], v[36:39], v[44:59]
  ds_read_b128 v[32:35], v8 offset:8192
  s_add_u32 m0, s36, 49152
  s_bfe_u32 s43, s0, 0x40014
  s_lshl_b32 s43, s43, 7
  s_add_u32 s43, s43, s83
  buffer_load_dwordx4 v6, s[12:15], s43 offen lds
  v_mul_f32 v2, v1, v64
  v_mul_f32 v64, v0, v64
  v_fma_f32 v64, -v1, v72, v64
  v_fma_f32 v72, v0, v72, v2
  v_mul_f32 v2, v1, v65
  v_mul_f32 v65, v0, v65
  s_waitcnt lgkmcnt(1)
  v_mfma_f32_32x32x16_bf16 v[44:59], v[168:171], v[28:31], v[44:59]
  ds_read_b128 v[36:39], v9 offset:8192
  v_fma_f32 v65, -v1, v73, v65
  v_fma_f32 v73, v0, v73, v2
  v_mul_f32 v2, v1, v66
  v_mul_f32 v66, v0, v66
  v_fma_f32 v66, -v1, v74, v66
  v_fma_f32 v74, v0, v74, v2
  v_mul_f32 v2, v1, v67
  s_waitcnt lgkmcnt(1)
  v_mfma_f32_32x32x16_bf16 v[44:59], v[172:175], v[32:35], v[44:59]
  v_mfma_f32_16x16x32_bf16 v[20:23], v[24:27], v[32:35], v[20:23]
  ds_read_b128 v[28:31], v10 offset:8192
  v_mul_f32 v67, v0, v67
  v_fma_f32 v67, -v1, v75, v67
  v_fma_f32 v75, v0, v75, v2
  v_mul_f32 v2, v1, v106
  v_mul_f32 v106, v0, v106
  v_fma_f32 v106, -v1, v107, v106
  v_fma_f32 v107, v0, v107, v2
  ds_read_b64 v[0:1], v15 offset:12544
  s_waitcnt lgkmcnt(2)
  v_mfma_f32_32x32x16_bf16 v[44:59], v[176:179], v[36:39], v[44:59]
  ds_read_b128 v[32:35], v11 offset:8192
  s_waitcnt vmcnt(15)
  s_barrier
  s_waitcnt vmcnt(3)
  v_max3_u32 v2, v40, v42, v252
  ds_read_b64 v[96:97], v17 offset:21504
  ds_read_b64 v[98:99], v17 offset:21760
  s_waitcnt lgkmcnt(4)
  v_mfma_f32_32x32x16_bf16 v[44:59], v[180:183], v[28:31], v[44:59]
  ds_read_b128 v[36:39], v8 offset:16384
  s_add_u32 m0, s36, 57344
  s_bfe_u32 s44, s0, 0x40018
  s_lshl_b32 s44, s44, 7
  s_add_u32 s44, s44, s83
  buffer_load_dwordx4 v6, s[12:15], s44 offen lds
  v_max_u32 v2, v2, v254
  ds_read_b64 v[100:101], v17 offset:22016
  v_cmp_eq_u32 vcc, -1, v2
  s_nop 1
  s_cbranch_vccnz SPIN_p1
BACK_p1:
  s_add_u32 s32, s32, 4096
  s_addc_u32 s33, s33, 0
  s_waitcnt lgkmcnt(4)
  v_mfma_f32_32x32x16_bf16 v[44:59], v[184:187], v[32:35], v[44:59]
  ds_read_b128 v[28:31], v9 offset:16384
  s_add_u32 m0, s36, 65536
  s_bfe_u32 s45, s0, 0x4001c
  s_lshl_b32 s45, s45, 7
  s_add_u32 s45, s45, s83
  buffer_load_dwordx4 v6, s[12:15], s45 offen lds
  v_fmac_f32 v252, v0, v254
  s_waitcnt lgkmcnt(3)
  v_fmac_f32 v98, v102, v96
  v_fmac_f32 v99, v102, v97
  v_fma_f32 v98, -v103, v97, v98
  v_fmac_f32 v99, v103, v96
  s_waitcnt lgkmcnt(2)
  v_mfma_f32_32x32x16_bf16 v[44:59], v[188:191], v[36:39], v[44:59]
  v_mfma_f32_16x16x32_bf16 v[20:23], v[24:27], v[36:39], v[20:23]
  ds_read_b128 v[32:35], v10 offset:16384
  v_fmac_f32 v253, v0, v255
  s_waitcnt lgkmcnt(2)
  v_fmac_f32 v100, v102, v98
  v_fmac_f32 v101, v102, v99
  v_fma_f32 v100, -v103, v99, v100
  v_fmac_f32 v101, v103, v98
  v_fmac_f32 v94, v102, v100
  v_fmac_f32 v95, v102, v101
  v_fma_f32 v94, -v103, v101, v94
  s_waitcnt lgkmcnt(1)
  v_mfma_f32_32x32x16_bf16 v[44:59], v[192:195], v[28:31], v[44:59]
  ds_read_b128 v[36:39], v11 offset:16384
  v_fma_f32 v252, -v1, v255, v252
  v_fmac_f32 v95, v103, v100
  v_min_u32 v94, -2, v94
  buffer_store_dwordx2 v[94:95], v16, s[28:31], 0 offen sc1
  s_add_u32 s28, s28, 4096
  s_addc_u32 s29, s29, 0
  v_fmac_f32 v104, v92, v100
  v_fmac_f32 v105, v92, v101
  s_waitcnt lgkmcnt(1)
  v_mfma_f32_32x32x16_bf16 v[44:59], v[196:199], v[32:35], v[44:59]
  ds_read_b128 v[28:31], v8 offset:24576
  v_fmac_f32 v253, v1, v254
  v_fma_f32 v104, -v93, v101, v104
  v_fmac_f32 v105, v93, v100
  ds_read_b64 v[254:255], v16 offset:13312
  v_fmac_f32 v42, v0, v252
  v_fmac_f32 v43, v0, v253
  v_fma_f32 v42, -v1, v253, v42
  v_fmac_f32 v43, v1, v252
  s_waitcnt lgkmcnt(2)
  v_mfma_f32_32x32x16_bf16 v[44:59], v[200:203], v[36:39], v[44:59]
  ds_read_b128 v[32:35], v9 offset:24576
  v_fmac_f32 v40, v0, v42
  v_fmac_f32 v41, v0, v43
  v_fma_f32 v40, -v1, v43, v40
  v_fmac_f32 v41, v1, v42
  ds_read_b64 v[0:1], v15 offset:12288
  v_mul_f32 v42, v4, v40
  v_mul_f32 v43, v4, v41
  s_waitcnt lgkmcnt(3)
  v_mfma_f32_32x32x16_bf16 v[44:59], v[204:207], v[28:31], v[44:59]
  v_mfma_f32_16x16x32_bf16 v[20:23], v[24:27], v[28:31], v[20:23]
  ds_read_b128 v[36:39], v10 offset:24576
  v_fma_f32 v42, -v5, v41, v42
  v_fmac_f32 v43, v5, v40
  s_nop 1
  v_permlane32_swap_b32 v42, v43
  v_add_f32 v42, v42, v43
  v_mov_b32 v43, v42
  s_nop 1
  v_permlane16_swap_b32 v42, v43
  v_add_f32 v42, v42, v43
  v_mov_b32 v43, v42
  s_waitcnt lgkmcnt(2)
  v_mfma_f32_32x32x16_bf16 v[44:59], v[208:211], v[32:35], v[44:59]
  ds_read_b128 v[28:31], v11 offset:24576
  s_barrier
  v_permlane32_swap_b32 v42, v43
  s_waitcnt lgkmcnt(2)
  v_xor_b32 v2, 0x80000000, v1
  v_fmac_f32 v106, v254, v42
  s_waitcnt lgkmcnt(1)
  v_mfma_f32_32x32x16_bf16 v[44:59], v[212:215], v[36:39], v[44:59]
  ds_read_b128 v[32:35], v8 offset:32768
  v_fmac_f32 v107, v254, v43
  v_fma_f32 v106, -v255, v43, v106
  v_fmac_f32 v107, v255, v42
  v_fmac_f32 v60, v0, v106
  v_fmac_f32 v68, v0, v107
  v_fmac_f32 v60, v2, v107
  v_fmac_f32 v68, v1, v106
  s_waitcnt lgkmcnt(1)
  v_mfma_f32_32x32x16_bf16 v[44:59], v[216:219], v[28:31], v[44:59]
  ds_read_b128 v[36:39], v9 offset:32768
  v_fmac_f32 v61, v0, v60
  v_fmac_f32 v69, v0, v68
  v_fmac_f32 v61, v2, v68
  v_fmac_f32 v69, v1, v60
  v_cvt_pk_bf16_f32 v40, v60, v61
  v_cvt_pk_bf16_f32 v252, -v68, -v69
  v_fmac_f32 v62, v0, v61
  v_fmac_f32 v70, v0, v69
  s_waitcnt lgkmcnt(1)
  v_mfma_f32_32x32x16_bf16 v[44:59], v[220:223], v[32:35], v[44:59]
  v_mfma_f32_16x16x32_bf16 v[20:23], v[24:27], v[32:35], v[20:23]
  ds_read_b128 v[28:31], v10 offset:32768
  v_fmac_f32 v62, v2, v69
  v_fmac_f32 v70, v1, v61
  v_fmac_f32 v63, v0, v62
  v_fmac_f32 v71, v0, v70
  v_fmac_f32 v63, v2, v70
  v_fmac_f32 v71, v1, v62
  v_cvt_pk_bf16_f32 v41, v62, v63
  s_waitcnt lgkmcnt(1)
  v_mfma_f32_32x32x16_bf16 v[44:59], v[224:227], v[36:39], v[44:59]
  ds_read_b128 v[32:35], v11 offset:32768
  v_cvt_pk_bf16_f32 v253, -v70, -v71
  v_fmac_f32 v64, v0, v63
  v_fmac_f32 v72, v0, v71
  v_fmac_f32 v64, v2, v71
  v_fmac_f32 v72, v1, v63
  v_fmac_f32 v65, v0, v64
  v_fmac_f32 v73, v0, v72
  v_fmac_f32 v65, v2, v72
  s_waitcnt lgkmcnt(1)
  v_mfma_f32_32x32x16_bf16 v[44:59], v[228:231], v[28:31], v[44:59]
  v_add_u32 v8, 0xffff0000, v8
  v_add_u32 v9, 0xffff0000, v9
  v_add_u32 v10, 0xffff0000, v10
  v_add_u32 v11, 0xffff0000, v11
  ds_read_b128 v[36:39], v8 offset:0
  v_fmac_f32 v73, v1, v64
  v_cvt_pk_bf16_f32 v42, v64, v65
  v_cvt_pk_bf16_f32 v254, -v72, -v73
  v_fmac_f32 v66, v0, v65
  v_fmac_f32 v74, v0, v73
  v_fmac_f32 v66, v2, v73
  v_fmac_f32 v74, v1, v65
  s_waitcnt lgkmcnt(1)
  v_mfma_f32_32x32x16_bf16 v[44:59], v[232:235], v[32:35], v[44:59]
  ds_read_b128 v[28:31], v9 offset:0
  v_fmac_f32 v67, v0, v66
  v_fmac_f32 v75, v0, v74
  v_fmac_f32 v67, v2, v74
  v_fmac_f32 v75, v1, v66
  v_cvt_pk_bf16_f32 v43, v66, v67
  v_cvt_pk_bf16_f32 v255, -v74, -v75
  ds_write_b128 v18, v[40:43] offset:16384
  ds_write_b128 v18, v[252:255] offset:17408
  s_waitcnt lgkmcnt(3)
  v_mfma_f32_32x32x16_bf16 v[44:59], v[236:239], v[36:39], v[44:59]
  v_mfma_f32_16x16x32_bf16 v[20:23], v[24:27], v[36:39], v[20:23]
  ds_read_b128 v[32:35], v10 offset:0
  ds_read_b64 v[0:1], v15 offset:10240
  ds_read_b64 v[40:41], v16 offset:10240
  ds_read_b64 v[42:43], v17 offset:11264
  s_waitcnt lgkmcnt(6)
  v_mfma_f32_32x32x16_bf16 v[44:59], v[240:243], v[28:31], v[44:59]
  ds_read_b128 v[36:39], v11 offset:0
  s_nop 0
  ds_write_b32 v13, v20
  s_waitcnt lgkmcnt(0)
  s_barrier
  v_mul_f32 v4, v40, v42
  ds_read_b64 v[100:101], v7
  ds_read_b128 v[92:95], v14
  ds_read_b128 v[96:99], v14 offset:16
  v_mul_f32 v5, v40, v43
  v_fma_f32 v4, -v41, v43, v4
  v_fmac_f32 v5, v41, v42
  v_mfma_f32_32x32x16_bf16 v[44:59], v[244:247], v[32:35], v[44:59]
  ds_read_b128 v[28:31], v8 offset:8192
  s_add_u32 m0, s36, 73728
  s_and_b32 s46, s1, 15
  s_lshl_b32 s46, s46, 7
  s_add_u32 s46, s46, s83
  buffer_load_dwordx4 v6, s[12:15], s46 offen lds
  s_add_u32 m0, s36, 81920
  s_mov_b32 s47, 0
  buffer_load_dwordx4 v6, s[16:19], s47 offen lds
  s_waitcnt lgkmcnt(3)
  v_add_f32 v100, v100, v101
  v_cvt_pk_bf16_f32 v101, v100, v100
  v_lshlrev_b32 v101, 16, v101
  v_sub_f32 v102, v100, v101
  v_cvt_pk_bf16_f32 v100, v101, v102
  v_mfma_f32_32x32x16_bf16 v[44:59], v[248:251], v[36:39], v[44:59]
  ds_read_b128 v[32:35], v9 offset:8192
  s_add_u32 m0, s36, 90112
  s_mov_b32 s40, 0
  buffer_load_dwordx4 v6, s[20:23], s40 offen lds
  v_mov_b32 v101, 0
  s_nop 1
  v_mfma_f32_32x32x8_bf16 v[44:59], v[12:13], v[100:101], v[44:59]
  ds_read_b64 v[102:103], v15 offset:4096
  s_waitcnt lgkmcnt(2)
  v_mfma_f32_32x32x16_bf16 v[60:75], v[108:111], v[28:31], 0
  v_mfma_f32_16x16x32_bf16 v[20:23], v[24:27], v[28:31], 0
  ds_read_b128 v[36:39], v10 offset:8192
  s_add_u32 m0, s36, 98304
  s_mov_b32 s41, 73728
  buffer_load_dwordx4 v6, s[16:19], s41 offen lds
  s_nop 3
  v_permlane16_swap_b32 v44, v52
  v_permlane16_swap_b32 v45, v53
  v_permlane16_swap_b32 v46, v54
  v_permlane16_swap_b32 v47, v55
  v_permlane16_swap_b32 v48, v56
  v_permlane16_swap_b32 v49, v57
  v_permlane16_swap_b32 v50, v58
  s_waitcnt lgkmcnt(2)
  v_mfma_f32_32x32x16_bf16 v[60:75], v[112:115], v[32:35], v[60:75]
  ds_read_b128 v[28:31], v11 offset:8192
  v_permlane16_swap_b32 v51, v59
  v_mul_f32 v44, v92, v44
  v_mul_f32 v52, v92, v52
  v_mul_f32 v45, v93, v45
  v_mul_f32 v53, v93, v53
  v_mul_f32 v46, v94, v46
  v_mul_f32 v54, v94, v54
  s_waitcnt lgkmcnt(1)
  v_mfma_f32_32x32x16_bf16 v[60:75], v[116:119], v[36:39], v[60:75]
  ds_read_b128 v[32:35], v8 offset:16384
  v_mul_f32 v47, v95, v47
  v_mul_f32 v55, v95, v55
  v_mul_f32 v48, v96, v48
  v_mul_f32 v56, v96, v56
  v_mul_f32 v49, v97, v49
  v_mul_f32 v57, v97, v57
  v_mul_f32 v50, v98, v50
  v_mul_f32 v58, v98, v58
  s_waitcnt lgkmcnt(1)
  v_mfma_f32_32x32x16_bf16 v[60:75], v[120:123], v[28:31], v[60:75]
  ds_read_b128 v[36:39], v9 offset:16384
  v_mul_f32 v51, v99, v51
  v_mul_f32 v59, v99, v59
  ds_read_b64 v[96:97], v15 offset:5376
  ds_read_b64 v[98:99], v15 offset:5632
  ds_read_b64 v[100:101], v16 offset:4608
  v_fma_f32 v94, v102, v44, v45
  v_fma_f32 v95, v102, v52, v53
  s_waitcnt lgkmcnt(4)
  v_mfma_f32_32x32x16_bf16 v[60:75], v[124:127], v[32:35], v[60:75]
  v_mfma_f32_16x16x32_bf16 v[20:23], v[24:27], v[32:35], v[20:23]
  ds_read_b128 v[28:31], v10 offset:16384
  v_fma_f32 v94, -v103, v52, v94
  v_fmac_f32 v95, v103, v44
  v_fma_f32 v92, v102, v94, v46
  v_fma_f32 v93, v102, v95, v54
  v_fma_f32 v92, -v103, v95, v92
  v_fmac_f32 v93, v103, v94
  v_fma_f32 v94, v102, v92, v47
  v_fma_f32 v95, v102, v93, v55
  s_waitcnt lgkmcnt(4)
  v_mfma_f32_32x32x16_bf16 v[60:75], v[128:131], v[36:39], v[60:75]
  ds_read_b128 v[32:35], v11 offset:16384
  v_fma_f32 v94, -v103, v93, v94
  v_fmac_f32 v95, v103, v92
  v_fma_f32 v92, v102, v94, v48
  v_fma_f32 v93, v102, v95, v56
  v_fma_f32 v92, -v103, v95, v92
  v_fmac_f32 v93, v103, v94
  v_fma_f32 v94, v102, v92, v49
  s_waitcnt lgkmcnt(1)
  v_mfma_f32_32x32x16_bf16 v[60:75], v[132:135], v[28:31], v[60:75]
  ds_read_b128 v[36:39], v8 offset:24576
  v_fma_f32 v95, v102, v93, v57
  v_fma_f32 v94, -v103, v93, v94
  v_fmac_f32 v95, v103, v92
  v_fma_f32 v92, v102, v94, v50
  v_fma_f32 v93, v102, v95, v58
  v_fma_f32 v92, -v103, v95, v92
  v_fmac_f32 v93, v103, v94
  v_fma_f32 v94, v102, v92, v51
  s_waitcnt lgkmcnt(1)
  v_mfma_f32_32x32x16_bf16 v[60:75], v[136:139], v[32:35], v[60:75]
  ds_read_b128 v[28:31], v9 offset:24576
  buffer_load_dwordx2 v[254:255], v16, s[32:35], 0 offen offset:3072 sc1
  buffer_load_dwordx2 v[252:253], v16, s[32:35], 0 offen offset:2048 sc1
  buffer_load_dwordx2 v[42:43], v16, s[32:35], 0 offen offset:1024 sc1
  buffer_load_dwordx2 v[40:41], v16, s[32:35], 0 offen offset:0 sc1
  v_fma_f32 v95, v102, v93, v59
  v_fma_f32 v94, -v103, v93, v94
  v_fmac_f32 v95, v103, v92
  v_mov_b32 v92, v94
  v_mov_b32 v93, v95
  s_nop 0
  v_permlane32_swap_b32 v94, v92
  s_waitcnt lgkmcnt(1)
  v_mfma_f32_32x32x16_bf16 v[60:75], v[140:143], v[36:39], v[60:75]
  v_mfma_f32_16x16x32_bf16 v[20:23], v[24:27], v[36:39], v[20:23]
  ds_read_b128 v[32:35], v10 offset:24576
  ds_read_b64_tr_b16 v[108:109], v19 offset:0
  v_mul_f32 v2, v1, v76
  v_permlane32_swap_b32 v95, v93
  v_fmac_f32 v92, v96, v94
  v_fmac_f32 v93, v96, v95
  v_fma_f32 v92, -v97, v95, v92
  v_fmac_f32 v93, v97, v94
  v_cndmask_b32 v106, 0, v94, s[90:91]
  v_cndmask_b32 v107, 0, v95, s[90:91]
  s_waitcnt lgkmcnt(2)
  v_mfma_f32_32x32x16_bf16 v[60:75], v[144:147], v[28:31], v[60:75]
  ds_read_b128 v[36:39], v11 offset:24576
  s_waitcnt lgkmcnt(1)
  s_waitcnt vmcnt(12)
  s_barrier
  v_mul_f32 v76, v0, v76
  v_mov_b32 v94, v92
  v_mov_b32 v95, v93
  v_mfma_f32_32x32x16_bf16 v[60:75], v[148:151], v[32:35], v[60:75]
  ds_read_b128 v[28:31], v8 offset:32768
  ds_read_b64_tr_b16 v[110:111], v19 offset:256
  v_fma_f32 v76, -v1, v84, v76
  v_permlane16_swap_b32 v92, v94
  v_permlane16_swap_b32 v93, v95
  v_fmac_f32 v94, v98, v92
  v_fmac_f32 v95, v98, v93
  v_fma_f32 v94, -v99, v93, v94
  v_fmac_f32 v95, v99, v92
  s_waitcnt lgkmcnt(2)
  v_mfma_f32_32x32x16_bf16 v[60:75], v[152:155], v[36:39], v[60:75]
  ds_read_b128 v[32:35], v9 offset:32768
  ds_read_b64_tr_b16 v[124:125], v19 offset:1024
  v_fma_f32 v84, v0, v84, v2
  s_mov_b64 exec, 0xffff
  ds_write_b64 v17, v[94:95] offset:22272
  s_mov_b64 exec, -1
  v_fmac_f32 v106, v100, v92
  v_fmac_f32 v107, v100, v93
  v_fma_f32 v106, -v101, v93, v106
  v_fmac_f32 v107, v101, v92
  ds_read_b64 v[102:103], v15 offset:7424
  ds_read_b64 v[92:93], v16 offset:5120
  s_waitcnt lgkmcnt(6)
  v_mfma_f32_32x32x16_bf16 v[60:75], v[156:159], v[28:31], v[60:75]
  v_mfma_f32_16x16x32_bf16 v[20:23], v[24:27], v[28:31], v[20:23]
  ds_read_b128 v[36:39], v10 offset:32768
  ds_read_b64_tr_b16 v[126:127], v19 offset:1280
  v_mul_f32 v2, v1, v77
  v_mul_f32 v77, v0, v77
  v_fma_f32 v77, -v1, v85, v77
  v_fma_f32 v85, v0, v85, v2
  v_mul_f32 v2, v1, v78
  v_mul_f32 v78, v0, v78
  v_fma_f32 v78, -v1, v86, v78
  s_waitcnt lgkmcnt(6)
  v_mfma_f32_32x32x16_bf16 v[60:75], v[160:163], v[32:35], v[60:75]
  ds_read_b128 v[28:31], v11 offset:32768
  s_add_u32 m0, s36, 0
  s_mov_b32 s42, 73728
  buffer_load_dwordx4 v6, s[20:23], s42 offen lds
  ds_read_b64_tr_b16 v[112:113], v19 offset:2048
  v_fma_f32 v86, v0, v86, v2
  v_mul_f32 v2, v1, v79
  v_mul_f32 v79, v0, v79
  v_fma_f32 v79, -v1, v87, v79
  v_fma_f32 v87, v0, v87, v2
  v_mul_f32 v2, v1, v80
  s_waitcnt lgkmcnt(3)
  v_mfma_f32_32x32x16_bf16 v[60:75], v[164:167], v[36:39], v[60:75]
  ds_read_b128 v[32:35], v8 offset:40960
  s_add_u32 m0, s36, 8192
  s_mov_b32 s43, 221184
  buffer_load_dwordx4 v6, s[16:19], s43 offen lds
  ds_read_b64_tr_b16 v[114:115], v19 offset:2304
  v_mul_f32 v80, v0, v80
  v_fma_f32 v80, -v1, v88, v80
  v_fma_f32 v88, v0, v88, v2
  v_mul_f32 v2, v1, v81
  v_mul_f32 v81, v0, v81
  s_waitcnt lgkmcnt(3)
  v_mfma_f32_32x32x16_bf16 v[60:75], v[168:171], v[28:31], v[60:75]
  ds_read_b128 v[36:39], v9 offset:40960
  s_add_u32 m0, s36, 16384
  s_mov_b32 s44, 221184
  buffer_load_dwordx4 v6, s[20:23], s44 offen lds
  ds_read_b64_tr_b16 v[128:129], v19 offset:3072
  v_fma_f32 v81, -v1, v89, v81
  v_fma_f32 v89, v0, v89, v2
  v_mul_f32 v2, v1, v82
  v_mul_f32 v82, v0, v82
  v_fma_f32 v82, -v1, v90, v82
  s_waitcnt lgkmcnt(3)
  v_mfma_f32_32x32x16_bf16 v[60:75], v[172:175], v[32:35], v[60:75]
  v_mfma_f32_16x16x32_bf16 v[20:23], v[24:27], v[32:35], v[20:23]
  ds_read_b128 v[28:31], v10 offset:40960
  ds_read_b64_tr_b16 v[130:131], v19 offset:3328
  v_fma_f32 v90, v0, v90, v2
  v_mul_f32 v2, v1, v83
  v_mul_f32 v83, v0, v83
  v_fma_f32 v83, -v1, v91, v83
  v_fma_f32 v91, v0, v91, v2
  v_mul_f32 v2, v1, v104
  v_mul_f32 v104, v0, v104
  v_fma_f32 v104, -v1, v105, v104
  s_waitcnt lgkmcnt(3)
  v_mfma_f32_32x32x16_bf16 v[60:75], v[176:179], v[36:39], v[60:75]
  ds_read_b128 v[32:35], v11 offset:40960
  s_waitcnt lgkmcnt(1)
  s_waitcnt vmcnt(13)
  s_barrier
  v_fma_f32 v105, v0, v105, v2
  ds_read_b64 v[96:97], v17 offset:21504
  ds_read_b64 v[98:99], v17 offset:21760
  v_mfma_f32_32x32x16_bf16 v[60:75], v[180:183], v[28:31], v[60:75]
  ds_read_b128 v[36:39], v8 offset:49152
  s_add_u32 m0, s36, 24576
  s_mov_b32 s45, 294912
  buffer_load_dwordx4 v6, s[16:19], s45 offen lds
  ds_read_b64_tr_b16 v[116:117], v19 offset:16384
  ds_read_b64 v[0:1], v15 offset:8448
  ds_read_b64 v[100:101], v17 offset:22016
  s_waitcnt vmcnt(4)
  v_max3_u32 v2, v40, v42, v252
  v_max_u32 v2, v2, v254
  v_cmp_eq_u32 vcc, -1, v2
  s_waitcnt lgkmcnt(6)
  v_mfma_f32_32x32x16_bf16 v[60:75], v[184:187], v[32:35], v[60:75]
  ds_read_b128 v[28:31], v9 offset:49152
  s_add_u32 m0, s36, 32768
  s_mov_b32 s46, 294912
  buffer_load_dwordx4 v6, s[20:23], s46 offen lds
  ds_read_b64_tr_b16 v[118:119], v19 offset:16640
  s_nop 1
  s_cbranch_vccnz SPIN_p2
BACK_p2:
  s_waitcnt lgkmcnt(6)
  v_fmac_f32 v98, v102, v96
  v_fmac_f32 v99, v102, v97
  v_fma_f32 v98, -v103, v97, v98
  v_fmac_f32 v99, v103, v96
  s_waitcnt lgkmcnt(5)
  v_mfma_f32_32x32x16_bf16 v[60:75], v[188:191], v[36:39], v[60:75]
  v_mfma_f32_16x16x32_bf16 v[20:23], v[24:27], v[36:39], v[20:23]
  ds_read_b128 v[32:35], v10 offset:49152
  ds_read_b64_tr_b16 v[132:133], v19 offset:17408
  s_add_u32 s32, s32, 4096
  s_addc_u32 s33, s33, 0
  s_waitcnt lgkmcnt(4)
  v_fmac_f32 v100, v102, v98
  v_fmac_f32 v101, v102, v99
  v_fma_f32 v100, -v103, v99, v100
  v_fmac_f32 v101, v103, v98
  v_fmac_f32 v94, v102, v100
  v_fmac_f32 v95, v102, v101
  v_fma_f32 v94, -v103, v101, v94
  s_waitcnt lgkmcnt(3)
  v_mfma_f32_32x32x16_bf16 v[60:75], v[192:195], v[28:31], v[60:75]
  ds_read_b128 v[36:39], v11 offset:49152
  ds_read_b64_tr_b16 v[134:135], v19 offset:17664
  v_fmac_f32 v252, v0, v254
  v_fmac_f32 v95, v103, v100
  v_min_u32 v94, -2, v94
  buffer_store_dwordx2 v[94:95], v16, s[28:31], 0 offen sc1
  s_add_u32 s28, s28, 4096
  s_addc_u32 s29, s29, 0
  v_fmac_f32 v106, v92, v100
  v_fmac_f32 v107, v92, v101
  s_waitcnt lgkmcnt(3)
  v_mfma_f32_32x32x16_bf16 v[60:75], v[196:199], v[32:35], v[60:75]
  ds_read_b128 v[28:31], v8 offset:57344
  ds_read_b64_tr_b16 v[120:121], v19 offset:18432
  v_fmac_f32 v253, v0, v255
  v_fma_f32 v106, -v93, v101, v106
  v_fmac_f32 v107, v93, v100
  v_fma_f32 v252, -v1, v255, v252
  v_fmac_f32 v253, v1, v254
  ds_read_b64 v[254:255], v16 offset:9216
  v_fmac_f32 v42, v0, v252
  v_fmac_f32 v43, v0, v253
  s_waitcnt lgkmcnt(4)
  v_mfma_f32_32x32x16_bf16 v[60:75], v[200:203], v[36:39], v[60:75]
  ds_read_b128 v[32:35], v9 offset:57344
  ds_read_b64_tr_b16 v[122:123], v19 offset:18688
  v_fma_f32 v42, -v1, v253, v42
  v_fmac_f32 v43, v1, v252
  v_fmac_f32 v40, v0, v42
  v_fmac_f32 v41, v0, v43
  v_fma_f32 v40, -v1, v43, v40
  v_fmac_f32 v41, v1, v42
  ds_read_b64 v[0:1], v15 offset:8192
  s_waitcnt lgkmcnt(5)
  v_mfma_f32_32x32x16_bf16 v[60:75], v[204:207], v[28:31], v[60:75]
  v_mfma_f32_16x16x32_bf16 v[20:23], v[24:27], v[28:31], v[20:23]
  ds_read_b128 v[36:39], v10 offset:57344
  ds_read_b64_tr_b16 v[136:137], v19 offset:19456
  v_mul_f32 v42, v4, v40
  v_mul_f32 v43, v4, v41
  v_fma_f32 v42, -v5, v41, v42
  v_fmac_f32 v43, v5, v40
  s_nop 1
  v_permlane32_swap_b32 v42, v43
  v_add_f32 v42, v42, v43
  v_mov_b32 v43, v42
  s_nop 1
  v_permlane16_swap_b32 v42, v43
  s_waitcnt lgkmcnt(4)
  v_mfma_f32_32x32x16_bf16 v[60:75], v[208:211], v[32:35], v[60:75]
  ds_read_b128 v[28:31], v11 offset:57344
  s_waitcnt lgkmcnt(1)
  s_barrier
  v_add_f32 v42, v42, v43
  v_mov_b32 v43, v42
  s_nop 1
  v_permlane32_swap_b32 v42, v43
  v_mfma_f32_32x32x16_bf16 v[60:75], v[212:215], v[36:39], v[60:75]
  v_add_u32 v8, 0x10000, v8
  v_add_u32 v9, 0x10000, v9
  v_add_u32 v10, 0x10000, v10
  v_add_u32 v11, 0x10000, v11
  ds_read_b128 v[32:35], v8 offset:0
  ds_read_b64_tr_b16 v[138:139], v19 offset:19712
  v_xor_b32 v2, 0x80000000, v1
  v_fmac_f32 v104, v254, v42
  v_fmac_f32 v105, v254, v43
  v_fma_f32 v104, -v255, v43, v104
  v_fmac_f32 v105, v255, v42
  v_fmac_f32 v76, v0, v104
  v_fmac_f32 v84, v0, v105
  s_waitcnt lgkmcnt(2)
  v_mfma_f32_32x32x16_bf16 v[60:75], v[216:219], v[28:31], v[60:75]
  ds_read_b128 v[36:39], v9 offset:0
  v_fmac_f32 v76, v2, v105
  v_fmac_f32 v84, v1, v104
  v_fmac_f32 v77, v0, v76
  v_fmac_f32 v85, v0, v84
  v_fmac_f32 v77, v2, v84
  v_fmac_f32 v85, v1, v76
  v_cvt_pk_bf16_f32 v40, v76, v77
  v_cvt_pk_bf16_f32 v252, -v84, -v85
  s_waitcnt lgkmcnt(2)
  v_mfma_f32_32x32x16_bf16 v[60:75], v[220:223], v[32:35], v[60:75]
  v_mfma_f32_16x16x32_bf16 v[20:23], v[24:27], v[32:35], v[20:23]
  ds_read_b128 v[28:31], v10 offset:0
  v_fmac_f32 v78, v0, v77
  v_fmac_f32 v86, v0, v85
  v_fmac_f32 v78, v2, v85
  v_fmac_f32 v86, v1, v77
  v_fmac_f32 v79, v0, v78
  v_fmac_f32 v87, v0, v86
  v_fmac_f32 v79, v2, v86
  s_waitcnt lgkmcnt(1)
  v_mfma_f32_32x32x16_bf16 v[60:75], v[224:227], v[36:39], v[60:75]
  ds_read_b128 v[32:35], v11 offset:0
  v_fmac_f32 v87, v1, v78
  v_cvt_pk_bf16_f32 v41, v78, v79
  v_cvt_pk_bf16_f32 v253, -v86, -v87
  v_fmac_f32 v80, v0, v79
  v_fmac_f32 v88, v0, v87
  v_fmac_f32 v80, v2, v87
  v_fmac_f32 v88, v1, v79
  v_fmac_f32 v81, v0, v80
  s_waitcnt lgkmcnt(1)
  v_mfma_f32_32x32x16_bf16 v[60:75], v[228:231], v[28:31], v[60:75]
  ds_read_b128 v[36:39], v8 offset:8192
  v_fmac_f32 v89, v0, v88
  v_fmac_f32 v81, v2, v88
  v_fmac_f32 v89, v1, v80
  v_cvt_pk_bf16_f32 v42, v80, v81
  v_cvt_pk_bf16_f32 v254, -v88, -v89
  v_fmac_f32 v82, v0, v81
  v_fmac_f32 v90, v0, v89
  s_waitcnt lgkmcnt(1)
  v_mfma_f32_32x32x16_bf16 v[60:75], v[232:235], v[32:35], v[60:75]
  ds_read_b128 v[28:31], v9 offset:8192
  v_fmac_f32 v82, v2, v89
  v_fmac_f32 v90, v1, v81
  v_fmac_f32 v83, v0, v82
  v_fmac_f32 v91, v0, v90
  v_fmac_f32 v83, v2, v90
  v_fmac_f32 v91, v1, v82
  v_cvt_pk_bf16_f32 v43, v82, v83
  v_cvt_pk_bf16_f32 v255, -v90, -v91
  s_waitcnt lgkmcnt(1)
  v_mfma_f32_32x32x16_bf16 v[60:75], v[236:239], v[36:39], v[60:75]
  v_mfma_f32_16x16x32_bf16 v[20:23], v[24:27], v[36:39], v[20:23]
  ds_read_b128 v[32:35], v10 offset:8192
  ds_write_b128 v18, v[40:43] offset:0
  ds_write_b128 v18, v[252:255] offset:1024
  ds_read_b64 v[0:1], v15 offset:6144
  ds_read_b64 v[40:41], v16 offset:6144
  ds_read_b64 v[42:43], v17 offset:7168
  s_waitcnt lgkmcnt(6)
  v_mfma_f32_32x32x16_bf16 v[60:75], v[240:243], v[28:31], v[60:75]
  ds_read_b128 v[36:39], v11 offset:8192
  ds_write_b32 v13, v20
  s_waitcnt lgkmcnt(0)
  s_barrier
  v_mul_f32 v4, v40, v42
  ds_read_b64 v[100:101], v7
  ds_read_b128 v[92:95], v14
  ds_read_b128 v[96:99], v14 offset:16
  v_mul_f32 v5, v40, v43
  v_mfma_f32_32x32x16_bf16 v[60:75], v[244:247], v[32:35], v[60:75]
  s_lshl_b32 s40, s38, 5
  v_xor_b32 v8, s40, v8
  v_xor_b32 v9, s40, v9
  v_xor_b32 v10, s40, v10
  v_xor_b32 v11, s40, v11
  ds_read_b128 v[28:31], v8 offset:16384
  v_fma_f32 v4, -v41, v43, v4
  s_waitcnt lgkmcnt(3)
  v_add_f32 v100, v100, v101
  v_cvt_pk_bf16_f32 v101, v100, v100
  v_lshlrev_b32 v101, 16, v101
  v_sub_f32 v102, v100, v101
  v_cvt_pk_bf16_f32 v100, v101, v102
  v_mov_b32 v101, 0
  v_fmac_f32 v5, v41, v42
  v_mfma_f32_32x32x16_bf16 v[60:75], v[248:251], v[36:39], v[60:75]
  ds_read_b128 v[32:35], v9 offset:16384
  s_add_u32 m0, s36, 40960
  s_mov_b32 s47, 442368
  buffer_load_dwordx4 v6, s[16:19], s47 offen lds
  s_add_u32 m0, s36, 49152
  s_mov_b32 s40, 442368
  buffer_load_dwordx4 v6, s[20:23], s40 offen lds
  v_mfma_f32_32x32x8_bf16 v[60:75], v[12:13], v[100:101], v[60:75]
  ds_read_b64 v[102:103], v15 offset:0
  s_waitcnt lgkmcnt(2)
  v_mfma_f32_32x32x16_bf16 v[140:155], v[28:31], v[108:111], 0
  ds_read_b128 v[36:39], v10 offset:16384
  s_add_u32 m0, s36, 57344
  s_mov_b32 s41, 516096
  buffer_load_dwordx4 v6, s[16:19], s41 offen lds
  ds_read_b64_tr_b16 v[236:237], v19 offset:0
  s_nop 3
  v_permlane16_swap_b32 v60, v68
  v_permlane16_swap_b32 v61, v69
  v_permlane16_swap_b32 v62, v70
  v_permlane16_swap_b32 v63, v71
  v_permlane16_swap_b32 v64, v72
  v_permlane16_swap_b32 v65, v73
  v_permlane16_swap_b32 v66, v74
  s_waitcnt lgkmcnt(3)
  v_mfma_f32_32x32x16_bf16 v[140:155], v[32:35], v[112:115], v[140:155]
  ds_read_b128 v[28:31], v11 offset:16384
  s_add_u32 m0, s36, 65536
  s_mov_b32 s42, 516096
  buffer_load_dwordx4 v6, s[20:23], s42 offen lds
  ds_read_b64_tr_b16 v[238:239], v19 offset:256
  v_permlane16_swap_b32 v67, v75
  v_mul_f32 v60, v92, v60
  v_mul_f32 v68, v92, v68
  v_mul_f32 v61, v93, v61
  v_mul_f32 v69, v93, v69
  s_waitcnt lgkmcnt(3)
  v_mfma_f32_32x32x16_bf16 v[140:155], v[36:39], v[116:119], v[140:155]
  ds_read_b128 v[32:35], v8 offset:24576
  ds_read_b64_tr_b16 v[244:245], v19 offset:1024
  v_mul_f32 v62, v94, v62
  v_mul_f32 v70, v94, v70
  v_mul_f32 v63, v95, v63
  v_mul_f32 v71, v95, v71
  v_mul_f32 v64, v96, v64
  v_mul_f32 v72, v96, v72
  v_mul_f32 v65, v97, v65
  v_mul_f32 v73, v97, v73
  s_waitcnt lgkmcnt(3)
  v_mfma_f32_32x32x16_bf16 v[140:155], v[28:31], v[120:123], v[140:155]
  ds_read_b128 v[36:39], v9 offset:24576
  ds_read_b64_tr_b16 v[246:247], v19 offset:1280
  v_mul_f32 v66, v98, v66
  v_mul_f32 v74, v98, v74
  v_mul_f32 v67, v99, v67
  v_mul_f32 v75, v99, v75
  ds_read_b64 v[96:97], v15 offset:1280
  ds_read_b64 v[98:99], v15 offset:1536
  ds_read_b64 v[100:101], v16 offset:512
  s_waitcnt lgkmcnt(6)
  v_mfma_f32_32x32x16_bf16 v[140:155], v[32:35], v[124:127], v[140:155]
  ds_read_b128 v[28:31], v10 offset:24576
  ds_read_b64_tr_b16 v[240:241], v19 offset:2048
  v_fma_f32 v94, v102, v60, v61
  v_fma_f32 v95, v102, v68, v69
  v_fma_f32 v94, -v103, v68, v94
  v_fmac_f32 v95, v103, v60
  v_fma_f32 v92, v102, v94, v62
  v_fma_f32 v93, v102, v95, v70
  v_fma_f32 v92, -v103, v95, v92
  v_fmac_f32 v93, v103, v94
  s_waitcnt lgkmcnt(6)
  v_mfma_f32_32x32x16_bf16 v[140:155], v[36:39], v[128:131], v[140:155]
  ds_read_b128 v[32:35], v11 offset:24576
  ds_read_b64_tr_b16 v[242:243], v19 offset:2304
  v_fma_f32 v94, v102, v92, v63
  v_fma_f32 v95, v102, v93, v71
  v_fma_f32 v94, -v103, v93, v94
  v_fmac_f32 v95, v103, v92
  v_fma_f32 v92, v102, v94, v64
  v_fma_f32 v93, v102, v95, v72
  v_fma_f32 v92, -v103, v95, v92
  s_waitcnt lgkmcnt(3)
  v_mfma_f32_32x32x16_bf16 v[140:155], v[28:31], v[132:135], v[140:155]
  ds_read_b128 v[36:39], v8 offset:32768
  ds_read_b64_tr_b16 v[248:249], v19 offset:3072
  v_fmac_f32 v93, v103, v94
  v_fma_f32 v94, v102, v92, v65
  v_fma_f32 v95, v102, v93, v73
  v_fma_f32 v94, -v103, v93, v94
  v_fmac_f32 v95, v103, v92
  v_fma_f32 v92, v102, v94, v66
  v_fma_f32 v93, v102, v95, v74
  v_fma_f32 v92, -v103, v95, v92
  s_waitcnt lgkmcnt(3)
  v_mfma_f32_32x32x16_bf16 v[140:155], v[32:35], v[136:139], v[140:155]
  ds_read_b128 v[28:31], v9 offset:32768
  ds_read_b64_tr_b16 v[250:251], v19 offset:3328
  v_fmac_f32 v93, v103, v94
  v_fma_f32 v94, v102, v92, v67
  v_fma_f32 v95, v102, v93, v75
  v_fma_f32 v94, -v103, v93, v94
  v_fmac_f32 v95, v103, v92
  v_mov_b32 v92, v94
  v_mov_b32 v93, v95
  s_waitcnt lgkmcnt(3)
  v_mfma_f32_32x32x16_bf16 v[156:171], v[36:39], v[108:111], 0
  ds_read_b128 v[32:35], v10 offset:32768
  v_permlane32_swap_b32 v94, v92
  v_permlane32_swap_b32 v95, v93
  v_fmac_f32 v92, v96, v94
  v_fmac_f32 v93, v96, v95
  v_fma_f32 v92, -v97, v95, v92
  v_fmac_f32 v93, v97, v94
  v_cndmask_b32 v104, 0, v94, s[90:91]
  v_cndmask_b32 v105, 0, v95, s[90:91]
  s_waitcnt lgkmcnt(2)
  v_mfma_f32_32x32x16_bf16 v[156:171], v[28:31], v[112:115], v[156:171]
  ds_read_b128 v[36:39], v11 offset:32768
  s_waitcnt lgkmcnt(2)
  s_waitcnt vmcnt(8)
  s_barrier
  buffer_load_dwordx2 v[254:255], v16, s[32:35], 0 offen offset:3072 sc1
  buffer_load_dwordx2 v[252:253], v16, s[32:35], 0 offen offset:2048 sc1
  buffer_load_dwordx2 v[42:43], v16, s[32:35], 0 offen offset:1024 sc1
  buffer_load_dwordx2 v[40:41], v16, s[32:35], 0 offen offset:0 sc1
  v_mov_b32 v94, v92
  v_mov_b32 v95, v93
  s_waitcnt lgkmcnt(1)
  v_mfma_f32_32x32x16_bf16 v[156:171], v[32:35], v[116:119], v[156:171]
  v_add_u32 v8, 0xffff0000, v8
  v_add_u32 v9, 0xffff0000, v9
  v_add_u32 v10, 0xffff0000, v10
  v_add_u32 v11, 0xffff0000, v11
  ds_read_b128 v[28:31], v8 offset:0
  v_mul_f32 v2, v1, v44
  v_permlane16_swap_b32 v92, v94
  v_permlane16_swap_b32 v93, v95
  v_fmac_f32 v94, v98, v92
  v_fmac_f32 v95, v98, v93
  v_fma_f32 v94, -v99, v93, v94
  v_fmac_f32 v95, v99, v92
  s_waitcnt lgkmcnt(1)
  v_mfma_f32_32x32x16_bf16 v[156:171], v[36:39], v[120:123], v[156:171]
  ds_read_b128 v[32:35], v9 offset:0
  v_mul_f32 v44, v0, v44
  s_mov_b64 exec, 0xffff
  ds_write_b64 v17, v[94:95] offset:22272
  s_mov_b64 exec, -1
  v_fmac_f32 v104, v100, v92
  v_fmac_f32 v105, v100, v93
  v_fma_f32 v104, -v101, v93, v104
  v_fmac_f32 v105, v101, v92
  ds_read_b64 v[102:103], v15 offset:3328
  ds_read_b64 v[92:93], v16 offset:1024
  s_waitcnt lgkmcnt(4)
  v_mfma_f32_32x32x16_bf16 v[156:171], v[28:31], v[124:127], v[156:171]
  ds_read_b128 v[36:39], v10 offset:0
  v_fma_f32 v44, -v1, v52, v44
  v_fma_f32 v52, v0, v52, v2
  v_mul_f32 v2, v1, v45
  v_mul_f32 v45, v0, v45
  v_fma_f32 v45, -v1, v53, v45
  v_fma_f32 v53, v0, v53, v2
  v_mul_f32 v2, v1, v46
  s_waitcnt lgkmcnt(4)
  v_mfma_f32_32x32x16_bf16 v[156:171], v[32:35], v[128:131], v[156:171]
  ds_read_b128 v[28:31], v11 offset:0
  v_mul_f32 v46, v0, v46
  v_fma_f32 v46, -v1, v54, v46
  v_fma_f32 v54, v0, v54, v2
  v_mul_f32 v2, v1, v47
  v_mul_f32 v47, v0, v47
  v_fma_f32 v47, -v1, v55, v47
  v_fma_f32 v55, v0, v55, v2
  v_mul_f32 v2, v1, v48
  s_waitcnt lgkmcnt(1)
  v_mfma_f32_32x32x16_bf16 v[156:171], v[36:39], v[132:135], v[156:171]
  ds_read_b128 v[32:35], v8 offset:8192
  s_add_u32 m0, s36, 73728
  s_mov_b32 s43, 128
  buffer_load_dwordx4 v6, s[16:19], s43 offen lds
  v_mul_f32 v48, v0, v48
  v_fma_f32 v48, -v1, v56, v48
  v_fma_f32 v56, v0, v56, v2
  v_mul_f32 v2, v1, v49
  v_mul_f32 v49, v0, v49
  s_waitcnt lgkmcnt(1)
  v_mfma_f32_32x32x16_bf16 v[156:171], v[28:31], v[136:139], v[156:171]
  ds_read_b128 v[36:39], v9 offset:8192
  s_add_u32 m0, s36, 81920
  s_mov_b32 s44, 128
  buffer_load_dwordx4 v6, s[20:23], s44 offen lds
  v_fma_f32 v49, -v1, v57, v49
  v_fma_f32 v57, v0, v57, v2
  v_mul_f32 v2, v1, v50
  v_mul_f32 v50, v0, v50
  v_fma_f32 v50, -v1, v58, v50
  s_waitcnt lgkmcnt(1)
  v_mfma_f32_32x32x16_bf16 v[172:187], v[32:35], v[108:111], 0
  ds_read_b128 v[28:31], v10 offset:8192
  s_add_u32 m0, s36, 90112
  s_mov_b32 s45, 73856
  buffer_load_dwordx4 v6, s[16:19], s45 offen lds
  v_fma_f32 v58, v0, v58, v2
  v_mul_f32 v2, v1, v51
  v_mul_f32 v51, v0, v51
  v_fma_f32 v51, -v1, v59, v51
  v_fma_f32 v59, v0, v59, v2
  v_mul_f32 v2, v1, v106
  s_waitcnt lgkmcnt(1)
  v_mfma_f32_32x32x16_bf16 v[172:187], v[36:39], v[112:115], v[172:187]
  ds_read_b128 v[32:35], v11 offset:8192
  s_waitcnt vmcnt(13)
  s_barrier
  v_mul_f32 v106, v0, v106
  ds_read_b64 v[96:97], v17 offset:21504
  ds_read_b64 v[98:99], v17 offset:21760
  s_waitcnt lgkmcnt(3)
  v_mfma_f32_32x32x16_bf16 v[172:187], v[28:31], v[116:119], v[172:187]
  ds_read_b128 v[36:39], v8 offset:16384
  s_add_u32 m0, s36, 98304
  s_mov_b32 s46, 73856
  buffer_load_dwordx4 v6, s[20:23], s46 offen lds
  v_fma_f32 v106, -v1, v107, v106
  ds_read_b64 v[100:101], v17 offset:22016
  v_fma_f32 v107, v0, v107, v2
  ds_read_b64 v[0:1], v15 offset:4352
  s_waitcnt vmcnt(4)
  v_max3_u32 v2, v40, v42, v252
  s_waitcnt lgkmcnt(5)
  v_mfma_f32_32x32x16_bf16 v[172:187], v[32:35], v[120:123], v[172:187]
  ds_read_b128 v[28:31], v9 offset:16384
  s_add_u32 m0, s36, 0
  s_mov_b32 s47, 221312
  buffer_load_dwordx4 v6, s[16:19], s47 offen lds
  v_max_u32 v2, v2, v254
  s_waitcnt lgkmcnt(4)
  v_fmac_f32 v98, v102, v96
  v_fmac_f32 v99, v102, v97
  v_fma_f32 v98, -v103, v97, v98
  v_fmac_f32 v99, v103, v96
  s_waitcnt lgkmcnt(3)
  v_mfma_f32_32x32x16_bf16 v[172:187], v[36:39], v[124:127], v[172:187]
  ds_read_b128 v[32:35], v10 offset:16384
  v_cmp_eq_u32 vcc, -1, v2
  s_waitcnt lgkmcnt(3)
  v_fmac_f32 v100, v102, v98
  v_fmac_f32 v101, v102, v99
  v_fma_f32 v100, -v103, v99, v100
  v_fmac_f32 v101, v103, v98
  v_fmac_f32 v94, v102, v100
  v_fmac_f32 v95, v102, v101
  v_fma_f32 v94, -v103, v101, v94
  s_waitcnt lgkmcnt(1)
  v_mfma_f32_32x32x16_bf16 v[172:187], v[28:31], v[128:131], v[172:187]
  ds_read_b128 v[36:39], v11 offset:16384
  s_nop 1
  s_cbranch_vccnz SPIN_p3
BACK_p3:
  v_fmac_f32 v95, v103, v100
  v_min_u32 v94, -2, v94
  buffer_store_dwordx2 v[94:95], v16, s[28:31], 0 offen sc1
  s_add_u32 s28, s28, 4096
  s_addc_u32 s29, s29, 0
  v_fmac_f32 v104, v92, v100
  v_fmac_f32 v105, v92, v101
  s_waitcnt lgkmcnt(1)
  v_mfma_f32_32x32x16_bf16 v[172:187], v[32:35], v[132:135], v[172:187]
  ds_read_b128 v[28:31], v8 offset:24576
  s_add_u32 s32, s32, 4096
  s_addc_u32 s33, s33, 0
  v_fma_f32 v104, -v93, v101, v104
  v_fmac_f32 v105, v93, v100
  v_mbcnt_lo_u32_b32 v92, -1, 0
  v_mbcnt_hi_u32_b32 v92, -1, v92
  s_mul_i32 s83, s4, 12288
  v_and_b32 v93, 15, v92
  v_lshl_add_u32 v7, v93, 4, s83
  s_waitcnt lgkmcnt(1)
  v_mfma_f32_32x32x16_bf16 v[172:187], v[36:39], v[136:139], v[172:187]
  ds_read_b128 v[32:35], v9 offset:24576
  v_fmac_f32 v252, v0, v254
  v_lshrrev_b32 v93, 5, v92
  v_lshl_add_u32 v7, v93, 8, v7
  v_and_b32 v93, 16, v92
  v_mul_u32_u24 v93, 0xc00, v93
  v_add_u32 v7, v7, v93
  v_and_b32 v93, 31, v92
  s_waitcnt lgkmcnt(1)
  v_mfma_f32_32x32x16_bf16 v[188:203], v[28:31], v[108:111], 0
  ds_read_b128 v[36:39], v10 offset:24576
  v_fmac_f32 v253, v0, v255
  s_lshl_b32 s83, s5, 10
  v_lshl_add_u32 v93, v93, 5, s83
  v_lshrrev_b32 v94, 5, v92
  v_lshl_add_u32 v12, v94, 4, v93
  s_and_b32 s83, s3, 1
  s_lshl_b32 s83, s83, 5
  v_lshrrev_b32 v93, 1, v92
  s_waitcnt lgkmcnt(1)
  v_mfma_f32_32x32x16_bf16 v[188:203], v[32:35], v[112:115], v[188:203]
  ds_read_b128 v[28:31], v11 offset:24576
  s_barrier
  v_fma_f32 v252, -v1, v255, v252
  v_add_u32 v93, s83, v93
  v_mul_u32_u24 v93, 0x480, v93
  s_waitcnt lgkmcnt(1)
  v_mfma_f32_32x32x16_bf16 v[188:203], v[36:39], v[116:119], v[188:203]
  ds_read_b128 v[32:35], v8 offset:32768
  s_add_u32 m0, s36, 8192
  s_mov_b32 s40, 221312
  buffer_load_dwordx4 v6, s[20:23], s40 offen lds
  v_fmac_f32 v253, v1, v254
  v_and_b32 v94, 1, v92
  v_lshl_add_u32 v13, v94, 4, v93
  s_lshl4_add_u32 s40, s6, s7
  s_lshl_b32 s40, s40, 7
  s_add_u32 s40, s40, 37945344
  s_cmp_eq_u32 s3, 0
  s_cselect_b32 s41, 4, 0
  s_add_u32 s8, s80, s40
  s_addc_u32 s9, s81, 0
  s_mov_b32 s10, s41
  s_mov_b32 s11, 0x00020000
  v_mov_b32 v92, -1
  s_waitcnt lgkmcnt(1)
  v_mfma_f32_32x32x16_bf16 v[188:203], v[28:31], v[120:123], v[188:203]
  ds_read_b128 v[36:39], v9 offset:32768
  s_add_u32 m0, s36, 16384
  s_mov_b32 s41, 295040
  buffer_load_dwordx4 v6, s[16:19], s41 offen lds
  ds_read_b64 v[254:255], v16 offset:5120
  v_mov_b32 v93, -1
  v_mov_b32 v94, -1
  v_mov_b32 v95, -1
  s_mul_i32 s42, s5, 98304
  s_add_u32 s42, s42, 0
  buffer_store_dwordx4 v[92:95], v7, s[24:27], s42 offen offset:0 sc1
  s_waitcnt lgkmcnt(2)
  v_mfma_f32_32x32x16_bf16 v[188:203], v[32:35], v[124:127], v[188:203]
  ds_read_b128 v[28:31], v10 offset:32768
  v_fmac_f32 v42, v0, v252
  v_fmac_f32 v43, v0, v253
  v_fma_f32 v42, -v1, v253, v42
  v_fmac_f32 v43, v1, v252
  v_fmac_f32 v40, v0, v42
  v_fmac_f32 v41, v0, v43
  v_fma_f32 v40, -v1, v43, v40
  v_fmac_f32 v41, v1, v42
  s_waitcnt lgkmcnt(2)
  v_mfma_f32_32x32x16_bf16 v[188:203], v[36:39], v[128:131], v[188:203]
  ds_read_b128 v[32:35], v11 offset:32768
  ds_read_b64 v[0:1], v15 offset:4096
  v_mul_f32 v42, v4, v40
  v_mul_f32 v43, v4, v41
  v_fma_f32 v42, -v5, v41, v42
  v_fmac_f32 v43, v5, v40
  s_nop 1
  v_permlane32_swap_b32 v42, v43
  v_add_f32 v42, v42, v43
  s_waitcnt lgkmcnt(2)
  v_mfma_f32_32x32x16_bf16 v[188:203], v[28:31], v[132:135], v[188:203]
  ds_read_b128 v[36:39], v8 offset:40960
  v_mov_b32 v43, v42
  s_mul_i32 s43, s5, 98304
  s_add_u32 s43, s43, 98304
  buffer_store_dwordx4 v[92:95], v7, s[24:27], s43 offen offset:0 sc1
  v_permlane16_swap_b32 v42, v43
  v_add_f32 v42, v42, v43
  v_mov_b32 v43, v42
  s_nop 1
  v_permlane32_swap_b32 v42, v43
  s_waitcnt lgkmcnt(1)
  v_xor_b32 v2, 0x80000000, v1
  v_fmac_f32 v106, v254, v42
  v_mfma_f32_32x32x16_bf16 v[188:203], v[32:35], v[136:139], v[188:203]
  ds_read_b128 v[28:31], v9 offset:40960
  v_fmac_f32 v107, v254, v43
  v_fma_f32 v106, -v255, v43, v106
  v_fmac_f32 v107, v255, v42
  v_fmac_f32 v44, v0, v106
  v_fmac_f32 v52, v0, v107
  v_fmac_f32 v44, v2, v107
  v_fmac_f32 v52, v1, v106
  s_waitcnt lgkmcnt(1)
  v_mfma_f32_32x32x16_bf16 v[204:219], v[36:39], v[108:111], 0
  ds_read_b128 v[32:35], v10 offset:40960
  v_fmac_f32 v45, v0, v44
  v_fmac_f32 v53, v0, v52
  v_fmac_f32 v45, v2, v52
  v_fmac_f32 v53, v1, v44
  v_cvt_pk_bf16_f32 v40, v44, v45
  v_cvt_pk_bf16_f32 v252, -v52, -v53
  v_fmac_f32 v46, v0, v45
  v_fmac_f32 v54, v0, v53
  s_waitcnt lgkmcnt(1)
  v_mfma_f32_32x32x16_bf16 v[204:219], v[28:31], v[112:115], v[204:219]
  ds_read_b128 v[36:39], v11 offset:40960
  s_barrier
  v_fmac_f32 v46, v2, v53
  s_mul_i32 s44, s5, 98304
  s_add_u32 s44, s44, 786432
  buffer_store_dwordx4 v[92:95], v7, s[24:27], s44 offen offset:0 sc1
  v_fmac_f32 v54, v1, v45
  s_waitcnt lgkmcnt(1)
  v_mfma_f32_32x32x16_bf16 v[204:219], v[32:35], v[116:119], v[204:219]
  ds_read_b128 v[28:31], v8 offset:49152
  v_fmac_f32 v47, v0, v46
  v_fmac_f32 v55, v0, v54
  v_fmac_f32 v47, v2, v54
  v_fmac_f32 v55, v1, v46
  v_cvt_pk_bf16_f32 v41, v46, v47
  v_cvt_pk_bf16_f32 v253, -v54, -v55
  v_fmac_f32 v48, v0, v47
  s_waitcnt lgkmcnt(1)
  v_mfma_f32_32x32x16_bf16 v[204:219], v[36:39], v[120:123], v[204:219]
  ds_read_b128 v[32:35], v9 offset:49152
  v_fmac_f32 v56, v0, v55
  v_fmac_f32 v48, v2, v55
  v_fmac_f32 v56, v1, v47
  v_fmac_f32 v49, v0, v48
  v_fmac_f32 v57, v0, v56
  v_fmac_f32 v49, v2, v56
  v_fmac_f32 v57, v1, v48
  v_cvt_pk_bf16_f32 v42, v48, v49
  s_waitcnt lgkmcnt(1)
  v_mfma_f32_32x32x16_bf16 v[204:219], v[28:31], v[124:127], v[204:219]
  ds_read_b128 v[36:39], v10 offset:49152
  v_cvt_pk_bf16_f32 v254, -v56, -v57
  s_mul_i32 s45, s5, 98304
  s_add_u32 s45, s45, 884736
  buffer_store_dwordx4 v[92:95], v7, s[24:27], s45 offen offset:0 sc1
  v_fmac_f32 v50, v0, v49
  v_fmac_f32 v58, v0, v57
  v_fmac_f32 v50, v2, v57
  v_fmac_f32 v58, v1, v49
  v_fmac_f32 v51, v0, v50
  s_waitcnt lgkmcnt(1)
  v_mfma_f32_32x32x16_bf16 v[204:219], v[32:35], v[128:131], v[204:219]
  ds_read_b128 v[28:31], v11 offset:49152
  v_fmac_f32 v59, v0, v58
  v_fmac_f32 v51, v2, v58
  v_fmac_f32 v59, v1, v50
  v_cvt_pk_bf16_f32 v43, v50, v51
  v_cvt_pk_bf16_f32 v255, -v58, -v59
  ds_write_b128 v18, v[40:43] offset:16384
  ds_write_b128 v18, v[252:255] offset:17408
  ds_read_b64 v[0:1], v15 offset:2048
  s_waitcnt lgkmcnt(4)
  v_mfma_f32_32x32x16_bf16 v[204:219], v[36:39], v[132:135], v[204:219]
  ds_read_b128 v[32:35], v8 offset:57344
  ds_read_b64 v[40:41], v16 offset:2048
  ds_read_b64 v[42:43], v17 offset:3072
  s_waitcnt lgkmcnt(6)
  v_mfma_f32_32x32x16_bf16 v[204:219], v[28:31], v[136:139], v[204:219]
  ds_read_b128 v[36:39], v9 offset:57344
  s_waitcnt lgkmcnt(1)
  v_mul_f32 v4, v40, v42
  s_mul_i32 s46, s5, 98304
  s_add_u32 s46, s46, 1572864
  buffer_store_dwordx4 v[92:95], v7, s[24:27], s46 offen offset:0 sc1
  v_mul_f32 v5, v40, v43
  v_fma_f32 v4, -v41, v43, v4
  v_fmac_f32 v5, v41, v42
  v_mfma_f32_32x32x16_bf16 v[220:235], v[32:35], v[108:111], 0
  ds_read_b128 v[28:31], v10 offset:57344
  s_add_u32 m0, s36, 24576
  s_mov_b32 s47, 295040
  buffer_load_dwordx4 v6, s[20:23], s47 offen lds
  s_waitcnt lgkmcnt(1)
  v_mfma_f32_32x32x16_bf16 v[220:235], v[36:39], v[112:115], v[220:235]
  ds_read_b128 v[32:35], v11 offset:57344
  s_add_u32 m0, s36, 32768
  s_mov_b32 s40, 442496
  buffer_load_dwordx4 v6, s[16:19], s40 offen lds
  s_waitcnt lgkmcnt(1)
  v_mfma_f32_32x32x16_bf16 v[220:235], v[28:31], v[116:119], v[220:235]
  v_add_u32 v8, 0x10000, v8
  v_add_u32 v9, 0x10000, v9
  v_add_u32 v10, 0x10000, v10
  v_add_u32 v11, 0x10000, v11
  ds_read_b128 v[36:39], v8 offset:0
  s_mul_i32 s41, s5, 98304
  s_add_u32 s41, s41, 1671168
  buffer_store_dwordx4 v[92:95], v7, s[24:27], s41 offen offset:0 sc1
  s_waitcnt lgkmcnt(1)
  v_mfma_f32_32x32x16_bf16 v[220:235], v[32:35], v[120:123], v[220:235]
  ds_read_b128 v[28:31], v9 offset:0
  s_waitcnt lgkmcnt(1)
  v_mfma_f32_32x32x16_bf16 v[220:235], v[36:39], v[124:127], v[220:235]
  ds_read_b128 v[32:35], v10 offset:0
  s_waitcnt lgkmcnt(1)
  v_mfma_f32_32x32x16_bf16 v[220:235], v[28:31], v[128:131], v[220:235]
  ds_read_b128 v[36:39], v11 offset:0
  s_waitcnt vmcnt(13)
  s_barrier
  s_waitcnt lgkmcnt(1)
  v_mfma_f32_32x32x16_bf16 v[220:235], v[32:35], v[132:135], v[220:235]
  ds_read_b128 v[28:31], v8 offset:8192
  s_add_u32 m0, s36, 40960
  s_mov_b32 s42, 442496
  buffer_load_dwordx4 v6, s[20:23], s42 offen lds
  ds_read_b64_tr_b16 v[76:77], v19 offset:16384
  s_waitcnt lgkmcnt(2)
  v_mfma_f32_32x32x16_bf16 v[220:235], v[36:39], v[136:139], v[220:235]
  ds_read_b128 v[32:35], v9 offset:8192
  s_add_u32 m0, s36, 49152
  s_mov_b32 s43, 516224
  buffer_load_dwordx4 v6, s[16:19], s43 offen lds
  ds_read_b64_tr_b16 v[78:79], v19 offset:16640
  ds_read_b64_tr_b16 v[84:85], v19 offset:17408
  ds_read_b64_tr_b16 v[86:87], v19 offset:17664
  ds_read_b64_tr_b16 v[80:81], v19 offset:18432
  ds_read_b64_tr_b16 v[82:83], v19 offset:18688
  ds_read_b64_tr_b16 v[88:89], v19 offset:19456
  ds_read_b64_tr_b16 v[90:91], v19 offset:19712
  s_waitcnt lgkmcnt(9)
  v_mfma_f32_32x32x16_bf16 v[140:155], v[28:31], v[236:239], v[140:155]
  ds_read_b128 v[36:39], v10 offset:8192
  s_add_u32 m0, s36, 57344
  s_mov_b32 s44, 516224
  buffer_load_dwordx4 v6, s[20:23], s44 offen lds
  s_waitcnt lgkmcnt(8)
  v_mfma_f32_32x32x16_bf16 v[140:155], v[32:35], v[240:243], v[140:155]
  ds_read_b128 v[28:31], v11 offset:8192
  s_waitcnt lgkmcnt(1)
  v_mfma_f32_32x32x16_bf16 v[140:155], v[36:39], v[76:79], v[140:155]
  ds_read_b128 v[32:35], v8 offset:16384
  s_waitcnt lgkmcnt(1)
  v_mfma_f32_32x32x16_bf16 v[140:155], v[28:31], v[80:83], v[140:155]
  ds_read_b128 v[36:39], v9 offset:16384
  s_waitcnt lgkmcnt(1)
  v_mfma_f32_32x32x16_bf16 v[140:155], v[32:35], v[244:247], v[140:155]
  ds_read_b128 v[28:31], v10 offset:16384
  s_waitcnt lgkmcnt(1)
  v_mfma_f32_32x32x16_bf16 v[140:155], v[36:39], v[248:251], v[140:155]
  ds_read_b128 v[32:35], v11 offset:16384
  s_waitcnt lgkmcnt(1)
  v_mfma_f32_32x32x16_bf16 v[140:155], v[28:31], v[84:87], v[140:155]
  ds_read_b128 v[36:39], v8 offset:24576
  s_waitcnt lgkmcnt(1)
  v_mfma_f32_32x32x16_bf16 v[140:155], v[32:35], v[88:91], v[140:155]
  ds_read_b128 v[28:31], v9 offset:24576
  buffer_load_dwordx2 v[254:255], v16, s[32:35], 0 offen offset:3072 sc1
  buffer_load_dwordx2 v[252:253], v16, s[32:35], 0 offen offset:2048 sc1
  buffer_load_dwordx2 v[42:43], v16, s[32:35], 0 offen offset:1024 sc1
  buffer_load_dwordx2 v[40:41], v16, s[32:35], 0 offen offset:0 sc1
  v_mul_f32 v2, v1, v60
  v_mul_f32 v60, v0, v60
  v_fma_f32 v60, -v1, v68, v60
  v_fma_f32 v68, v0, v68, v2
  v_mul_f32 v2, v1, v61
  v_mul_f32 v61, v0, v61
  v_fma_f32 v61, -v1, v69, v61
  v_fma_f32 v69, v0, v69, v2
  s_waitcnt lgkmcnt(1)
  v_mfma_f32_32x32x16_bf16 v[156:171], v[36:39], v[236:239], v[156:171]
  ds_read_b128 v[32:35], v10 offset:24576
  v_mul_f32 v2, v1, v62
  v_mul_f32 v62, v0, v62
  v_fma_f32 v62, -v1, v70, v62
  v_fma_f32 v70, v0, v70, v2
  v_mul_f32 v2, v1, v63
  v_mul_f32 v63, v0, v63
  v_fma_f32 v63, -v1, v71, v63
  s_waitcnt lgkmcnt(1)
  v_mfma_f32_32x32x16_bf16 v[156:171], v[28:31], v[240:243], v[156:171]
  ds_read_b128 v[36:39], v11 offset:24576
  s_waitcnt vmcnt(16)
  s_barrier
  v_fma_f32 v71, v0, v71, v2
  v_mul_f32 v2, v1, v64
  v_mul_f32 v64, v0, v64
  s_waitcnt lgkmcnt(1)
  v_mfma_f32_32x32x16_bf16 v[156:171], v[32:35], v[76:79], v[156:171]
  ds_read_b128 v[28:31], v8 offset:32768
  s_add_u32 m0, s36, 65536
  s_add_u32 s45, s86, 0
  buffer_load_dwordx4 v13, s[92:95], s45 offen lds
  v_fma_f32 v64, -v1, v72, v64
  v_fma_f32 v72, v0, v72, v2
  v_mul_f32 v2, v1, v65
  v_mul_f32 v65, v0, v65
  v_fma_f32 v65, -v1, v73, v65
  v_fma_f32 v73, v0, v73, v2
  s_waitcnt lgkmcnt(1)
  v_mfma_f32_32x32x16_bf16 v[156:171], v[36:39], v[80:83], v[156:171]
  ds_read_b128 v[32:35], v9 offset:32768
  s_add_u32 m0, s36, 73728
  s_add_u32 s46, s86, 221184
  buffer_load_dwordx4 v13, s[92:95], s46 offen lds
  v_mul_f32 v2, v1, v66
  v_mul_f32 v66, v0, v66
  v_fma_f32 v66, -v1, v74, v66
  v_fma_f32 v74, v0, v74, v2
  v_mul_f32 v2, v1, v67
  s_waitcnt lgkmcnt(1)
  v_mfma_f32_32x32x16_bf16 v[156:171], v[28:31], v[244:247], v[156:171]
  ds_read_b128 v[36:39], v10 offset:32768
  s_add_u32 m0, s36, 81920
  s_add_u32 s47, s86, 442368
  buffer_load_dwordx4 v13, s[92:95], s47 offen lds
  v_mul_f32 v67, v0, v67
  v_fma_f32 v67, -v1, v75, v67
  v_fma_f32 v75, v0, v75, v2
  v_mul_f32 v2, v1, v104
  v_mul_f32 v104, v0, v104
  s_waitcnt lgkmcnt(1)
  v_mfma_f32_32x32x16_bf16 v[156:171], v[32:35], v[248:251], v[156:171]
  ds_read_b128 v[28:31], v11 offset:32768
  v_fma_f32 v104, -v1, v105, v104
  v_fma_f32 v105, v0, v105, v2
  ds_read_b64 v[0:1], v15 offset:256
  s_waitcnt lgkmcnt(2)
  v_mfma_f32_32x32x16_bf16 v[156:171], v[36:39], v[84:87], v[156:171]
  v_add_u32 v8, 0xffff0000, v8
  v_add_u32 v9, 0xffff0000, v9
  v_add_u32 v10, 0xffff0000, v10
  v_add_u32 v11, 0xffff0000, v11
  ds_read_b128 v[32:35], v8 offset:0
  s_waitcnt lgkmcnt(2)
  v_mfma_f32_32x32x16_bf16 v[156:171], v[28:31], v[88:91], v[156:171]
  ds_read_b128 v[36:39], v9 offset:0
  s_waitcnt lgkmcnt(1)
  v_mfma_f32_32x32x16_bf16 v[172:187], v[32:35], v[236:239], v[172:187]
  ds_read_b128 v[28:31], v10 offset:0
  s_waitcnt vmcnt(3)
  v_max3_u32 v2, v40, v42, v252
  v_max_u32 v2, v2, v254
  v_cmp_eq_u32 vcc, -1, v2
  s_nop 1
  s_cbranch_vccnz SPIN_p4
BACK_p4:
  s_add_u32 s32, s32, 4096
  s_addc_u32 s33, s33, 0
  v_fmac_f32 v252, v0, v254
  v_fmac_f32 v253, v0, v255
  v_fma_f32 v252, -v1, v255, v252
  v_fmac_f32 v253, v1, v254
  s_waitcnt lgkmcnt(1)
  v_mfma_f32_32x32x16_bf16 v[172:187], v[36:39], v[240:243], v[172:187]
  ds_read_b128 v[32:35], v11 offset:0
  ds_read_b64 v[254:255], v16 offset:1024
  v_fmac_f32 v42, v0, v252
  v_fmac_f32 v43, v0, v253
  v_fma_f32 v42, -v1, v253, v42
  v_fmac_f32 v43, v1, v252
  v_fmac_f32 v40, v0, v42
  v_fmac_f32 v41, v0, v43
  s_waitcnt lgkmcnt(2)
  v_mfma_f32_32x32x16_bf16 v[172:187], v[28:31], v[76:79], v[172:187]
  ds_read_b128 v[36:39], v8 offset:8192
  v_fma_f32 v40, -v1, v43, v40
  v_fmac_f32 v41, v1, v42
  ds_read_b64 v[0:1], v15 offset:0
  v_mul_f32 v42, v4, v40
  v_mul_f32 v43, v4, v41
  v_fma_f32 v42, -v5, v41, v42
  v_fmac_f32 v43, v5, v40
  s_nop 1
  v_permlane32_swap_b32 v42, v43
  s_waitcnt lgkmcnt(3)
  v_mfma_f32_32x32x16_bf16 v[172:187], v[32:35], v[80:83], v[172:187]
  ds_read_b128 v[28:31], v9 offset:8192
  v_add_f32 v42, v42, v43
  v_mov_b32 v43, v42
  s_nop 1
  v_permlane16_swap_b32 v42, v43
  v_add_f32 v42, v42, v43
  v_mov_b32 v43, v42
  s_nop 1
  v_permlane32_swap_b32 v42, v43
  s_waitcnt lgkmcnt(1)
  v_xor_b32 v2, 0x80000000, v1
  v_mfma_f32_32x32x16_bf16 v[172:187], v[36:39], v[244:247], v[172:187]
  ds_read_b128 v[32:35], v10 offset:8192
  v_fmac_f32 v104, v254, v42
  v_fmac_f32 v105, v254, v43
  v_fma_f32 v104, -v255, v43, v104
  v_fmac_f32 v105, v255, v42
  v_fmac_f32 v60, v0, v104
  v_fmac_f32 v68, v0, v105
  v_fmac_f32 v60, v2, v105
  v_fmac_f32 v68, v1, v104
  s_waitcnt lgkmcnt(1)
  v_mfma_f32_32x32x16_bf16 v[172:187], v[28:31], v[248:251], v[172:187]
  ds_read_b128 v[36:39], v11 offset:8192
  s_barrier
  v_fmac_f32 v61, v0, v60
  v_fmac_f32 v69, v0, v68
  v_fmac_f32 v61, v2, v68
  s_waitcnt lgkmcnt(1)
  v_mfma_f32_32x32x16_bf16 v[172:187], v[32:35], v[84:87], v[172:187]
  ds_read_b128 v[28:31], v8 offset:16384
  v_fmac_f32 v69, v1, v60
  v_cvt_pk_bf16_f32 v40, v60, v61
  v_cvt_pk_bf16_f32 v252, -v68, -v69
  v_fmac_f32 v62, v0, v61
  v_fmac_f32 v70, v0, v69
  v_fmac_f32 v62, v2, v69
  v_fmac_f32 v70, v1, v61
  s_waitcnt lgkmcnt(1)
  v_mfma_f32_32x32x16_bf16 v[172:187], v[36:39], v[88:91], v[172:187]
  ds_read_b128 v[32:35], v9 offset:16384
  v_fmac_f32 v63, v0, v62
  v_fmac_f32 v71, v0, v70
  v_fmac_f32 v63, v2, v70
  v_fmac_f32 v71, v1, v62
  v_cvt_pk_bf16_f32 v41, v62, v63
  v_cvt_pk_bf16_f32 v253, -v70, -v71
  v_fmac_f32 v64, v0, v63
  v_fmac_f32 v72, v0, v71
  s_waitcnt lgkmcnt(1)
  v_mfma_f32_32x32x16_bf16 v[188:203], v[28:31], v[236:239], v[188:203]
  ds_read_b128 v[36:39], v10 offset:16384
  v_fmac_f32 v64, v2, v71
  v_fmac_f32 v72, v1, v63
  v_fmac_f32 v65, v0, v64
  v_fmac_f32 v73, v0, v72
  v_fmac_f32 v65, v2, v72
  v_fmac_f32 v73, v1, v64
  v_cvt_pk_bf16_f32 v42, v64, v65
  s_waitcnt lgkmcnt(1)
  v_mfma_f32_32x32x16_bf16 v[188:203], v[32:35], v[240:243], v[188:203]
  ds_read_b128 v[28:31], v11 offset:16384
  v_cvt_pk_bf16_f32 v254, -v72, -v73
  v_fmac_f32 v66, v0, v65
  v_fmac_f32 v74, v0, v73
  v_fmac_f32 v66, v2, v73
  v_fmac_f32 v74, v1, v65
  v_fmac_f32 v67, v0, v66
  v_fmac_f32 v75, v0, v74
  v_fmac_f32 v67, v2, v74
  s_waitcnt lgkmcnt(1)
  v_mfma_f32_32x32x16_bf16 v[188:203], v[36:39], v[76:79], v[188:203]
  ds_read_b128 v[32:35], v8 offset:24576
  v_fmac_f32 v75, v1, v66
  v_cvt_pk_bf16_f32 v43, v66, v67
  v_cvt_pk_bf16_f32 v255, -v74, -v75
  ds_write_b128 v18, v[40:43] offset:0
  ds_write_b128 v18, v[252:255] offset:1024
  s_waitcnt lgkmcnt(3)
  v_mfma_f32_32x32x16_bf16 v[188:203], v[28:31], v[80:83], v[188:203]
  ds_read_b128 v[36:39], v9 offset:24576
  s_waitcnt lgkmcnt(3)
  v_mfma_f32_32x32x16_bf16 v[188:203], v[32:35], v[244:247], v[188:203]
  ds_read_b128 v[28:31], v10 offset:24576
  s_add_u32 m0, s36, 90112
  s_mov_b32 s40, 147456
  buffer_load_dwordx4 v6, s[16:19], s40 offen lds
  s_waitcnt lgkmcnt(1)
  v_mfma_f32_32x32x16_bf16 v[188:203], v[36:39], v[248:251], v[188:203]
  ds_read_b128 v[32:35], v11 offset:24576
  s_add_u32 m0, s36, 98304
  s_mov_b32 s41, 147456
  buffer_load_dwordx4 v6, s[20:23], s41 offen lds
  s_waitcnt lgkmcnt(1)
  v_mfma_f32_32x32x16_bf16 v[188:203], v[28:31], v[84:87], v[188:203]
  ds_read_b128 v[36:39], v8 offset:32768
  s_add_u32 m0, s36, 0
  s_mov_b32 s42, 147584
  buffer_load_dwordx4 v6, s[16:19], s42 offen lds
  s_waitcnt lgkmcnt(1)
  v_mfma_f32_32x32x16_bf16 v[188:203], v[32:35], v[88:91], v[188:203]
  ds_read_b128 v[28:31], v9 offset:32768
  s_waitcnt lgkmcnt(1)
  v_mfma_f32_32x32x16_bf16 v[204:219], v[36:39], v[236:239], v[204:219]
  ds_read_b128 v[32:35], v10 offset:32768
  s_waitcnt lgkmcnt(1)
  v_mfma_f32_32x32x16_bf16 v[204:219], v[28:31], v[240:243], v[204:219]
  ds_read_b128 v[36:39], v11 offset:32768
  s_barrier
  s_waitcnt lgkmcnt(1)
  v_mfma_f32_32x32x16_bf16 v[204:219], v[32:35], v[76:79], v[204:219]
  ds_read_b128 v[28:31], v8 offset:40960
  s_add_u32 m0, s36, 8192
  s_mov_b32 s43, 147584
  buffer_load_dwordx4 v6, s[20:23], s43 offen lds
  ds_read_b64_tr_b16 v[20:21], v19 offset:0
  s_waitcnt lgkmcnt(2)
  v_mfma_f32_32x32x16_bf16 v[204:219], v[36:39], v[80:83], v[204:219]
  ds_read_b128 v[32:35], v9 offset:40960
  s_add_u32 m0, s36, 16384
  s_mov_b32 s44, 368640
  buffer_load_dwordx4 v6, s[16:19], s44 offen lds
  ds_read_b64_tr_b16 v[22:23], v19 offset:256
  s_waitcnt lgkmcnt(3)
  v_mfma_f32_32x32x16_bf16 v[204:219], v[28:31], v[244:247], v[204:219]
  ds_read_b128 v[36:39], v10 offset:40960
  s_add_u32 m0, s36, 24576
  s_mov_b32 s45, 368640
  buffer_load_dwordx4 v6, s[20:23], s45 offen lds
  ds_read_b64_tr_b16 v[24:25], v19 offset:1024
  s_waitcnt lgkmcnt(3)
  v_mfma_f32_32x32x16_bf16 v[204:219], v[32:35], v[248:251], v[204:219]
  ds_read_b128 v[28:31], v11 offset:40960
  ds_read_b64_tr_b16 v[26:27], v19 offset:1280
  s_waitcnt lgkmcnt(3)
  v_mfma_f32_32x32x16_bf16 v[204:219], v[36:39], v[84:87], v[204:219]
  ds_read_b128 v[32:35], v8 offset:49152
  s_waitcnt lgkmcnt(2)
  v_mfma_f32_32x32x16_bf16 v[204:219], v[28:31], v[88:91], v[204:219]
  ds_read_b128 v[36:39], v9 offset:49152
  s_waitcnt lgkmcnt(1)
  v_mfma_f32_32x32x16_bf16 v[220:235], v[32:35], v[236:239], v[220:235]
  ds_read_b128 v[28:31], v10 offset:49152
  s_waitcnt lgkmcnt(1)
  v_mfma_f32_32x32x16_bf16 v[220:235], v[36:39], v[240:243], v[220:235]
  ds_read_b128 v[32:35], v11 offset:49152
  s_waitcnt lgkmcnt(1)
  v_mfma_f32_32x32x16_bf16 v[220:235], v[28:31], v[76:79], v[220:235]
  ds_read_b128 v[36:39], v8 offset:57344
  s_waitcnt lgkmcnt(1)
  v_mfma_f32_32x32x16_bf16 v[220:235], v[32:35], v[80:83], v[220:235]
  ds_read_b128 v[28:31], v9 offset:57344
  s_waitcnt lgkmcnt(1)
  v_mfma_f32_32x32x16_bf16 v[220:235], v[36:39], v[244:247], v[220:235]
  ds_read_b128 v[32:35], v10 offset:57344
  s_waitcnt lgkmcnt(1)
  v_mfma_f32_32x32x16_bf16 v[220:235], v[28:31], v[248:251], v[220:235]
  ds_read_b128 v[36:39], v11 offset:57344
  s_waitcnt vmcnt(6)
  s_barrier
  s_waitcnt lgkmcnt(1)
  v_mfma_f32_32x32x16_bf16 v[220:235], v[32:35], v[84:87], v[220:235]
  v_add_u32 v12, 0x10000, v12
  ds_read_b128 v[28:31], v12 offset:0
  s_add_u32 m0, s36, 32768
  s_mov_b32 s46, 368768
  buffer_load_dwordx4 v6, s[16:19], s46 offen lds
  s_waitcnt lgkmcnt(1)
  v_mfma_f32_32x32x16_bf16 v[220:235], v[36:39], v[88:91], v[220:235]
  ds_read_b128 v[32:35], v12 offset:2048
  s_add_u32 m0, s36, 40960
  s_mov_b32 s47, 368768
  buffer_load_dwordx4 v6, s[20:23], s47 offen lds
  s_waitcnt lgkmcnt(1)
  v_mfma_f32_32x32x16_bf16 v[140:155], v[28:31], v[20:23], v[140:155]
  ds_read_b128 v[36:39], v12 offset:4096
  s_add_u32 m0, s36, 49152
  s_mul_i32 s40, s86, 3
  s_add_u32 s40, s40, 147456
  buffer_load_dwordx4 v13, s[92:95], s40 offen lds
  s_waitcnt lgkmcnt(1)
  v_mfma_f32_32x32x16_bf16 v[140:155], v[32:35], v[24:27], v[140:155]
  ds_read_b128 v[28:31], v12 offset:6144
  s_waitcnt lgkmcnt(1)
  v_mfma_f32_32x32x16_bf16 v[156:171], v[36:39], v[20:23], v[156:171]
  ds_read_b128 v[32:35], v12 offset:8192
  s_waitcnt lgkmcnt(1)
  v_mfma_f32_32x32x16_bf16 v[156:171], v[28:31], v[24:27], v[156:171]
  ds_read_b128 v[36:39], v12 offset:10240
  s_nop 4
  v_cvt_pk_bf16_f32 v92, v140, v141
  v_cvt_pk_bf16_f32 v93, v142, v143
  v_cvt_pk_bf16_f32 v94, v148, v149
  v_cvt_pk_bf16_f32 v95, v150, v151
  s_lshl_b32 s41, s82, 9
  s_add_u32 s41, s41, 8192
  buffer_store_dwordx4 v[92:95], v7, s[24:27], s41 offen offset:0 sc1
  s_waitcnt lgkmcnt(1)
  v_mfma_f32_32x32x16_bf16 v[172:187], v[32:35], v[20:23], v[172:187]
  ds_read_b128 v[28:31], v12 offset:12288
  s_waitcnt lgkmcnt(1)
  v_mfma_f32_32x32x16_bf16 v[172:187], v[36:39], v[24:27], v[172:187]
  ds_read_b128 v[32:35], v12 offset:14336
  s_waitcnt lgkmcnt(1)
  v_mfma_f32_32x32x16_bf16 v[188:203], v[28:31], v[20:23], v[188:203]
  ds_read_b128 v[36:39], v12 offset:16384
  v_cvt_pk_bf16_f32 v96, v144, v145
  v_cvt_pk_bf16_f32 v97, v146, v147
  v_cvt_pk_bf16_f32 v98, v152, v153
  v_cvt_pk_bf16_f32 v99, v154, v155
  s_lshl_b32 s42, s82, 9
  s_add_u32 s42, s42, 8192
  buffer_store_dwordx4 v[96:99], v7, s[24:27], s42 offen offset:512 sc1
  v_cvt_pk_bf16_f32 v100, v156, v157
  v_cvt_pk_bf16_f32 v101, v158, v159
  v_cvt_pk_bf16_f32 v102, v164, v165
  v_cvt_pk_bf16_f32 v103, v166, v167
  s_waitcnt lgkmcnt(1)
  v_mfma_f32_32x32x16_bf16 v[188:203], v[32:35], v[24:27], v[188:203]
  ds_read_b128 v[28:31], v12 offset:18432
  s_lshl_b32 s43, s82, 9
  s_add_u32 s43, s43, 204800
  buffer_store_dwordx4 v[100:103], v7, s[24:27], s43 offen offset:0 sc1
  s_waitcnt lgkmcnt(1)
  v_mfma_f32_32x32x16_bf16 v[204:219], v[36:39], v[20:23], v[204:219]
  ds_read_b128 v[32:35], v12 offset:20480
  s_waitcnt lgkmcnt(1)
  v_mfma_f32_32x32x16_bf16 v[204:219], v[28:31], v[24:27], v[204:219]
  ds_read_b128 v[36:39], v12 offset:22528
  s_waitcnt vmcnt(9)
  s_barrier
  s_waitcnt lgkmcnt(1)
  v_mfma_f32_32x32x16_bf16 v[220:235], v[32:35], v[20:23], v[220:235]
  v_add_u32 v8, 0x16000, v8
  v_add_u32 v9, 0x16000, v9
  v_add_u32 v10, 0x16000, v10
  v_add_u32 v11, 0x16000, v11
  ds_read_b128 v[28:31], v8 offset:0
  s_add_u32 m0, s36, 57344
  s_mov_b32 s44, 589824
  buffer_load_dwordx4 v6, s[16:19], s44 offen lds
  v_cvt_pk_bf16_f32 v104, v160, v161
  v_cvt_pk_bf16_f32 v105, v162, v163
  v_cvt_pk_bf16_f32 v106, v168, v169
  v_cvt_pk_bf16_f32 v107, v170, v171
  s_lshl_b32 s45, s82, 9
  s_add_u32 s45, s45, 204800
  buffer_store_dwordx4 v[104:107], v7, s[24:27], s45 offen offset:512 sc1
  v_cvt_pk_bf16_f32 v92, v172, v173
  v_cvt_pk_bf16_f32 v93, v174, v175
  v_cvt_pk_bf16_f32 v94, v180, v181
  v_cvt_pk_bf16_f32 v95, v182, v183
  s_waitcnt lgkmcnt(1)
  v_mfma_f32_32x32x16_bf16 v[220:235], v[36:39], v[24:27], v[220:235]
  ds_read_b128 v[32:35], v9 offset:0
  s_add_u32 m0, s36, 65536
  s_mov_b32 s46, 589824
  buffer_load_dwordx4 v6, s[20:23], s46 offen lds
  s_lshl_b32 s47, s82, 9
  s_add_u32 s47, s47, 794624
  buffer_store_dwordx4 v[92:95], v7, s[24:27], s47 offen offset:0 sc1
  s_waitcnt lgkmcnt(1)
  v_mfma_f32_32x32x16_bf16 v[44:59], v[28:31], v[108:111], 0
  ds_read_b128 v[36:39], v10 offset:0
  s_add_u32 m0, s36, 73728
  s_mov_b32 s40, 589952
  buffer_load_dwordx4 v6, s[16:19], s40 offen lds
  s_waitcnt lgkmcnt(1)
  v_mfma_f32_32x32x16_bf16 v[44:59], v[32:35], v[112:115], v[44:59]
  ds_read_b128 v[28:31], v11 offset:0
  s_waitcnt lgkmcnt(1)
  v_mfma_f32_32x32x16_bf16 v[44:59], v[36:39], v[116:119], v[44:59]
  ds_read_b128 v[32:35], v8 offset:8192
  v_cvt_pk_bf16_f32 v96, v176, v177
  v_cvt_pk_bf16_f32 v97, v178, v179
  v_cvt_pk_bf16_f32 v98, v184, v185
  v_cvt_pk_bf16_f32 v99, v186, v187
  s_lshl_b32 s41, s82, 9
  s_add_u32 s41, s41, 794624
  buffer_store_dwordx4 v[96:99], v7, s[24:27], s41 offen offset:512 sc1
  v_cvt_pk_bf16_f32 v100, v188, v189
  v_cvt_pk_bf16_f32 v101, v190, v191
  v_cvt_pk_bf16_f32 v102, v196, v197
  v_cvt_pk_bf16_f32 v103, v198, v199
  s_waitcnt lgkmcnt(1)
  v_mfma_f32_32x32x16_bf16 v[44:59], v[28:31], v[120:123], v[44:59]
  ds_read_b128 v[36:39], v9 offset:8192
  s_lshl_b32 s42, s82, 9
  s_add_u32 s42, s42, 991232
  buffer_store_dwordx4 v[100:103], v7, s[24:27], s42 offen offset:0 sc1
  s_waitcnt lgkmcnt(1)
  v_mfma_f32_32x32x16_bf16 v[44:59], v[32:35], v[124:127], v[44:59]
  ds_read_b128 v[28:31], v10 offset:8192
  s_waitcnt lgkmcnt(1)
  v_mfma_f32_32x32x16_bf16 v[44:59], v[36:39], v[128:131], v[44:59]
  ds_read_b128 v[32:35], v11 offset:8192
  s_waitcnt lgkmcnt(1)
  v_mfma_f32_32x32x16_bf16 v[44:59], v[28:31], v[132:135], v[44:59]
  v_add_u32 v8, 0xfffea000, v8
  v_add_u32 v9, 0xfffea000, v9
  v_add_u32 v10, 0xfffea000, v10
  v_add_u32 v11, 0xfffea000, v11
  ds_read_b128 v[36:39], v8 offset:0
  v_cvt_pk_bf16_f32 v104, v192, v193
  v_cvt_pk_bf16_f32 v105, v194, v195
  v_cvt_pk_bf16_f32 v106, v200, v201
  v_cvt_pk_bf16_f32 v107, v202, v203
  s_lshl_b32 s43, s82, 9
  s_add_u32 s43, s43, 991232
  buffer_store_dwordx4 v[104:107], v7, s[24:27], s43 offen offset:512 sc1
  v_cvt_pk_bf16_f32 v92, v204, v205
  v_cvt_pk_bf16_f32 v93, v206, v207
  v_cvt_pk_bf16_f32 v94, v212, v213
  v_cvt_pk_bf16_f32 v95, v214, v215
  s_waitcnt lgkmcnt(1)
  v_mfma_f32_32x32x16_bf16 v[44:59], v[32:35], v[136:139], v[44:59]
  ds_read_b128 v[28:31], v9 offset:0
  s_lshl_b32 s44, s82, 9
  s_add_u32 s44, s44, 1581056
  buffer_store_dwordx4 v[92:95], v7, s[24:27], s44 offen offset:0 sc1
  s_waitcnt lgkmcnt(1)
  v_mfma_f32_32x32x16_bf16 v[44:59], v[36:39], v[236:239], v[44:59]
  ds_read_b128 v[32:35], v10 offset:0
  s_waitcnt lgkmcnt(1)
  v_mfma_f32_32x32x16_bf16 v[44:59], v[28:31], v[240:243], v[44:59]
  ds_read_b128 v[36:39], v11 offset:0
  s_waitcnt vmcnt(15)
  s_barrier
  s_waitcnt lgkmcnt(1)
  v_mfma_f32_32x32x16_bf16 v[44:59], v[32:35], v[76:79], v[44:59]
  ds_read_b128 v[28:31], v8 offset:8192
  s_add_u32 m0, s36, 81920
  s_mov_b32 s45, 589952
  buffer_load_dwordx4 v6, s[20:23], s45 offen lds
  v_cvt_pk_bf16_f32 v96, v208, v209
  v_cvt_pk_bf16_f32 v97, v210, v211
  v_cvt_pk_bf16_f32 v98, v216, v217
  v_cvt_pk_bf16_f32 v99, v218, v219
  s_lshl_b32 s46, s82, 9
  s_add_u32 s46, s46, 1581056
  buffer_store_dwordx4 v[96:99], v7, s[24:27], s46 offen offset:512 sc1
  v_cvt_pk_bf16_f32 v100, v220, v221
  v_cvt_pk_bf16_f32 v101, v222, v223
  v_cvt_pk_bf16_f32 v102, v228, v229
  v_cvt_pk_bf16_f32 v103, v230, v231
  s_waitcnt lgkmcnt(1)
  v_mfma_f32_32x32x16_bf16 v[44:59], v[36:39], v[80:83], v[44:59]
  ds_read_b128 v[32:35], v9 offset:8192
  s_add_u32 m0, s36, 90112
  s_mov_b32 s47, 589824
  buffer_load_dwordx4 v13, s[92:95], s47 offen lds
  s_lshl_b32 s40, s82, 9
  s_add_u32 s40, s40, 1777664
  buffer_store_dwordx4 v[100:103], v7, s[24:27], s40 offen offset:0 sc1
  s_waitcnt lgkmcnt(1)
  v_mfma_f32_32x32x16_bf16 v[44:59], v[28:31], v[244:247], v[44:59]
  ds_read_b128 v[36:39], v10 offset:8192
  s_waitcnt lgkmcnt(1)
  v_mfma_f32_32x32x16_bf16 v[44:59], v[32:35], v[248:251], v[44:59]
  ds_read_b128 v[28:31], v11 offset:8192
  s_waitcnt lgkmcnt(1)
  v_mfma_f32_32x32x16_bf16 v[44:59], v[36:39], v[84:87], v[44:59]
  ds_read_b128 v[32:35], v8 offset:16384
  v_cvt_pk_bf16_f32 v104, v224, v225
  v_cvt_pk_bf16_f32 v105, v226, v227
  v_cvt_pk_bf16_f32 v106, v232, v233
  v_cvt_pk_bf16_f32 v107, v234, v235
  s_lshl_b32 s41, s82, 9
  s_add_u32 s41, s41, 1777664
  buffer_store_dwordx4 v[104:107], v7, s[24:27], s41 offen offset:512 sc1
  s_waitcnt lgkmcnt(1)
  v_mfma_f32_32x32x16_bf16 v[44:59], v[28:31], v[88:91], v[44:59]
  ds_read_b128 v[36:39], v9 offset:16384
  s_waitcnt lgkmcnt(1)
  v_mfma_f32_32x32x16_bf16 v[60:75], v[32:35], v[108:111], 0
  ds_read_b128 v[28:31], v10 offset:16384
  s_waitcnt lgkmcnt(1)
  v_mfma_f32_32x32x16_bf16 v[60:75], v[36:39], v[112:115], v[60:75]
  ds_read_b128 v[32:35], v11 offset:16384
  s_waitcnt lgkmcnt(1)
  v_mfma_f32_32x32x16_bf16 v[60:75], v[28:31], v[116:119], v[60:75]
  ds_read_b128 v[36:39], v8 offset:24576
  s_waitcnt lgkmcnt(1)
  v_mfma_f32_32x32x16_bf16 v[60:75], v[32:35], v[120:123], v[60:75]
  ds_read_b128 v[28:31], v9 offset:24576
  s_waitcnt lgkmcnt(1)
  v_mfma_f32_32x32x16_bf16 v[60:75], v[36:39], v[124:127], v[60:75]
  ds_read_b128 v[32:35], v10 offset:24576
  s_waitcnt lgkmcnt(1)
  v_mfma_f32_32x32x16_bf16 v[60:75], v[28:31], v[128:131], v[60:75]
  ds_read_b128 v[36:39], v11 offset:24576
  s_waitcnt vmcnt(17)
  s_barrier
  s_waitcnt lgkmcnt(1)
  v_mfma_f32_32x32x16_bf16 v[60:75], v[32:35], v[132:135], v[60:75]
  ds_read_b128 v[28:31], v8 offset:32768
  s_waitcnt lgkmcnt(1)
  v_mfma_f32_32x32x16_bf16 v[60:75], v[36:39], v[136:139], v[60:75]
  ds_read_b128 v[32:35], v9 offset:32768
  s_waitcnt lgkmcnt(1)
  v_mfma_f32_32x32x16_bf16 v[60:75], v[28:31], v[236:239], v[60:75]
  ds_read_b128 v[36:39], v10 offset:32768
  s_waitcnt lgkmcnt(1)
  v_mfma_f32_32x32x16_bf16 v[60:75], v[32:35], v[240:243], v[60:75]
  ds_read_b128 v[28:31], v11 offset:32768
  s_waitcnt lgkmcnt(1)
  v_mfma_f32_32x32x16_bf16 v[60:75], v[36:39], v[76:79], v[60:75]
  ds_read_b128 v[32:35], v8 offset:40960
  s_waitcnt lgkmcnt(1)
  v_mfma_f32_32x32x16_bf16 v[60:75], v[28:31], v[80:83], v[60:75]
  ds_read_b128 v[36:39], v9 offset:40960
  s_waitcnt lgkmcnt(1)
  v_mfma_f32_32x32x16_bf16 v[60:75], v[32:35], v[244:247], v[60:75]
  ds_read_b128 v[28:31], v10 offset:40960
  s_waitcnt lgkmcnt(1)
  v_mfma_f32_32x32x16_bf16 v[60:75], v[36:39], v[248:251], v[60:75]
  ds_read_b128 v[32:35], v11 offset:40960
  s_waitcnt lgkmcnt(1)
  v_mfma_f32_32x32x16_bf16 v[60:75], v[28:31], v[84:87], v[60:75]
  v_add_u32 v12, 0xffffc000, v12
  ds_read_b128 v[36:39], v12 offset:0
  s_waitcnt lgkmcnt(1)
  v_mfma_f32_32x32x16_bf16 v[60:75], v[32:35], v[88:91], v[60:75]
  ds_read_b128 v[28:31], v12 offset:2048
  s_waitcnt lgkmcnt(1)
  v_mfma_f32_32x32x16_bf16 v[44:59], v[36:39], v[20:23], v[44:59]
  ds_read_b128 v[32:35], v12 offset:4096
  s_waitcnt lgkmcnt(1)
  v_mfma_f32_32x32x16_bf16 v[44:59], v[28:31], v[24:27], v[44:59]
  ds_read_b128 v[36:39], v12 offset:6144
  s_waitcnt vmcnt(0)
  s_barrier
  v_mov_b32 v1, 6
  s_mov_b64 exec, 1
  buffer_store_dword v1, off, s[8:11], 0 sc1
  s_mov_b64 exec, -1
  s_waitcnt lgkmcnt(1)
  v_mfma_f32_32x32x16_bf16 v[60:75], v[32:35], v[20:23], v[60:75]
  ds_read_b128 v[28:31], v8 offset:57344
  s_waitcnt lgkmcnt(1)
  v_mfma_f32_32x32x16_bf16 v[60:75], v[36:39], v[24:27], v[60:75]
  ds_read_b128 v[32:35], v9 offset:57344
  v_cvt_pk_bf16_f32 v92, v44, v45
  v_cvt_pk_bf16_f32 v93, v46, v47
  v_cvt_pk_bf16_f32 v94, v48, v49
  v_cvt_pk_bf16_f32 v95, v50, v51
  s_mul_i32 s42, s5, 98304
  s_add_u32 s42, s42, 0
  buffer_store_dwordx4 v[92:95], v7, s[24:27], s42 offen offset:0 sc1
  s_waitcnt lgkmcnt(1)
  v_mfma_f32_32x32x16_bf16 v[140:155], v[28:31], v[108:111], 0
  ds_read_b128 v[36:39], v10 offset:57344
  s_waitcnt lgkmcnt(1)
  v_mfma_f32_32x32x16_bf16 v[140:155], v[32:35], v[112:115], v[140:155]
  ds_read_b128 v[28:31], v11 offset:57344
  s_waitcnt lgkmcnt(1)
  v_mfma_f32_32x32x16_bf16 v[140:155], v[36:39], v[116:119], v[140:155]
  v_add_u32 v8, 0x10000, v8
  v_add_u32 v9, 0x10000, v9
  v_add_u32 v10, 0x10000, v10
  v_add_u32 v11, 0x10000, v11
  ds_read_b128 v[32:35], v8 offset:0
  v_cvt_pk_bf16_f32 v96, v52, v53
  v_cvt_pk_bf16_f32 v97, v54, v55
  v_cvt_pk_bf16_f32 v98, v56, v57
  v_cvt_pk_bf16_f32 v99, v58, v59
  s_mul_i32 s43, s5, 98304
  s_add_u32 s43, s43, 98304
  buffer_store_dwordx4 v[96:99], v7, s[24:27], s43 offen offset:0 sc1
  v_cvt_pk_bf16_f32 v100, v60, v61
  v_cvt_pk_bf16_f32 v101, v62, v63
  v_cvt_pk_bf16_f32 v102, v64, v65
  v_cvt_pk_bf16_f32 v103, v66, v67
  s_waitcnt lgkmcnt(1)
  v_mfma_f32_32x32x16_bf16 v[140:155], v[28:31], v[120:123], v[140:155]
  ds_read_b128 v[36:39], v9 offset:0
  s_mul_i32 s44, s5, 98304
  s_add_u32 s44, s44, 786432
  buffer_store_dwordx4 v[100:103], v7, s[24:27], s44 offen offset:0 sc1
  s_waitcnt lgkmcnt(1)
  v_mfma_f32_32x32x16_bf16 v[140:155], v[32:35], v[124:127], v[140:155]
  ds_read_b128 v[28:31], v10 offset:0
  s_waitcnt lgkmcnt(1)
  v_mfma_f32_32x32x16_bf16 v[140:155], v[36:39], v[128:131], v[140:155]
  ds_read_b128 v[32:35], v11 offset:0
  s_waitcnt lgkmcnt(1)
  v_mfma_f32_32x32x16_bf16 v[140:155], v[28:31], v[132:135], v[140:155]
  ds_read_b128 v[36:39], v8 offset:8192
  v_cvt_pk_bf16_f32 v104, v68, v69
  v_cvt_pk_bf16_f32 v105, v70, v71
  v_cvt_pk_bf16_f32 v106, v72, v73
  v_cvt_pk_bf16_f32 v107, v74, v75
  s_mul_i32 s45, s5, 98304
  s_add_u32 s45, s45, 884736
  buffer_store_dwordx4 v[104:107], v7, s[24:27], s45 offen offset:0 sc1
  s_waitcnt lgkmcnt(1)
  v_mfma_f32_32x32x16_bf16 v[140:155], v[32:35], v[136:139], v[140:155]
  ds_read_b128 v[28:31], v9 offset:8192
  s_waitcnt lgkmcnt(1)
  v_mfma_f32_32x32x16_bf16 v[140:155], v[36:39], v[236:239], v[140:155]
  ds_read_b128 v[32:35], v10 offset:8192
  s_waitcnt lgkmcnt(1)
  v_mfma_f32_32x32x16_bf16 v[140:155], v[28:31], v[240:243], v[140:155]
  ds_read_b128 v[36:39], v11 offset:8192
  s_barrier
  s_waitcnt lgkmcnt(1)
  v_mfma_f32_32x32x16_bf16 v[140:155], v[32:35], v[76:79], v[140:155]
  ds_read_b128 v[28:31], v8 offset:16384
  s_waitcnt lgkmcnt(1)
  v_mfma_f32_32x32x16_bf16 v[140:155], v[36:39], v[80:83], v[140:155]
  ds_read_b128 v[32:35], v9 offset:16384
  s_waitcnt lgkmcnt(1)
  v_mfma_f32_32x32x16_bf16 v[140:155], v[28:31], v[244:247], v[140:155]
  ds_read_b128 v[36:39], v10 offset:16384
  s_waitcnt lgkmcnt(1)
  v_mfma_f32_32x32x16_bf16 v[140:155], v[32:35], v[248:251], v[140:155]
  ds_read_b128 v[28:31], v11 offset:16384
  s_waitcnt lgkmcnt(1)
  v_mfma_f32_32x32x16_bf16 v[140:155], v[36:39], v[84:87], v[140:155]
  ds_read_b128 v[32:35], v12 offset:40960
  s_waitcnt lgkmcnt(1)
  v_mfma_f32_32x32x16_bf16 v[140:155], v[28:31], v[88:91], v[140:155]
  ds_read_b128 v[36:39], v12 offset:43008
  s_waitcnt lgkmcnt(1)
  v_mfma_f32_32x32x16_bf16 v[140:155], v[32:35], v[20:23], v[140:155]
  s_waitcnt lgkmcnt(0)
  v_mfma_f32_32x32x16_bf16 v[140:155], v[36:39], v[24:27], v[140:155]
  s_nop 11
  v_cvt_pk_bf16_f32 v92, v140, v141
  v_cvt_pk_bf16_f32 v93, v142, v143
  v_cvt_pk_bf16_f32 v94, v144, v145
  v_cvt_pk_bf16_f32 v95, v146, v147
  s_mul_i32 s46, s5, 98304
  s_add_u32 s46, s46, 1572864
  buffer_store_dwordx4 v[92:95], v7, s[24:27], s46 offen offset:0 sc1
  v_cvt_pk_bf16_f32 v96, v148, v149
  v_cvt_pk_bf16_f32 v97, v150, v151
  v_cvt_pk_bf16_f32 v98, v152, v153
  v_cvt_pk_bf16_f32 v99, v154, v155
  s_mul_i32 s47, s5, 98304
  s_add_u32 s47, s47, 1671168
  buffer_store_dwordx4 v[96:99], v7, s[24:27], s47 offen offset:0 sc1
  s_endpgm
SPIN_c:
  s_add_u32 s89, s89, 1
  s_cmp_gt_u32 s89, 200000
  s_cbranch_scc1 BACK_c
  s_sleep 2
  buffer_load_dword v40, off, s[96:99], s101 sc1
  s_waitcnt vmcnt(0)
  v_and_b32 v40, s87, v40
  v_cmp_ne_u32 vcc, s87, v40
  s_nop 4
  s_cbranch_vccnz SPIN_c
  s_branch BACK_c
SPIN_p0:
  s_add_u32 s89, s89, 1
  s_cmp_gt_u32 s89, 200000
  s_cbranch_scc1 BACK_p0
  s_sleep 2
  buffer_load_dwordx2 v[254:255], v16, s[32:35], 0 offen offset:3072 sc1
  buffer_load_dwordx2 v[252:253], v16, s[32:35], 0 offen offset:2048 sc1
  buffer_load_dwordx2 v[42:43], v16, s[32:35], 0 offen offset:1024 sc1
  buffer_load_dwordx2 v[40:41], v16, s[32:35], 0 offen offset:0 sc1
  s_waitcnt vmcnt(0)
  v_max3_u32 v2, v40, v42, v252
  v_max_u32 v2, v2, v254
  v_cmp_eq_u32 vcc, -1, v2
  s_nop 4
  s_cbranch_vccnz SPIN_p0
  s_branch BACK_p0
SPIN_p1:
  s_add_u32 s89, s89, 1
  s_cmp_gt_u32 s89, 200000
  s_cbranch_scc1 BACK_p1
  s_sleep 2
  buffer_load_dwordx2 v[254:255], v16, s[32:35], 0 offen offset:3072 sc1
  buffer_load_dwordx2 v[252:253], v16, s[32:35], 0 offen offset:2048 sc1
  buffer_load_dwordx2 v[42:43], v16, s[32:35], 0 offen offset:1024 sc1
  buffer_load_dwordx2 v[40:41], v16, s[32:35], 0 offen offset:0 sc1
  s_waitcnt vmcnt(0)
  v_max3_u32 v2, v40, v42, v252
  v_max_u32 v2, v2, v254
  v_cmp_eq_u32 vcc, -1, v2
  s_nop 4
  s_cbranch_vccnz SPIN_p1
  s_branch BACK_p1
SPIN_p2:
  s_add_u32 s89, s89, 1
  s_cmp_gt_u32 s89, 200000
  s_cbranch_scc1 BACK_p2
  s_sleep 2
  buffer_load_dwordx2 v[254:255], v16, s[32:35], 0 offen offset:3072 sc1
  buffer_load_dwordx2 v[252:253], v16, s[32:35], 0 offen offset:2048 sc1
  buffer_load_dwordx2 v[42:43], v16, s[32:35], 0 offen offset:1024 sc1
  buffer_load_dwordx2 v[40:41], v16, s[32:35], 0 offen offset:0 sc1
  s_waitcnt vmcnt(0)
  v_max3_u32 v2, v40, v42, v252
  v_max_u32 v2, v2, v254
  v_cmp_eq_u32 vcc, -1, v2
  s_nop 4
  s_cbranch_vccnz SPIN_p2
  s_branch BACK_p2
SPIN_p3:
  s_add_u32 s89, s89, 1
  s_cmp_gt_u32 s89, 200000
  s_cbranch_scc1 BACK_p3
  s_sleep 2
  buffer_load_dwordx2 v[254:255], v16, s[32:35], 0 offen offset:3072 sc1
  buffer_load_dwordx2 v[252:253], v16, s[32:35], 0 offen offset:2048 sc1
  buffer_load_dwordx2 v[42:43], v16, s[32:35], 0 offen offset:1024 sc1
  buffer_load_dwordx2 v[40:41], v16, s[32:35], 0 offen offset:0 sc1
  s_waitcnt vmcnt(0)
  v_max3_u32 v2, v40, v42, v252
  v_max_u32 v2, v2, v254
  v_cmp_eq_u32 vcc, -1, v2
  s_nop 4
  s_cbranch_vccnz SPIN_p3
  s_branch BACK_p3
SPIN_p4:
  s_add_u32 s89, s89, 1
  s_cmp_gt_u32 s89, 200000
  s_cbranch_scc1 BACK_p4
  s_sleep 2
  buffer_load_dwordx2 v[254:255], v16, s[32:35], 0 offen offset:3072 sc1
  buffer_load_dwordx2 v[252:253], v16, s[32:35], 0 offen offset:2048 sc1
  buffer_load_dwordx2 v[42:43], v16, s[32:35], 0 offen offset:1024 sc1
  buffer_load_dwordx2 v[40:41], v16, s[32:35], 0 offen offset:0 sc1
  s_waitcnt vmcnt(0)
  v_max3_u32 v2, v40, v42, v252
  v_max_u32 v2, v2, v254
  v_cmp_eq_u32 vcc, -1, v2
  s_nop 4
  s_cbranch_vccnz SPIN_p4
  s_branch BACK_p4
K1_END:
  s_endpgm
CODE_END:
.section .rodata,"a"
.p2align 6
.amdhsa_kernel recurrent_scan__ssm_conv_s5__dense_activation_gelu__prompt_kernel
  .amdhsa_next_free_vgpr 256
  .amdhsa_next_free_sgpr 102
  .amdhsa_accum_offset 256
  .amdhsa_group_segment_fixed_size 0
  .amdhsa_kernarg_size 136
  .amdhsa_user_sgpr_count 2
  .amdhsa_user_sgpr_kernarg_segment_ptr 1
  .amdhsa_system_sgpr_workgroup_id_x 1
.end_amdhsa_kernel
```
